```python
import torch

def _softmax(x, axis=-1):
    return torch.softmax(x, dim=axis)
def _gelu(x):
    return torch.nn.functional.gelu(x, approximate="tanh")
def _silu(x):
    return torch.nn.functional.silu(x)
def _sigmoid(x):
    return torch.sigmoid(x)
def _layernorm(x, axis=-1, eps=1e-5):
    m = x.mean(dim=axis, keepdim=True)
    v = x.var(dim=axis, keepdim=True, unbiased=False)
    return (x - m) / torch.sqrt(v + eps)
def _scatter_add(tgt, idx, src, axis=0):
    return tgt.clone().index_add_(axis, idx, src)
def _segment_sum(src, seg, n):
    out = torch.zeros((n,) + src.shape[1:], dtype=src.dtype)
    return out.index_add_(0, seg, src)
def _pad(x, pw):
    flat = tuple(v for pair in reversed(pw) for v in pair)
    return torch.nn.functional.pad(x, flat)

kernel_name = 'standalone__layernorm_linear__sampling'

def setup_inputs():

    _w = (lambda a: (lambda t: t.to(torch.bfloat16) if t.is_floating_point() else t)(torch.as_tensor(a)))
    B, S, D = 1024, 32, 448
    return {
        "x": _w((lambda *s: torch.randn(*s, dtype=torch.bfloat16) * 0.05)(B, S, D)),
        "g": _w((lambda *s: torch.randn(*s, dtype=torch.bfloat16) * 0.05)(D) + 1.0),
        "b": _w((lambda *s: torch.randn(*s, dtype=torch.bfloat16) * 0.4)(D)),
        "w": _w((lambda *s: torch.randn(*s, dtype=torch.bfloat16) * 0.05)(D, D)),
    }

def reference(x, g, b, w):
    return (_layernorm(x, axis=-1) * g + b) @ w
```

```asm
; @launch grid=(256,1,1) block=(256,1,1) lds=163840
.amdgcn_target "amdgcn-amd-amdhsa--gfx950"
.text
.globl standalone__layernorm_linear__sampling_kernel
.p2align 8
.type standalone__layernorm_linear__sampling_kernel,@function
standalone__layernorm_linear__sampling_kernel:
    s_getpc_b64 s[48:49]
    s_cmp_ge_u32 s2, 256
    s_cbranch_scc1 L_end
    s_load_dwordx4 s[4:7], s[0:1], 0
    s_load_dwordx4 s[8:11], s[0:1], 16
    s_load_dwordx2 s[12:13], s[0:1], 32
    v_lshrrev_b32 v58, 6, v0
    v_and_b32 v66, 63, v0
    v_readfirstlane_b32 s3, v58
    s_lshr_b32 s46, s2, 3
    s_and_b32 s46, s46, 31
    s_lshl_b32 s46, s46, 2
    s_add_u32 s46, s46, s3
    s_mul_i32 s37, s46, 4
    v_min_u32 v59, 3, v66
    v_add_u32 v59, s37, v59
    v_min_u32 v59, CODE_LINES-1, v59
    v_lshlrev_b32_e64 v59, 7, v59
    global_load_dword v64, v59, s[48:49]
    v_lshrrev_b32 v58, 4, v0
    v_lshrrev_b32 v56, 4, v66
    v_and_b32_e64 v57, 15, v66
    v_mul_u32_u24 v58, 896, v58
    v_lshl_add_u32 v1, v57, 3, v58
    v_lshl_add_u32 v0, v57, 4, v58
    v_add_u32 v1, 768, v1
    s_and_b32 s50, s2, 7
    s_lshl_b32 s50, s50, 5
    s_lshr_b32 s51, s2, 3
    s_add_u32 s50, s50, s51
    s_mul_i32 s50, s50, 114688
    s_add_u32 s51, s50, 14336
    s_add_u32 s52, s50, 28672
    s_add_u32 s53, s50, 43008
    s_add_u32 s54, s50, 57344
    s_add_u32 s55, s50, 71680
    s_add_u32 s56, s50, 86016
    s_add_u32 s57, s50, 100352
    s_mul_i32 s38, s3, 12288
    s_add_u32 s38, s38, 114688
    v_lshlrev_b32_e64 v70, 4, v66
    v_lshl_add_u32 v68, v57, 4, s38
    v_lshl_add_u32 v69, v57, 3, s38
    s_mov_b32 s18, 29360128
    s_mov_b32 s19, 0x20000
    s_mov_b32 s22, 403456
    s_mov_b32 s23, 0x20000
    s_mov_b32 s26, 29360128
    s_mov_b32 s27, 0x20000
    s_mov_b32 s30, 896
    s_mov_b32 s31, 0x20000
    s_mov_b32 s34, 896
    s_mov_b32 s35, 0x20000
    s_waitcnt lgkmcnt(0)
    s_load_dword s95, s[6:7], 0
    s_load_dword s95, s[8:9], 0
    s_load_dword s95, s[10:11], 0
    s_sub_u32 s20, s10, 2048
    s_subb_u32 s21, s11, 0
    s_mov_b64 s[16:17], s[4:5]
    buffer_load_dwordx4 v[120:123], v0, s[16:19], s50 offen offset:0 nt
    buffer_load_dwordx4 v[124:127], v0, s[16:19], s50 offen offset:256 nt
    buffer_load_dwordx4 v[128:131], v0, s[16:19], s50 offen offset:512 nt
    buffer_load_dwordx2 v[132:133], v1, s[16:19], s50 offen nt
    s_mov_b64 s[28:29], s[6:7]
    s_mov_b64 s[32:33], s[8:9]
    s_mov_b32 m0, s38
    s_nop 0
    buffer_load_dwordx4 v70, s[28:31], 0 offen lds
    s_add_u32 m0, s38, 1024
    s_nop 0
    buffer_load_dwordx4 v70, s[32:35], 0 offen lds
    buffer_load_dwordx4 v[134:137], v0, s[16:19], s51 offen offset:0 nt
    buffer_load_dwordx4 v[138:141], v0, s[16:19], s51 offen offset:256 nt
    buffer_load_dwordx4 v[142:145], v0, s[16:19], s51 offen offset:512 nt
    buffer_load_dwordx2 v[146:147], v1, s[16:19], s51 offen nt
    s_mov_b32 s40, 0xffff0000
    s_mov_b32 s41, 0x00003f80
    s_mov_b32 s42, 0x3f800000
    s_mov_b32 s43, 0x3f803f80
    s_mov_b32 s44, 0x3b124925
    v_mov_b32 v16, 0x3727c5ac
    s_lshl_b32 s39, s3, 2
    v_add_u32 v58, s39, v56
    v_and_b32 v59, 7, v57
    v_xor_b32 v59, v59, v58
    v_and_b32 v60, 3, v57
    v_lshl_add_u32 v59, v60, 4, v59
    v_lshlrev_b32 v59, 4, v59
    v_lshrrev_b32 v60, 2, v57
    v_lshl_add_u32 v14, v60, 10, v59
    v_lshrrev_b32 v59, 1, v57
    v_xor_b32 v60, v59, v58
    v_and_b32_e64 v59, 3, v59
    v_lshl_add_u32 v60, v59, 4, v60
    v_lshlrev_b32 v60, 4, v60
    v_lshrrev_b32 v59, 3, v57
    v_lshl_add_u32 v60, v59, 10, v60
    v_and_b32_e64 v59, 1, v57
    v_lshl_add_u32 v60, v59, 3, v60
    v_add_u32 v15, 12288, v60
    v_mul_u32_u24 v58, 400, v58
    v_add_u32 v58, 114688, v58
    v_lshl_add_u32 v23, v57, 4, v58
    v_lshl_add_u32 v24, v57, 3, v58
    v_add_u32 v24, 256, v24
    v_lshrrev_b32 v58, 3, v66
    v_and_b32 v59, 4, v58
    v_add_u32_e64 v59, v59, v58
    v_mul_u32_u24 v59, 896, v59
    v_and_b32 v60, 6, v58
    v_and_b32 v61, 7, v66
    v_xor_b32_e64 v60, v60, v61
    v_lshl_add_u32 v59, v60, 4, v59
    s_lshl_b32 s39, s3, 7
    s_add_u32 s37, s39, 2048
    v_add_u32 v8, s37, v59
    v_add_u32 v9, 13312, v8
    v_mul_u32_u24 v59, 896, v58
    v_lshl_add_u32 v59, v61, 4, v59
    v_add_u32_e64 v19, s39, v59
    v_add_u32 v20, 7168, v19
    v_xor_b32_e64 v59, v61, v58
    v_lshl_add_u32 v59, v58, 3, v59
    s_add_u32 s47, s38, 10240
    v_lshl_add_u32 v18, v59, 4, s47
    v_lshrrev_b32 v59, 2, v66
    v_lshlrev_b32 v59, 7, v59
    v_and_b32_e64 v60, 3, v58
    v_lshl_add_u32 v59, v60, 5, v59
    v_and_b32_e64 v60, 3, v66
    v_lshl_add_u32 v59, v60, 3, v59
    v_add_u32 v10, s38, v59
    v_xor_b32 v11, 32, v10
    v_xor_b32_e64 v12, 64, v10
    v_xor_b32 v13, 96, v10
    v_xor_b32_e64 v58, v56, v57
    v_lshl_add_u32 v58, v56, 4, v58
    v_lshlrev_b32 v6, 4, v58
    v_xor_b32 v7, 64, v6
    v_lshrrev_b32 v58, 1, v56
    v_and_b32 v59, 7, v57
    v_xor_b32_e64 v58, v58, v59
    v_lshl_add_u32 v58, v57, 3, v58
    v_lshl_add_u32 v58, v58, 4, s47
    v_lshrrev_b32 v59, 3, v57
    v_xor_b32 v59, v59, v56
    v_and_b32_e64 v59, 1, v59
    v_lshl_add_u32 v28, v59, 3, v58
    v_xor_b32 v29, 32, v28
    v_xor_b32 v30, 64, v28
    v_xor_b32 v31, 96, v28
    v_lshrrev_b32 v58, 2, v66
    v_and_b32 v59, 12, v58
    v_add_u32_e64 v59, v59, v58
    v_mul_u32_u24 v59, 896, v59
    v_and_b32 v60, 1, v56
    v_lshlrev_b32 v61, 1, v60
    v_and_b32 v62, 3, v66
    v_xor_b32 v61, v61, v62
    v_lshl_add_u32 v59, v61, 4, v59
    s_lshl_b32 s39, s3, 6
    s_add_u32 s37, s39, 1536
    v_add_u32 v2, s37, v59
    v_add_u32 v3, 2560, v2
    v_lshlrev_b32_e64 v59, 6, v58
    v_lshl_add_u32 v59, v60, 5, v59
    v_lshl_add_u32 v59, v62, 3, v59
    v_add_u32 v26, s38, v59
    v_xor_b32 v27, 32, v26
    v_lshl_add_u32 v5, v66, 3, s38
    v_lshlrev_b32_e64 v25, 7, v66
    v_mul_u32_u24 v59, 400, v57
    v_lshl_add_u32 v59, v56, 3, v59
    s_add_u32 s37, s39, 114688
    v_add_u32 v21, s37, v59
    s_lshl_b32 s39, s3, 5
    s_add_u32 s37, s39, 114944
    v_add_u32_e64 v22, s37, v59
    v_bfe_u32 v58, v66, 3, 2
    v_lshrrev_b32 v59, 5, v66
    v_lshlrev_b32 v59, 2, v59
    v_lshl_add_u32 v59, v58, 3, v59
    v_bfe_u32 v58, v66, 1, 2
    v_add_u32_e64 v59, v59, v58
    v_mul_u32_u24 v59, 896, v59
    v_and_b32_e64 v58, 1, v66
    v_lshl_add_u32 v59, v58, 4, v59
    s_add_u32 s37, s39, 2816
    v_add_u32_e64 v4, s37, v59
    buffer_load_dwordx4 v[148:151], v0, s[16:19], s52 offen offset:0 nt
    buffer_load_dwordx4 v[152:155], v0, s[16:19], s52 offen offset:256 nt
    buffer_load_dwordx4 v[156:159], v0, s[16:19], s52 offen offset:512 nt
    buffer_load_dwordx2 v[160:161], v1, s[16:19], s52 offen nt
    s_waitcnt vmcnt(10)
    s_nop 0
    v_dot2_f32_bf16 v17, v120, s43, 0
    v_dot2_f32_bf16 v17, v121, s43, v17
    v_dot2_f32_bf16 v17, v122, s43, v17
    v_dot2_f32_bf16 v17, v123, s43, v17
    v_dot2_f32_bf16 v17, v124, s43, v17
    v_dot2_f32_bf16 v17, v125, s43, v17
    v_dot2_f32_bf16 v17, v126, s43, v17
    v_dot2_f32_bf16 v17, v127, s43, v17
    v_dot2_f32_bf16 v17, v128, s43, v17
    v_dot2_f32_bf16 v17, v129, s43, v17
    v_dot2_f32_bf16 v17, v130, s43, v17
    v_dot2_f32_bf16 v17, v131, s43, v17
    v_dot2_f32_bf16 v17, v132, s43, v17
    v_dot2_f32_bf16 v17, v133, s43, v17
    s_nop 2
    v_add_f32_dpp v17, v17, v17 row_ror:8 row_mask:0xf bank_mask:0xf
    s_nop 1
    v_add_f32_dpp v17, v17, v17 row_ror:4 row_mask:0xf bank_mask:0xf
    s_nop 1
    v_add_f32_dpp v17, v17, v17 row_ror:2 row_mask:0xf bank_mask:0xf
    s_nop 1
    v_add_f32_dpp v17, v17, v17 row_ror:1 row_mask:0xf bank_mask:0xf
    v_mul_f32_e64 v17, s44, v17
    v_dot2_f32_bf16 v172, v120, s41, v17 neg_lo:[0,0,1]
    v_dot2_f32_bf16 v173, v120, s42, v17 neg_lo:[0,0,1]
    v_dot2_f32_bf16 v174, v121, s41, v17 neg_lo:[0,0,1]
    v_dot2_f32_bf16 v175, v121, s42, v17 neg_lo:[0,0,1]
    v_dot2_f32_bf16 v176, v122, s41, v17 neg_lo:[0,0,1]
    v_dot2_f32_bf16 v177, v122, s42, v17 neg_lo:[0,0,1]
    v_dot2_f32_bf16 v178, v123, s41, v17 neg_lo:[0,0,1]
    v_dot2_f32_bf16 v179, v123, s42, v17 neg_lo:[0,0,1]
    v_dot2_f32_bf16 v180, v124, s41, v17 neg_lo:[0,0,1]
    v_dot2_f32_bf16 v181, v124, s42, v17 neg_lo:[0,0,1]
    v_dot2_f32_bf16 v182, v125, s41, v17 neg_lo:[0,0,1]
    v_dot2_f32_bf16 v183, v125, s42, v17 neg_lo:[0,0,1]
    v_dot2_f32_bf16 v184, v126, s41, v17 neg_lo:[0,0,1]
    v_dot2_f32_bf16 v185, v126, s42, v17 neg_lo:[0,0,1]
    v_dot2_f32_bf16 v186, v127, s41, v17 neg_lo:[0,0,1]
    v_dot2_f32_bf16 v187, v127, s42, v17 neg_lo:[0,0,1]
    v_dot2_f32_bf16 v188, v128, s41, v17 neg_lo:[0,0,1]
    v_dot2_f32_bf16 v189, v128, s42, v17 neg_lo:[0,0,1]
    v_dot2_f32_bf16 v190, v129, s41, v17 neg_lo:[0,0,1]
    v_dot2_f32_bf16 v191, v129, s42, v17 neg_lo:[0,0,1]
    v_dot2_f32_bf16 v192, v130, s41, v17 neg_lo:[0,0,1]
    s_bitcmp1_b32 s2, 3
    s_cbranch_scc1 L_cls1
    buffer_load_dwordx4 v[106:109], v0, s[16:19], s53 offen offset:0 nt
    v_dot2_f32_bf16 v193, v130, s42, v17 neg_lo:[0,0,1]
    v_dot2_f32_bf16 v194, v131, s41, v17 neg_lo:[0,0,1]
    v_dot2_f32_bf16 v195, v131, s42, v17 neg_lo:[0,0,1]
    v_dot2_f32_bf16 v196, v132, s41, v17 neg_lo:[0,0,1]
    v_dot2_f32_bf16 v197, v132, s42, v17 neg_lo:[0,0,1]
    v_dot2_f32_bf16 v198, v133, s41, v17 neg_lo:[0,0,1]
    v_dot2_f32_bf16 v199, v133, s42, v17 neg_lo:[0,0,1]
    s_waitcnt vmcnt(9)
    s_nop 0
    ds_read_b128 v[72:75], v68 offset:0
    ds_read_b128 v[76:79], v68 offset:256
    ds_read_b128 v[80:83], v68 offset:512
    ds_read_b64 v[84:85], v69 offset:768
    ds_read_b128 v[86:89], v68 offset:1024
    ds_read_b128 v[90:93], v68 offset:1280
    ds_read_b128 v[94:97], v68 offset:1536
    ds_read_b64 v[98:99], v69 offset:1792
    v_pk_mul_f32 v[120:121], v[172:173], v[172:173]
    v_pk_fma_f32 v[120:121], v[174:175], v[174:175], v[120:121]
    v_pk_fma_f32 v[120:121], v[176:177], v[176:177], v[120:121]
    v_pk_fma_f32 v[120:121], v[178:179], v[178:179], v[120:121]
    v_pk_fma_f32 v[120:121], v[180:181], v[180:181], v[120:121]
    v_pk_fma_f32 v[120:121], v[182:183], v[182:183], v[120:121]
    v_pk_fma_f32 v[120:121], v[184:185], v[184:185], v[120:121]
    v_pk_fma_f32 v[120:121], v[186:187], v[186:187], v[120:121]
    buffer_load_dwordx4 v[110:113], v0, s[16:19], s53 offen offset:256 nt
    v_pk_fma_f32 v[120:121], v[188:189], v[188:189], v[120:121]
    v_pk_fma_f32 v[120:121], v[190:191], v[190:191], v[120:121]
    v_pk_fma_f32 v[120:121], v[192:193], v[192:193], v[120:121]
    v_pk_fma_f32 v[120:121], v[194:195], v[194:195], v[120:121]
    v_pk_fma_f32 v[120:121], v[196:197], v[196:197], v[120:121]
    v_pk_fma_f32 v[120:121], v[198:199], v[198:199], v[120:121]
    s_waitcnt lgkmcnt(0)
    v_lshlrev_b32 v228, 16, v72
    v_and_b32 v229, s40, v72
    v_lshlrev_b32 v230, 16, v73
    v_and_b32 v231, s40, v73
    v_lshlrev_b32 v232, 16, v74
    v_and_b32 v233, s40, v74
    v_lshlrev_b32 v234, 16, v75
    v_and_b32 v235, s40, v75
    v_lshlrev_b32 v236, 16, v76
    v_and_b32 v237, s40, v76
    v_lshlrev_b32 v238, 16, v77
    v_and_b32 v239, s40, v77
    v_lshlrev_b32 v240, 16, v78
    v_and_b32 v241, s40, v78
    v_lshlrev_b32 v242, 16, v79
    v_and_b32 v243, s40, v79
    v_lshlrev_b32 v244, 16, v80
    buffer_load_dwordx4 v[114:117], v0, s[16:19], s53 offen offset:512 nt
    v_and_b32 v245, s40, v80
    v_lshlrev_b32 v246, 16, v81
    v_and_b32 v247, s40, v81
    v_lshlrev_b32 v248, 16, v82
    v_and_b32 v249, s40, v82
    v_lshlrev_b32 v250, 16, v83
    v_and_b32 v251, s40, v83
    v_lshlrev_b32 v252, 16, v84
    v_and_b32 v253, s40, v84
    v_lshlrev_b32 v254, 16, v85
    v_and_b32 v255, s40, v85
    v_lshlrev_b32 v200, 16, v86
    v_and_b32 v201, s40, v86
    v_lshlrev_b32 v202, 16, v87
    v_and_b32 v203, s40, v87
    v_lshlrev_b32 v204, 16, v88
    v_and_b32 v205, s40, v88
    v_lshlrev_b32 v206, 16, v89
    v_and_b32 v207, s40, v89
    v_lshlrev_b32 v208, 16, v90
    v_and_b32 v209, s40, v90
    v_lshlrev_b32 v210, 16, v91
    v_and_b32 v211, s40, v91
    v_lshlrev_b32 v212, 16, v92
    buffer_load_dwordx2 v[118:119], v1, s[16:19], s53 offen nt
    v_and_b32 v213, s40, v92
    v_lshlrev_b32 v214, 16, v93
    v_and_b32 v215, s40, v93
    v_lshlrev_b32 v216, 16, v94
    v_and_b32 v217, s40, v94
    v_lshlrev_b32 v218, 16, v95
    v_and_b32 v219, s40, v95
    v_lshlrev_b32 v220, 16, v96
    v_and_b32 v221, s40, v96
    v_lshlrev_b32 v222, 16, v97
    v_and_b32 v223, s40, v97
    v_lshlrev_b32 v224, 16, v98
    v_and_b32 v225, s40, v98
    v_lshlrev_b32 v226, 16, v99
    v_and_b32 v227, s40, v99
    v_add_f32 v120, v120, v121
    v_pk_mul_f32 v[172:173], v[172:173], v[228:229]
    v_pk_mul_f32 v[174:175], v[174:175], v[230:231]
    v_add_f32_dpp v120, v120, v120 row_ror:8 row_mask:0xf bank_mask:0xf
    v_pk_mul_f32 v[176:177], v[176:177], v[232:233]
    v_pk_mul_f32 v[178:179], v[178:179], v[234:235]
    v_add_f32_dpp v120, v120, v120 row_ror:4 row_mask:0xf bank_mask:0xf
    v_pk_mul_f32 v[180:181], v[180:181], v[236:237]
    v_pk_mul_f32 v[182:183], v[182:183], v[238:239]
    v_add_f32_dpp v120, v120, v120 row_ror:2 row_mask:0xf bank_mask:0xf
    v_pk_mul_f32 v[184:185], v[184:185], v[240:241]
    v_pk_mul_f32 v[186:187], v[186:187], v[242:243]
    v_add_f32_dpp v120, v120, v120 row_ror:1 row_mask:0xf bank_mask:0xf
    v_fma_f32 v120, v120, s44, v16
    v_rsq_f32_e64 v122, v120
    v_pk_mul_f32 v[188:189], v[188:189], v[244:245]
    v_pk_mul_f32 v[190:191], v[190:191], v[246:247]
    v_pk_mul_f32 v[192:193], v[192:193], v[248:249]
    v_pk_mul_f32 v[194:195], v[194:195], v[250:251]
    v_pk_mul_f32 v[196:197], v[196:197], v[252:253]
    v_pk_mul_f32 v[198:199], v[198:199], v[254:255]
    v_pk_fma_f32 v[172:173], v[172:173], v[122:123], v[200:201] op_sel_hi:[1,0,1]
    v_pk_fma_f32 v[174:175], v[174:175], v[122:123], v[202:203] op_sel_hi:[1,0,1]
    v_pk_fma_f32 v[176:177], v[176:177], v[122:123], v[204:205] op_sel_hi:[1,0,1]
    v_pk_fma_f32 v[178:179], v[178:179], v[122:123], v[206:207] op_sel_hi:[1,0,1]
    v_cvt_pk_bf16_f32 v172, v172, v173
    v_cvt_pk_bf16_f32 v173, v174, v175
    v_cvt_pk_bf16_f32 v174, v176, v177
    v_cvt_pk_bf16_f32 v175, v178, v179
    ds_write_b128 v14, v[172:175] offset:0
    v_pk_fma_f32 v[180:181], v[180:181], v[122:123], v[208:209] op_sel_hi:[1,0,1]
    v_pk_fma_f32 v[182:183], v[182:183], v[122:123], v[210:211] op_sel_hi:[1,0,1]
    v_pk_fma_f32 v[184:185], v[184:185], v[122:123], v[212:213] op_sel_hi:[1,0,1]
    v_pk_fma_f32 v[186:187], v[186:187], v[122:123], v[214:215] op_sel_hi:[1,0,1]
    v_cvt_pk_bf16_f32 v180, v180, v181
    v_cvt_pk_bf16_f32 v181, v182, v183
    v_cvt_pk_bf16_f32 v182, v184, v185
    v_cvt_pk_bf16_f32 v183, v186, v187
    ds_write_b128 v14, v[180:183] offset:4096
    v_pk_fma_f32 v[188:189], v[188:189], v[122:123], v[216:217] op_sel_hi:[1,0,1]
    v_pk_fma_f32 v[190:191], v[190:191], v[122:123], v[218:219] op_sel_hi:[1,0,1]
    v_pk_fma_f32 v[192:193], v[192:193], v[122:123], v[220:221] op_sel_hi:[1,0,1]
    v_pk_fma_f32 v[194:195], v[194:195], v[122:123], v[222:223] op_sel_hi:[1,0,1]
    s_waitcnt vmcnt(8)
    s_nop 0
    v_dot2_f32_bf16 v17, v134, s43, 0
    v_dot2_f32_bf16 v17, v135, s43, v17
    v_dot2_f32_bf16 v17, v136, s43, v17
    v_dot2_f32_bf16 v17, v137, s43, v17
    v_dot2_f32_bf16 v17, v138, s43, v17
    v_dot2_f32_bf16 v17, v139, s43, v17
    v_dot2_f32_bf16 v17, v140, s43, v17
    v_dot2_f32_bf16 v17, v141, s43, v17
    v_dot2_f32_bf16 v17, v142, s43, v17
    v_dot2_f32_bf16 v17, v143, s43, v17
    v_dot2_f32_bf16 v17, v144, s43, v17
    v_dot2_f32_bf16 v17, v145, s43, v17
    v_dot2_f32_bf16 v17, v146, s43, v17
    v_dot2_f32_bf16 v17, v147, s43, v17
    v_cvt_pk_bf16_f32 v188, v188, v189
    v_cvt_pk_bf16_f32 v189, v190, v191
    v_cvt_pk_bf16_f32 v190, v192, v193
    v_add_f32_dpp v17, v17, v17 row_ror:8 row_mask:0xf bank_mask:0xf
    v_cvt_pk_bf16_f32 v191, v194, v195
    ds_write_b128 v14, v[188:191] offset:8192
    v_add_f32_dpp v17, v17, v17 row_ror:4 row_mask:0xf bank_mask:0xf
    v_pk_fma_f32 v[196:197], v[196:197], v[122:123], v[224:225] op_sel_hi:[1,0,1]
    v_pk_fma_f32 v[198:199], v[198:199], v[122:123], v[226:227] op_sel_hi:[1,0,1]
    v_add_f32_dpp v17, v17, v17 row_ror:2 row_mask:0xf bank_mask:0xf
    v_cvt_pk_bf16_f32 v196, v196, v197
    v_cvt_pk_bf16_f32 v197, v198, v199
    v_add_f32_dpp v17, v17, v17 row_ror:1 row_mask:0xf bank_mask:0xf
    ds_write_b64 v15, v[196:197] offset:0
    v_mul_f32 v17, s44, v17
    s_mov_b64 s[24:25], s[12:13]
    s_mov_b32 s28, 28672
    s_mov_b32 s29, 57344
    s_mov_b32 s30, 86016
    s_mov_b32 s31, 114688
    s_mov_b32 s32, 143360
    s_mov_b32 s33, 172032
    s_mov_b32 s34, 200704
    s_mov_b32 s35, 229376
    s_mov_b32 s92, 258048
    s_mov_b32 s93, 286720
    s_mov_b32 s94, 315392
    s_mov_b32 s98, 344064
    s_mov_b32 s99, 372736
    v_dot2_f32_bf16 v172, v134, s41, v17 neg_lo:[0,0,1]
    v_dot2_f32_bf16 v173, v134, s42, v17 neg_lo:[0,0,1]
    buffer_load_dwordx4 v[72:75], v0, s[16:19], s54 offen offset:0 nt
    v_dot2_f32_bf16 v174, v135, s41, v17 neg_lo:[0,0,1]
    v_dot2_f32_bf16 v175, v135, s42, v17 neg_lo:[0,0,1]
    v_dot2_f32_bf16 v176, v136, s41, v17 neg_lo:[0,0,1]
    v_dot2_f32_bf16 v177, v136, s42, v17 neg_lo:[0,0,1]
    v_dot2_f32_bf16 v178, v137, s41, v17 neg_lo:[0,0,1]
    v_dot2_f32_bf16 v179, v137, s42, v17 neg_lo:[0,0,1]
    v_dot2_f32_bf16 v180, v138, s41, v17 neg_lo:[0,0,1]
    v_dot2_f32_bf16 v181, v138, s42, v17 neg_lo:[0,0,1]
    v_dot2_f32_bf16 v182, v139, s41, v17 neg_lo:[0,0,1]
    v_dot2_f32_bf16 v183, v139, s42, v17 neg_lo:[0,0,1]
    v_dot2_f32_bf16 v184, v140, s41, v17 neg_lo:[0,0,1]
    v_dot2_f32_bf16 v185, v140, s42, v17 neg_lo:[0,0,1]
    v_dot2_f32_bf16 v186, v141, s41, v17 neg_lo:[0,0,1]
    v_dot2_f32_bf16 v187, v141, s42, v17 neg_lo:[0,0,1]
    v_dot2_f32_bf16 v188, v142, s41, v17 neg_lo:[0,0,1]
    v_dot2_f32_bf16 v189, v142, s42, v17 neg_lo:[0,0,1]
    v_dot2_f32_bf16 v190, v143, s41, v17 neg_lo:[0,0,1]
    v_dot2_f32_bf16 v191, v143, s42, v17 neg_lo:[0,0,1]
    v_dot2_f32_bf16 v192, v144, s41, v17 neg_lo:[0,0,1]
    v_dot2_f32_bf16 v193, v144, s42, v17 neg_lo:[0,0,1]
    buffer_load_dwordx4 v[76:79], v0, s[16:19], s54 offen offset:256 nt
    v_dot2_f32_bf16 v194, v145, s41, v17 neg_lo:[0,0,1]
    v_dot2_f32_bf16 v195, v145, s42, v17 neg_lo:[0,0,1]
    v_dot2_f32_bf16 v196, v146, s41, v17 neg_lo:[0,0,1]
    v_dot2_f32_bf16 v197, v146, s42, v17 neg_lo:[0,0,1]
    v_dot2_f32_bf16 v198, v147, s41, v17 neg_lo:[0,0,1]
    v_dot2_f32_bf16 v199, v147, s42, v17 neg_lo:[0,0,1]
    v_pk_mul_f32 v[134:135], v[172:173], v[172:173]
    v_pk_fma_f32 v[134:135], v[174:175], v[174:175], v[134:135]
    v_pk_fma_f32 v[134:135], v[176:177], v[176:177], v[134:135]
    v_pk_fma_f32 v[134:135], v[178:179], v[178:179], v[134:135]
    v_pk_fma_f32 v[134:135], v[180:181], v[180:181], v[134:135]
    v_pk_fma_f32 v[134:135], v[182:183], v[182:183], v[134:135]
    v_pk_fma_f32 v[134:135], v[184:185], v[184:185], v[134:135]
    v_pk_fma_f32 v[134:135], v[186:187], v[186:187], v[134:135]
    v_pk_fma_f32 v[134:135], v[188:189], v[188:189], v[134:135]
    v_pk_fma_f32 v[134:135], v[190:191], v[190:191], v[134:135]
    v_pk_fma_f32 v[134:135], v[192:193], v[192:193], v[134:135]
    v_pk_fma_f32 v[134:135], v[194:195], v[194:195], v[134:135]
    v_pk_fma_f32 v[134:135], v[196:197], v[196:197], v[134:135]
    v_pk_fma_f32 v[134:135], v[198:199], v[198:199], v[134:135]
    v_add_f32_e64 v134, v134, v135
    buffer_load_dwordx4 v[80:83], v0, s[16:19], s54 offen offset:512 nt
    v_pk_mul_f32 v[172:173], v[172:173], v[228:229]
    v_pk_mul_f32 v[174:175], v[174:175], v[230:231]
    v_add_f32_dpp v134, v134, v134 row_ror:8 row_mask:0xf bank_mask:0xf
    v_pk_mul_f32 v[176:177], v[176:177], v[232:233]
    v_pk_mul_f32 v[178:179], v[178:179], v[234:235]
    v_add_f32_dpp v134, v134, v134 row_ror:4 row_mask:0xf bank_mask:0xf
    v_pk_mul_f32 v[180:181], v[180:181], v[236:237]
    v_pk_mul_f32 v[182:183], v[182:183], v[238:239]
    v_add_f32_dpp v134, v134, v134 row_ror:2 row_mask:0xf bank_mask:0xf
    v_pk_mul_f32 v[184:185], v[184:185], v[240:241]
    v_pk_mul_f32 v[186:187], v[186:187], v[242:243]
    v_add_f32_dpp v134, v134, v134 row_ror:1 row_mask:0xf bank_mask:0xf
    v_fma_f32 v134, v134, s44, v16
    v_rsq_f32_e64 v136, v134
    v_pk_mul_f32 v[188:189], v[188:189], v[244:245]
    v_pk_mul_f32 v[190:191], v[190:191], v[246:247]
    v_pk_mul_f32 v[192:193], v[192:193], v[248:249]
    v_pk_mul_f32 v[194:195], v[194:195], v[250:251]
    v_pk_mul_f32 v[196:197], v[196:197], v[252:253]
    v_pk_mul_f32 v[198:199], v[198:199], v[254:255]
    v_pk_fma_f32 v[172:173], v[172:173], v[136:137], v[200:201] op_sel_hi:[1,0,1]
    buffer_load_dwordx2 v[84:85], v1, s[16:19], s54 offen nt
    v_pk_fma_f32 v[174:175], v[174:175], v[136:137], v[202:203] op_sel_hi:[1,0,1]
    v_pk_fma_f32 v[176:177], v[176:177], v[136:137], v[204:205] op_sel_hi:[1,0,1]
    v_pk_fma_f32 v[178:179], v[178:179], v[136:137], v[206:207] op_sel_hi:[1,0,1]
    v_cvt_pk_bf16_f32 v172, v172, v173
    v_cvt_pk_bf16_f32 v173, v174, v175
    v_cvt_pk_bf16_f32 v174, v176, v177
    v_cvt_pk_bf16_f32 v175, v178, v179
    ds_write_b128 v14, v[172:175] offset:14336
    v_pk_fma_f32 v[180:181], v[180:181], v[136:137], v[208:209] op_sel_hi:[1,0,1]
    v_pk_fma_f32 v[182:183], v[182:183], v[136:137], v[210:211] op_sel_hi:[1,0,1]
    v_pk_fma_f32 v[184:185], v[184:185], v[136:137], v[212:213] op_sel_hi:[1,0,1]
    v_pk_fma_f32 v[186:187], v[186:187], v[136:137], v[214:215] op_sel_hi:[1,0,1]
    v_cvt_pk_bf16_f32 v180, v180, v181
    v_cvt_pk_bf16_f32 v181, v182, v183
    v_cvt_pk_bf16_f32 v182, v184, v185
    v_cvt_pk_bf16_f32 v183, v186, v187
    ds_write_b128 v14, v[180:183] offset:18432
    v_pk_fma_f32 v[188:189], v[188:189], v[136:137], v[216:217] op_sel_hi:[1,0,1]
    v_pk_fma_f32 v[190:191], v[190:191], v[136:137], v[218:219] op_sel_hi:[1,0,1]
    v_pk_fma_f32 v[192:193], v[192:193], v[136:137], v[220:221] op_sel_hi:[1,0,1]
    v_pk_fma_f32 v[194:195], v[194:195], v[136:137], v[222:223] op_sel_hi:[1,0,1]
    s_lshr_b32 s39, s2, 4
    s_lshl_b32 s39, s39, 2
    s_add_u32 s39, s39, s3
    s_mul_i32 s39, s39, 6272
    v_min_u32 v166, 3456, v25
    v_lshrrev_b32 v167, 9, v166
    v_mul_u32_u24 v167, 384, v167
    v_add_u32_e64 v166, v166, v167
    buffer_load_dword v167, v166, s[20:23], s39 offen offset:2048
    s_waitcnt vmcnt(9)
    s_nop 0
    v_dot2_f32_bf16 v17, v148, s43, 0
    v_dot2_f32_bf16 v17, v149, s43, v17
    v_dot2_f32_bf16 v17, v150, s43, v17
    v_dot2_f32_bf16 v17, v151, s43, v17
    v_dot2_f32_bf16 v17, v152, s43, v17
    v_dot2_f32_bf16 v17, v153, s43, v17
    v_dot2_f32_bf16 v17, v154, s43, v17
    v_dot2_f32_bf16 v17, v155, s43, v17
    v_dot2_f32_bf16 v17, v156, s43, v17
    v_dot2_f32_bf16 v17, v157, s43, v17
    v_dot2_f32_bf16 v17, v158, s43, v17
    v_dot2_f32_bf16 v17, v159, s43, v17
    v_dot2_f32_bf16 v17, v160, s43, v17
    v_dot2_f32_bf16 v17, v161, s43, v17
    v_cvt_pk_bf16_f32 v188, v188, v189
    v_cvt_pk_bf16_f32 v189, v190, v191
    v_cvt_pk_bf16_f32 v190, v192, v193
    v_add_f32_dpp v17, v17, v17 row_ror:8 row_mask:0xf bank_mask:0xf
    v_cvt_pk_bf16_f32 v191, v194, v195
    ds_write_b128 v14, v[188:191] offset:22528
    v_add_f32_dpp v17, v17, v17 row_ror:4 row_mask:0xf bank_mask:0xf
    v_pk_fma_f32 v[196:197], v[196:197], v[136:137], v[224:225] op_sel_hi:[1,0,1]
    v_pk_fma_f32 v[198:199], v[198:199], v[136:137], v[226:227] op_sel_hi:[1,0,1]
    v_add_f32_dpp v17, v17, v17 row_ror:2 row_mask:0xf bank_mask:0xf
    v_cvt_pk_bf16_f32 v196, v196, v197
    v_cvt_pk_bf16_f32 v197, v198, v199
    v_add_f32_dpp v17, v17, v17 row_ror:1 row_mask:0xf bank_mask:0xf
    ds_write_b64 v15, v[196:197] offset:14336
    v_mul_f32_e64 v17, s44, v17
    v_dot2_f32_bf16 v172, v148, s41, v17 neg_lo:[0,0,1]
    v_dot2_f32_bf16 v173, v148, s42, v17 neg_lo:[0,0,1]
    buffer_load_dwordx4 v[86:89], v0, s[16:19], s55 offen offset:0 nt
    v_dot2_f32_bf16 v174, v149, s41, v17 neg_lo:[0,0,1]
    v_dot2_f32_bf16 v175, v149, s42, v17 neg_lo:[0,0,1]
    v_dot2_f32_bf16 v176, v150, s41, v17 neg_lo:[0,0,1]
    v_dot2_f32_bf16 v177, v150, s42, v17 neg_lo:[0,0,1]
    v_dot2_f32_bf16 v178, v151, s41, v17 neg_lo:[0,0,1]
    v_dot2_f32_bf16 v179, v151, s42, v17 neg_lo:[0,0,1]
    v_dot2_f32_bf16 v180, v152, s41, v17 neg_lo:[0,0,1]
    v_dot2_f32_bf16 v181, v152, s42, v17 neg_lo:[0,0,1]
    v_dot2_f32_bf16 v182, v153, s41, v17 neg_lo:[0,0,1]
    v_dot2_f32_bf16 v183, v153, s42, v17 neg_lo:[0,0,1]
    v_dot2_f32_bf16 v184, v154, s41, v17 neg_lo:[0,0,1]
    v_dot2_f32_bf16 v185, v154, s42, v17 neg_lo:[0,0,1]
    v_dot2_f32_bf16 v186, v155, s41, v17 neg_lo:[0,0,1]
    v_dot2_f32_bf16 v187, v155, s42, v17 neg_lo:[0,0,1]
    v_dot2_f32_bf16 v188, v156, s41, v17 neg_lo:[0,0,1]
    v_dot2_f32_bf16 v189, v156, s42, v17 neg_lo:[0,0,1]
    v_dot2_f32_bf16 v190, v157, s41, v17 neg_lo:[0,0,1]
    v_dot2_f32_bf16 v191, v157, s42, v17 neg_lo:[0,0,1]
    v_dot2_f32_bf16 v192, v158, s41, v17 neg_lo:[0,0,1]
    v_dot2_f32_bf16 v193, v158, s42, v17 neg_lo:[0,0,1]
    v_dot2_f32_bf16 v194, v159, s41, v17 neg_lo:[0,0,1]
    v_dot2_f32_bf16 v195, v159, s42, v17 neg_lo:[0,0,1]
    buffer_load_dwordx4 v[90:93], v0, s[16:19], s55 offen offset:256 nt
    v_dot2_f32_bf16 v196, v160, s41, v17 neg_lo:[0,0,1]
    v_dot2_f32_bf16 v197, v160, s42, v17 neg_lo:[0,0,1]
    v_dot2_f32_bf16 v198, v161, s41, v17 neg_lo:[0,0,1]
    v_dot2_f32_bf16 v199, v161, s42, v17 neg_lo:[0,0,1]
    v_pk_mul_f32 v[148:149], v[172:173], v[172:173]
    v_pk_fma_f32 v[148:149], v[174:175], v[174:175], v[148:149]
    v_pk_fma_f32 v[148:149], v[176:177], v[176:177], v[148:149]
    v_pk_fma_f32 v[148:149], v[178:179], v[178:179], v[148:149]
    v_pk_fma_f32 v[148:149], v[180:181], v[180:181], v[148:149]
    v_pk_fma_f32 v[148:149], v[182:183], v[182:183], v[148:149]
    v_pk_fma_f32 v[148:149], v[184:185], v[184:185], v[148:149]
    v_pk_fma_f32 v[148:149], v[186:187], v[186:187], v[148:149]
    v_pk_fma_f32 v[148:149], v[188:189], v[188:189], v[148:149]
    v_pk_fma_f32 v[148:149], v[190:191], v[190:191], v[148:149]
    v_pk_fma_f32 v[148:149], v[192:193], v[192:193], v[148:149]
    v_pk_fma_f32 v[148:149], v[194:195], v[194:195], v[148:149]
    v_pk_fma_f32 v[148:149], v[196:197], v[196:197], v[148:149]
    v_pk_fma_f32 v[148:149], v[198:199], v[198:199], v[148:149]
    v_add_f32_e64 v148, v148, v149
    v_pk_mul_f32 v[172:173], v[172:173], v[228:229]
    v_pk_mul_f32 v[174:175], v[174:175], v[230:231]
    v_add_f32_dpp v148, v148, v148 row_ror:8 row_mask:0xf bank_mask:0xf
    v_pk_mul_f32 v[176:177], v[176:177], v[232:233]
    buffer_load_dwordx4 v[94:97], v0, s[16:19], s55 offen offset:512 nt
    v_pk_mul_f32 v[178:179], v[178:179], v[234:235]
    v_add_f32_dpp v148, v148, v148 row_ror:4 row_mask:0xf bank_mask:0xf
    v_pk_mul_f32 v[180:181], v[180:181], v[236:237]
    v_pk_mul_f32 v[182:183], v[182:183], v[238:239]
    v_add_f32_dpp v148, v148, v148 row_ror:2 row_mask:0xf bank_mask:0xf
    v_pk_mul_f32 v[184:185], v[184:185], v[240:241]
    v_pk_mul_f32 v[186:187], v[186:187], v[242:243]
    v_add_f32_dpp v148, v148, v148 row_ror:1 row_mask:0xf bank_mask:0xf
    v_fma_f32 v148, v148, s44, v16
    v_rsq_f32_e64 v150, v148
    v_pk_mul_f32 v[188:189], v[188:189], v[244:245]
    v_pk_mul_f32 v[190:191], v[190:191], v[246:247]
    v_pk_mul_f32 v[192:193], v[192:193], v[248:249]
    v_pk_mul_f32 v[194:195], v[194:195], v[250:251]
    v_pk_mul_f32 v[196:197], v[196:197], v[252:253]
    v_pk_mul_f32 v[198:199], v[198:199], v[254:255]
    v_pk_fma_f32 v[172:173], v[172:173], v[150:151], v[200:201] op_sel_hi:[1,0,1]
    v_pk_fma_f32 v[174:175], v[174:175], v[150:151], v[202:203] op_sel_hi:[1,0,1]
    v_pk_fma_f32 v[176:177], v[176:177], v[150:151], v[204:205] op_sel_hi:[1,0,1]
    v_pk_fma_f32 v[178:179], v[178:179], v[150:151], v[206:207] op_sel_hi:[1,0,1]
    v_cvt_pk_bf16_f32 v172, v172, v173
    v_cvt_pk_bf16_f32 v173, v174, v175
    v_cvt_pk_bf16_f32 v174, v176, v177
    buffer_load_dwordx2 v[98:99], v1, s[16:19], s55 offen nt
    v_cvt_pk_bf16_f32 v175, v178, v179
    ds_write_b128 v14, v[172:175] offset:28672
    v_pk_fma_f32 v[180:181], v[180:181], v[150:151], v[208:209] op_sel_hi:[1,0,1]
    v_pk_fma_f32 v[182:183], v[182:183], v[150:151], v[210:211] op_sel_hi:[1,0,1]
    v_pk_fma_f32 v[184:185], v[184:185], v[150:151], v[212:213] op_sel_hi:[1,0,1]
    v_pk_fma_f32 v[186:187], v[186:187], v[150:151], v[214:215] op_sel_hi:[1,0,1]
    v_cvt_pk_bf16_f32 v180, v180, v181
    v_cvt_pk_bf16_f32 v181, v182, v183
    v_cvt_pk_bf16_f32 v182, v184, v185
    v_cvt_pk_bf16_f32 v183, v186, v187
    ds_write_b128 v14, v[180:183] offset:32768
    v_pk_fma_f32 v[188:189], v[188:189], v[150:151], v[216:217] op_sel_hi:[1,0,1]
    v_pk_fma_f32 v[190:191], v[190:191], v[150:151], v[218:219] op_sel_hi:[1,0,1]
    v_pk_fma_f32 v[192:193], v[192:193], v[150:151], v[220:221] op_sel_hi:[1,0,1]
    v_pk_fma_f32 v[194:195], v[194:195], v[150:151], v[222:223] op_sel_hi:[1,0,1]
    s_waitcnt vmcnt(9)
    s_nop 0
    v_dot2_f32_bf16 v17, v106, s43, 0
    v_dot2_f32_bf16 v17, v107, s43, v17
    v_dot2_f32_bf16 v17, v108, s43, v17
    v_dot2_f32_bf16 v17, v109, s43, v17
    v_dot2_f32_bf16 v17, v110, s43, v17
    v_dot2_f32_bf16 v17, v111, s43, v17
    v_dot2_f32_bf16 v17, v112, s43, v17
    v_dot2_f32_bf16 v17, v113, s43, v17
    v_dot2_f32_bf16 v17, v114, s43, v17
    v_dot2_f32_bf16 v17, v115, s43, v17
    v_dot2_f32_bf16 v17, v116, s43, v17
    v_dot2_f32_bf16 v17, v117, s43, v17
    v_dot2_f32_bf16 v17, v118, s43, v17
    v_dot2_f32_bf16 v17, v119, s43, v17
    v_cvt_pk_bf16_f32 v188, v188, v189
    v_cvt_pk_bf16_f32 v189, v190, v191
    v_cvt_pk_bf16_f32 v190, v192, v193
    v_add_f32_dpp v17, v17, v17 row_ror:8 row_mask:0xf bank_mask:0xf
    v_cvt_pk_bf16_f32 v191, v194, v195
    ds_write_b128 v14, v[188:191] offset:36864
    v_add_f32_dpp v17, v17, v17 row_ror:4 row_mask:0xf bank_mask:0xf
    v_pk_fma_f32 v[196:197], v[196:197], v[150:151], v[224:225] op_sel_hi:[1,0,1]
    v_pk_fma_f32 v[198:199], v[198:199], v[150:151], v[226:227] op_sel_hi:[1,0,1]
    v_add_f32_dpp v17, v17, v17 row_ror:2 row_mask:0xf bank_mask:0xf
    v_cvt_pk_bf16_f32 v196, v196, v197
    v_cvt_pk_bf16_f32 v197, v198, v199
    v_add_f32_dpp v17, v17, v17 row_ror:1 row_mask:0xf bank_mask:0xf
    ds_write_b64 v15, v[196:197] offset:28672
    v_mul_f32_e64 v17, s44, v17
    v_dot2_f32_bf16 v172, v106, s41, v17 neg_lo:[0,0,1]
    v_dot2_f32_bf16 v173, v106, s42, v17 neg_lo:[0,0,1]
    buffer_load_dwordx4 v[120:123], v0, s[16:19], s56 offen offset:0 nt
    v_dot2_f32_bf16 v174, v107, s41, v17 neg_lo:[0,0,1]
    v_dot2_f32_bf16 v175, v107, s42, v17 neg_lo:[0,0,1]
    v_dot2_f32_bf16 v176, v108, s41, v17 neg_lo:[0,0,1]
    v_dot2_f32_bf16 v177, v108, s42, v17 neg_lo:[0,0,1]
    v_dot2_f32_bf16 v178, v109, s41, v17 neg_lo:[0,0,1]
    v_dot2_f32_bf16 v179, v109, s42, v17 neg_lo:[0,0,1]
    v_dot2_f32_bf16 v180, v110, s41, v17 neg_lo:[0,0,1]
    v_dot2_f32_bf16 v181, v110, s42, v17 neg_lo:[0,0,1]
    v_dot2_f32_bf16 v182, v111, s41, v17 neg_lo:[0,0,1]
    v_dot2_f32_bf16 v183, v111, s42, v17 neg_lo:[0,0,1]
    v_dot2_f32_bf16 v184, v112, s41, v17 neg_lo:[0,0,1]
    v_dot2_f32_bf16 v185, v112, s42, v17 neg_lo:[0,0,1]
    v_dot2_f32_bf16 v186, v113, s41, v17 neg_lo:[0,0,1]
    v_dot2_f32_bf16 v187, v113, s42, v17 neg_lo:[0,0,1]
    buffer_load_dwordx4 v[124:127], v0, s[16:19], s56 offen offset:256 nt
    v_dot2_f32_bf16 v188, v114, s41, v17 neg_lo:[0,0,1]
    v_dot2_f32_bf16 v189, v114, s42, v17 neg_lo:[0,0,1]
    v_dot2_f32_bf16 v190, v115, s41, v17 neg_lo:[0,0,1]
    v_dot2_f32_bf16 v191, v115, s42, v17 neg_lo:[0,0,1]
    v_dot2_f32_bf16 v192, v116, s41, v17 neg_lo:[0,0,1]
    v_dot2_f32_bf16 v193, v116, s42, v17 neg_lo:[0,0,1]
    v_dot2_f32_bf16 v194, v117, s41, v17 neg_lo:[0,0,1]
    v_dot2_f32_bf16 v195, v117, s42, v17 neg_lo:[0,0,1]
    v_dot2_f32_bf16 v196, v118, s41, v17 neg_lo:[0,0,1]
    v_dot2_f32_bf16 v197, v118, s42, v17 neg_lo:[0,0,1]
    v_dot2_f32_bf16 v198, v119, s41, v17 neg_lo:[0,0,1]
    v_dot2_f32_bf16 v199, v119, s42, v17 neg_lo:[0,0,1]
    v_pk_mul_f32 v[106:107], v[172:173], v[172:173]
    v_pk_fma_f32 v[106:107], v[174:175], v[174:175], v[106:107]
    buffer_load_dwordx4 v[128:131], v0, s[16:19], s56 offen offset:512 nt
    v_pk_fma_f32 v[106:107], v[176:177], v[176:177], v[106:107]
    v_pk_fma_f32 v[106:107], v[178:179], v[178:179], v[106:107]
    v_pk_fma_f32 v[106:107], v[180:181], v[180:181], v[106:107]
    v_pk_fma_f32 v[106:107], v[182:183], v[182:183], v[106:107]
    v_pk_fma_f32 v[106:107], v[184:185], v[184:185], v[106:107]
    v_pk_fma_f32 v[106:107], v[186:187], v[186:187], v[106:107]
    v_pk_fma_f32 v[106:107], v[188:189], v[188:189], v[106:107]
    v_pk_fma_f32 v[106:107], v[190:191], v[190:191], v[106:107]
    v_pk_fma_f32 v[106:107], v[192:193], v[192:193], v[106:107]
    v_pk_fma_f32 v[106:107], v[194:195], v[194:195], v[106:107]
    v_pk_fma_f32 v[106:107], v[196:197], v[196:197], v[106:107]
    v_pk_fma_f32 v[106:107], v[198:199], v[198:199], v[106:107]
    v_add_f32_e64 v106, v106, v107
    v_pk_mul_f32 v[172:173], v[172:173], v[228:229]
    v_pk_mul_f32 v[174:175], v[174:175], v[230:231]
    buffer_load_dwordx2 v[132:133], v1, s[16:19], s56 offen nt
    v_add_f32_dpp v106, v106, v106 row_ror:8 row_mask:0xf bank_mask:0xf
    v_pk_mul_f32 v[176:177], v[176:177], v[232:233]
    v_pk_mul_f32 v[178:179], v[178:179], v[234:235]
    v_add_f32_dpp v106, v106, v106 row_ror:4 row_mask:0xf bank_mask:0xf
    v_pk_mul_f32 v[180:181], v[180:181], v[236:237]
    v_pk_mul_f32 v[182:183], v[182:183], v[238:239]
    v_add_f32_dpp v106, v106, v106 row_ror:2 row_mask:0xf bank_mask:0xf
    v_pk_mul_f32 v[184:185], v[184:185], v[240:241]
    v_pk_mul_f32 v[186:187], v[186:187], v[242:243]
    v_add_f32_dpp v106, v106, v106 row_ror:1 row_mask:0xf bank_mask:0xf
    v_fma_f32 v106, v106, s44, v16
    v_rsq_f32_e64 v108, v106
    v_pk_mul_f32 v[188:189], v[188:189], v[244:245]
    v_pk_mul_f32 v[190:191], v[190:191], v[246:247]
    v_pk_mul_f32 v[192:193], v[192:193], v[248:249]
    v_pk_mul_f32 v[194:195], v[194:195], v[250:251]
    v_pk_mul_f32 v[196:197], v[196:197], v[252:253]
    v_pk_mul_f32 v[198:199], v[198:199], v[254:255]
    v_pk_fma_f32 v[172:173], v[172:173], v[108:109], v[200:201] op_sel_hi:[1,0,1]
    v_pk_fma_f32 v[174:175], v[174:175], v[108:109], v[202:203] op_sel_hi:[1,0,1]
    v_pk_fma_f32 v[176:177], v[176:177], v[108:109], v[204:205] op_sel_hi:[1,0,1]
    v_pk_fma_f32 v[178:179], v[178:179], v[108:109], v[206:207] op_sel_hi:[1,0,1]
    v_cvt_pk_bf16_f32 v172, v172, v173
    v_cvt_pk_bf16_f32 v173, v174, v175
    v_cvt_pk_bf16_f32 v174, v176, v177
    v_cvt_pk_bf16_f32 v175, v178, v179
    ds_write_b128 v14, v[172:175] offset:43008
    v_pk_fma_f32 v[180:181], v[180:181], v[108:109], v[208:209] op_sel_hi:[1,0,1]
    v_pk_fma_f32 v[182:183], v[182:183], v[108:109], v[210:211] op_sel_hi:[1,0,1]
    v_pk_fma_f32 v[184:185], v[184:185], v[108:109], v[212:213] op_sel_hi:[1,0,1]
    v_pk_fma_f32 v[186:187], v[186:187], v[108:109], v[214:215] op_sel_hi:[1,0,1]
    v_cvt_pk_bf16_f32 v180, v180, v181
    v_cvt_pk_bf16_f32 v181, v182, v183
    v_cvt_pk_bf16_f32 v182, v184, v185
    v_cvt_pk_bf16_f32 v183, v186, v187
    ds_write_b128 v14, v[180:183] offset:47104
    v_pk_fma_f32 v[188:189], v[188:189], v[108:109], v[216:217] op_sel_hi:[1,0,1]
    v_pk_fma_f32 v[190:191], v[190:191], v[108:109], v[218:219] op_sel_hi:[1,0,1]
    v_pk_fma_f32 v[192:193], v[192:193], v[108:109], v[220:221] op_sel_hi:[1,0,1]
    v_pk_fma_f32 v[194:195], v[194:195], v[108:109], v[222:223] op_sel_hi:[1,0,1]
    v_cvt_pk_bf16_f32 v188, v188, v189
    v_cvt_pk_bf16_f32 v189, v190, v191
    s_waitcnt vmcnt(9)
    s_nop 0
    v_dot2_f32_bf16 v17, v72, s43, 0
    v_dot2_f32_bf16 v17, v73, s43, v17
    v_dot2_f32_bf16 v17, v74, s43, v17
    v_dot2_f32_bf16 v17, v75, s43, v17
    v_dot2_f32_bf16 v17, v76, s43, v17
    v_dot2_f32_bf16 v17, v77, s43, v17
    v_dot2_f32_bf16 v17, v78, s43, v17
    v_dot2_f32_bf16 v17, v79, s43, v17
    v_dot2_f32_bf16 v17, v80, s43, v17
    v_dot2_f32_bf16 v17, v81, s43, v17
    v_dot2_f32_bf16 v17, v82, s43, v17
    v_dot2_f32_bf16 v17, v83, s43, v17
    v_dot2_f32_bf16 v17, v84, s43, v17
    v_dot2_f32_bf16 v17, v85, s43, v17
    v_cvt_pk_bf16_f32 v190, v192, v193
    v_cvt_pk_bf16_f32 v191, v194, v195
    ds_write_b128 v14, v[188:191] offset:51200
    v_add_f32_dpp v17, v17, v17 row_ror:8 row_mask:0xf bank_mask:0xf
    v_pk_fma_f32 v[196:197], v[196:197], v[108:109], v[224:225] op_sel_hi:[1,0,1]
    v_pk_fma_f32 v[198:199], v[198:199], v[108:109], v[226:227] op_sel_hi:[1,0,1]
    v_add_f32_dpp v17, v17, v17 row_ror:4 row_mask:0xf bank_mask:0xf
    v_cvt_pk_bf16_f32 v196, v196, v197
    v_cvt_pk_bf16_f32 v197, v198, v199
    v_add_f32_dpp v17, v17, v17 row_ror:2 row_mask:0xf bank_mask:0xf
    ds_write_b64 v15, v[196:197] offset:43008
    v_add_u32 v14, 57344, v14
    v_add_f32_dpp v17, v17, v17 row_ror:1 row_mask:0xf bank_mask:0xf
    v_add_u32 v15, 57344, v15
    v_mul_f32 v17, s44, v17
    s_waitcnt lgkmcnt(0)
    s_barrier
    s_nop 0
    v_dot2_f32_bf16 v172, v72, s41, v17 neg_lo:[0,0,1]
    v_dot2_f32_bf16 v173, v72, s42, v17 neg_lo:[0,0,1]
    buffer_load_dwordx4 v[134:137], v0, s[16:19], s57 offen offset:0 nt
    v_dot2_f32_bf16 v174, v73, s41, v17 neg_lo:[0,0,1]
    v_dot2_f32_bf16 v175, v73, s42, v17 neg_lo:[0,0,1]
    v_dot2_f32_bf16 v176, v74, s41, v17 neg_lo:[0,0,1]
    v_dot2_f32_bf16 v177, v74, s42, v17 neg_lo:[0,0,1]
    v_dot2_f32_bf16 v178, v75, s41, v17 neg_lo:[0,0,1]
    v_dot2_f32_bf16 v179, v75, s42, v17 neg_lo:[0,0,1]
    v_dot2_f32_bf16 v180, v76, s41, v17 neg_lo:[0,0,1]
    v_dot2_f32_bf16 v181, v76, s42, v17 neg_lo:[0,0,1]
    v_dot2_f32_bf16 v182, v77, s41, v17 neg_lo:[0,0,1]
    v_dot2_f32_bf16 v183, v77, s42, v17 neg_lo:[0,0,1]
    v_dot2_f32_bf16 v184, v78, s41, v17 neg_lo:[0,0,1]
    v_dot2_f32_bf16 v185, v78, s42, v17 neg_lo:[0,0,1]
    v_dot2_f32_bf16 v186, v79, s41, v17 neg_lo:[0,0,1]
    v_dot2_f32_bf16 v187, v79, s42, v17 neg_lo:[0,0,1]
    buffer_load_dwordx4 v[138:141], v0, s[16:19], s57 offen offset:256 nt
    v_dot2_f32_bf16 v188, v80, s41, v17 neg_lo:[0,0,1]
    v_dot2_f32_bf16 v189, v80, s42, v17 neg_lo:[0,0,1]
    v_dot2_f32_bf16 v190, v81, s41, v17 neg_lo:[0,0,1]
    v_dot2_f32_bf16 v191, v81, s42, v17 neg_lo:[0,0,1]
    v_dot2_f32_bf16 v192, v82, s41, v17 neg_lo:[0,0,1]
    v_dot2_f32_bf16 v193, v82, s42, v17 neg_lo:[0,0,1]
    v_dot2_f32_bf16 v194, v83, s41, v17 neg_lo:[0,0,1]
    v_dot2_f32_bf16 v195, v83, s42, v17 neg_lo:[0,0,1]
    v_dot2_f32_bf16 v196, v84, s41, v17 neg_lo:[0,0,1]
    v_dot2_f32_bf16 v197, v84, s42, v17 neg_lo:[0,0,1]
    v_dot2_f32_bf16 v198, v85, s41, v17 neg_lo:[0,0,1]
    v_dot2_f32_bf16 v199, v85, s42, v17 neg_lo:[0,0,1]
    v_pk_mul_f32 v[72:73], v[172:173], v[172:173]
    v_pk_fma_f32 v[72:73], v[174:175], v[174:175], v[72:73]
    buffer_load_dwordx4 v[142:145], v0, s[16:19], s57 offen offset:512 nt
    v_pk_fma_f32 v[72:73], v[176:177], v[176:177], v[72:73]
    v_pk_fma_f32 v[72:73], v[178:179], v[178:179], v[72:73]
    v_pk_fma_f32 v[72:73], v[180:181], v[180:181], v[72:73]
    v_pk_fma_f32 v[72:73], v[182:183], v[182:183], v[72:73]
    v_pk_fma_f32 v[72:73], v[184:185], v[184:185], v[72:73]
    v_pk_fma_f32 v[72:73], v[186:187], v[186:187], v[72:73]
    v_pk_fma_f32 v[72:73], v[188:189], v[188:189], v[72:73]
    v_pk_fma_f32 v[72:73], v[190:191], v[190:191], v[72:73]
    v_pk_fma_f32 v[72:73], v[192:193], v[192:193], v[72:73]
    v_pk_fma_f32 v[72:73], v[194:195], v[194:195], v[72:73]
    v_pk_fma_f32 v[72:73], v[196:197], v[196:197], v[72:73]
    v_pk_fma_f32 v[72:73], v[198:199], v[198:199], v[72:73]
    v_add_f32_e64 v72, v72, v73
    v_pk_mul_f32 v[172:173], v[172:173], v[228:229]
    v_pk_mul_f32 v[174:175], v[174:175], v[230:231]
    buffer_load_dwordx2 v[146:147], v1, s[16:19], s57 offen nt
    v_add_f32_dpp v72, v72, v72 row_ror:8 row_mask:0xf bank_mask:0xf
    v_pk_mul_f32 v[176:177], v[176:177], v[232:233]
    v_pk_mul_f32 v[178:179], v[178:179], v[234:235]
    v_add_f32_dpp v72, v72, v72 row_ror:4 row_mask:0xf bank_mask:0xf
    v_pk_mul_f32 v[180:181], v[180:181], v[236:237]
    v_pk_mul_f32 v[182:183], v[182:183], v[238:239]
    v_add_f32_dpp v72, v72, v72 row_ror:2 row_mask:0xf bank_mask:0xf
    v_pk_mul_f32 v[184:185], v[184:185], v[240:241]
    v_pk_mul_f32 v[186:187], v[186:187], v[242:243]
    v_add_f32_dpp v72, v72, v72 row_ror:1 row_mask:0xf bank_mask:0xf
    v_fma_f32 v72, v72, s44, v16
    v_rsq_f32_e64 v74, v72
    v_pk_mul_f32 v[188:189], v[188:189], v[244:245]
    v_pk_mul_f32 v[190:191], v[190:191], v[246:247]
    v_pk_mul_f32 v[192:193], v[192:193], v[248:249]
    v_pk_mul_f32 v[194:195], v[194:195], v[250:251]
    v_pk_mul_f32 v[196:197], v[196:197], v[252:253]
    v_pk_mul_f32 v[198:199], v[198:199], v[254:255]
    v_pk_fma_f32 v[172:173], v[172:173], v[74:75], v[200:201] op_sel_hi:[1,0,1]
    v_pk_fma_f32 v[174:175], v[174:175], v[74:75], v[202:203] op_sel_hi:[1,0,1]
    v_pk_fma_f32 v[176:177], v[176:177], v[74:75], v[204:205] op_sel_hi:[1,0,1]
    v_pk_fma_f32 v[178:179], v[178:179], v[74:75], v[206:207] op_sel_hi:[1,0,1]
    v_cvt_pk_bf16_f32 v172, v172, v173
    v_cvt_pk_bf16_f32 v173, v174, v175
    v_cvt_pk_bf16_f32 v174, v176, v177
    v_cvt_pk_bf16_f32 v175, v178, v179
    ds_write_b128 v14, v[172:175] offset:0
    v_pk_fma_f32 v[180:181], v[180:181], v[74:75], v[208:209] op_sel_hi:[1,0,1]
    v_pk_fma_f32 v[182:183], v[182:183], v[74:75], v[210:211] op_sel_hi:[1,0,1]
    v_pk_fma_f32 v[184:185], v[184:185], v[74:75], v[212:213] op_sel_hi:[1,0,1]
    v_pk_fma_f32 v[186:187], v[186:187], v[74:75], v[214:215] op_sel_hi:[1,0,1]
    v_cvt_pk_bf16_f32 v180, v180, v181
    v_cvt_pk_bf16_f32 v181, v182, v183
    v_cvt_pk_bf16_f32 v182, v184, v185
    v_cvt_pk_bf16_f32 v183, v186, v187
    ds_write_b128 v14, v[180:183] offset:4096
    v_pk_fma_f32 v[188:189], v[188:189], v[74:75], v[216:217] op_sel_hi:[1,0,1]
    v_pk_fma_f32 v[190:191], v[190:191], v[74:75], v[218:219] op_sel_hi:[1,0,1]
    v_pk_fma_f32 v[192:193], v[192:193], v[74:75], v[220:221] op_sel_hi:[1,0,1]
    v_pk_fma_f32 v[194:195], v[194:195], v[74:75], v[222:223] op_sel_hi:[1,0,1]
    s_waitcnt vmcnt(8)
    s_nop 0
    v_dot2_f32_bf16 v17, v86, s43, 0
    v_dot2_f32_bf16 v17, v87, s43, v17
    v_dot2_f32_bf16 v17, v88, s43, v17
    v_dot2_f32_bf16 v17, v89, s43, v17
    v_dot2_f32_bf16 v17, v90, s43, v17
    v_dot2_f32_bf16 v17, v91, s43, v17
    v_dot2_f32_bf16 v17, v92, s43, v17
    v_dot2_f32_bf16 v17, v93, s43, v17
    v_dot2_f32_bf16 v17, v94, s43, v17
    v_dot2_f32_bf16 v17, v95, s43, v17
    v_dot2_f32_bf16 v17, v96, s43, v17
    v_dot2_f32_bf16 v17, v97, s43, v17
    v_dot2_f32_bf16 v17, v98, s43, v17
    v_dot2_f32_bf16 v17, v99, s43, v17
    v_cvt_pk_bf16_f32 v188, v188, v189
    v_cvt_pk_bf16_f32 v189, v190, v191
    v_cvt_pk_bf16_f32 v190, v192, v193
    v_add_f32_dpp v17, v17, v17 row_ror:8 row_mask:0xf bank_mask:0xf
    v_cvt_pk_bf16_f32 v191, v194, v195
    ds_write_b128 v14, v[188:191] offset:8192
    v_add_f32_dpp v17, v17, v17 row_ror:4 row_mask:0xf bank_mask:0xf
    v_pk_fma_f32 v[196:197], v[196:197], v[74:75], v[224:225] op_sel_hi:[1,0,1]
    v_pk_fma_f32 v[198:199], v[198:199], v[74:75], v[226:227] op_sel_hi:[1,0,1]
    v_add_f32_dpp v17, v17, v17 row_ror:2 row_mask:0xf bank_mask:0xf
    v_cvt_pk_bf16_f32 v196, v196, v197
    v_cvt_pk_bf16_f32 v197, v198, v199
    v_add_f32_dpp v17, v17, v17 row_ror:1 row_mask:0xf bank_mask:0xf
    ds_write_b64 v15, v[196:197] offset:0
    v_mul_f32_e64 v17, s44, v17
    v_dot2_f32_bf16 v172, v86, s41, v17 neg_lo:[0,0,1]
    v_dot2_f32_bf16 v173, v86, s42, v17 neg_lo:[0,0,1]
    v_dot2_f32_bf16 v174, v87, s41, v17 neg_lo:[0,0,1]
    v_dot2_f32_bf16 v175, v87, s42, v17 neg_lo:[0,0,1]
    v_dot2_f32_bf16 v176, v88, s41, v17 neg_lo:[0,0,1]
    v_dot2_f32_bf16 v177, v88, s42, v17 neg_lo:[0,0,1]
    v_dot2_f32_bf16 v178, v89, s41, v17 neg_lo:[0,0,1]
    v_dot2_f32_bf16 v179, v89, s42, v17 neg_lo:[0,0,1]
    v_dot2_f32_bf16 v180, v90, s41, v17 neg_lo:[0,0,1]
    v_dot2_f32_bf16 v181, v90, s42, v17 neg_lo:[0,0,1]
    v_dot2_f32_bf16 v182, v91, s41, v17 neg_lo:[0,0,1]
    v_dot2_f32_bf16 v183, v91, s42, v17 neg_lo:[0,0,1]
    v_dot2_f32_bf16 v184, v92, s41, v17 neg_lo:[0,0,1]
    v_dot2_f32_bf16 v185, v92, s42, v17 neg_lo:[0,0,1]
    v_dot2_f32_bf16 v186, v93, s41, v17 neg_lo:[0,0,1]
    v_dot2_f32_bf16 v187, v93, s42, v17 neg_lo:[0,0,1]
    v_dot2_f32_bf16 v188, v94, s41, v17 neg_lo:[0,0,1]
    v_dot2_f32_bf16 v189, v94, s42, v17 neg_lo:[0,0,1]
    v_dot2_f32_bf16 v190, v95, s41, v17 neg_lo:[0,0,1]
    v_dot2_f32_bf16 v191, v95, s42, v17 neg_lo:[0,0,1]
    v_dot2_f32_bf16 v192, v96, s41, v17 neg_lo:[0,0,1]
    v_dot2_f32_bf16 v193, v96, s42, v17 neg_lo:[0,0,1]
    v_dot2_f32_bf16 v194, v97, s41, v17 neg_lo:[0,0,1]
    v_dot2_f32_bf16 v195, v97, s42, v17 neg_lo:[0,0,1]
    v_dot2_f32_bf16 v196, v98, s41, v17 neg_lo:[0,0,1]
    v_dot2_f32_bf16 v197, v98, s42, v17 neg_lo:[0,0,1]
    v_dot2_f32_bf16 v198, v99, s41, v17 neg_lo:[0,0,1]
    v_dot2_f32_bf16 v199, v99, s42, v17 neg_lo:[0,0,1]
    v_pk_mul_f32 v[86:87], v[172:173], v[172:173]
    v_pk_fma_f32 v[86:87], v[174:175], v[174:175], v[86:87]
    v_pk_fma_f32 v[86:87], v[176:177], v[176:177], v[86:87]
    v_pk_fma_f32 v[86:87], v[178:179], v[178:179], v[86:87]
    v_pk_fma_f32 v[86:87], v[180:181], v[180:181], v[86:87]
    v_pk_fma_f32 v[86:87], v[182:183], v[182:183], v[86:87]
    v_pk_fma_f32 v[86:87], v[184:185], v[184:185], v[86:87]
    v_pk_fma_f32 v[86:87], v[186:187], v[186:187], v[86:87]
    v_pk_fma_f32 v[86:87], v[188:189], v[188:189], v[86:87]
    v_pk_fma_f32 v[86:87], v[190:191], v[190:191], v[86:87]
    v_pk_fma_f32 v[86:87], v[192:193], v[192:193], v[86:87]
    v_pk_fma_f32 v[86:87], v[194:195], v[194:195], v[86:87]
    v_pk_fma_f32 v[86:87], v[196:197], v[196:197], v[86:87]
    v_pk_fma_f32 v[86:87], v[198:199], v[198:199], v[86:87]
    v_add_f32_e64 v86, v86, v87
    v_pk_mul_f32 v[172:173], v[172:173], v[228:229]
    v_pk_mul_f32 v[174:175], v[174:175], v[230:231]
    v_add_f32_dpp v86, v86, v86 row_ror:8 row_mask:0xf bank_mask:0xf
    v_pk_mul_f32 v[176:177], v[176:177], v[232:233]
    v_pk_mul_f32 v[178:179], v[178:179], v[234:235]
    v_add_f32_dpp v86, v86, v86 row_ror:4 row_mask:0xf bank_mask:0xf
    v_pk_mul_f32 v[180:181], v[180:181], v[236:237]
    v_pk_mul_f32 v[182:183], v[182:183], v[238:239]
    v_add_f32_dpp v86, v86, v86 row_ror:2 row_mask:0xf bank_mask:0xf
    v_pk_mul_f32 v[184:185], v[184:185], v[240:241]
    v_pk_mul_f32 v[186:187], v[186:187], v[242:243]
    v_add_f32_dpp v86, v86, v86 row_ror:1 row_mask:0xf bank_mask:0xf
    v_fma_f32 v86, v86, s44, v16
    v_rsq_f32_e64 v88, v86
    v_pk_mul_f32 v[188:189], v[188:189], v[244:245]
    v_pk_mul_f32 v[190:191], v[190:191], v[246:247]
    v_pk_mul_f32 v[192:193], v[192:193], v[248:249]
    v_pk_mul_f32 v[194:195], v[194:195], v[250:251]
    v_pk_mul_f32 v[196:197], v[196:197], v[252:253]
    v_pk_mul_f32 v[198:199], v[198:199], v[254:255]
    v_pk_fma_f32 v[172:173], v[172:173], v[88:89], v[200:201] op_sel_hi:[1,0,1]
    v_pk_fma_f32 v[174:175], v[174:175], v[88:89], v[202:203] op_sel_hi:[1,0,1]
    v_pk_fma_f32 v[176:177], v[176:177], v[88:89], v[204:205] op_sel_hi:[1,0,1]
    v_pk_fma_f32 v[178:179], v[178:179], v[88:89], v[206:207] op_sel_hi:[1,0,1]
    v_cvt_pk_bf16_f32 v172, v172, v173
    v_cvt_pk_bf16_f32 v173, v174, v175
    v_cvt_pk_bf16_f32 v174, v176, v177
    v_cvt_pk_bf16_f32 v175, v178, v179
    ds_write_b128 v14, v[172:175] offset:14336
    v_pk_fma_f32 v[180:181], v[180:181], v[88:89], v[208:209] op_sel_hi:[1,0,1]
    v_pk_fma_f32 v[182:183], v[182:183], v[88:89], v[210:211] op_sel_hi:[1,0,1]
    v_pk_fma_f32 v[184:185], v[184:185], v[88:89], v[212:213] op_sel_hi:[1,0,1]
    v_pk_fma_f32 v[186:187], v[186:187], v[88:89], v[214:215] op_sel_hi:[1,0,1]
    v_cvt_pk_bf16_f32 v180, v180, v181
    v_cvt_pk_bf16_f32 v181, v182, v183
    v_cvt_pk_bf16_f32 v182, v184, v185
    v_cvt_pk_bf16_f32 v183, v186, v187
    ds_write_b128 v14, v[180:183] offset:18432
    v_pk_fma_f32 v[188:189], v[188:189], v[88:89], v[216:217] op_sel_hi:[1,0,1]
    v_pk_fma_f32 v[190:191], v[190:191], v[88:89], v[218:219] op_sel_hi:[1,0,1]
    v_pk_fma_f32 v[192:193], v[192:193], v[88:89], v[220:221] op_sel_hi:[1,0,1]
    v_pk_fma_f32 v[194:195], v[194:195], v[88:89], v[222:223] op_sel_hi:[1,0,1]
    s_waitcnt vmcnt(4)
    s_nop 0
    v_dot2_f32_bf16 v17, v120, s43, 0
    v_dot2_f32_bf16 v17, v121, s43, v17
    v_dot2_f32_bf16 v17, v122, s43, v17
    v_dot2_f32_bf16 v17, v123, s43, v17
    v_dot2_f32_bf16 v17, v124, s43, v17
    v_dot2_f32_bf16 v17, v125, s43, v17
    v_dot2_f32_bf16 v17, v126, s43, v17
    v_dot2_f32_bf16 v17, v127, s43, v17
    v_dot2_f32_bf16 v17, v128, s43, v17
    v_dot2_f32_bf16 v17, v129, s43, v17
    v_dot2_f32_bf16 v17, v130, s43, v17
    v_dot2_f32_bf16 v17, v131, s43, v17
    v_dot2_f32_bf16 v17, v132, s43, v17
    v_dot2_f32_bf16 v17, v133, s43, v17
    v_cvt_pk_bf16_f32 v188, v188, v189
    v_cvt_pk_bf16_f32 v189, v190, v191
    v_cvt_pk_bf16_f32 v190, v192, v193
    v_add_f32_dpp v17, v17, v17 row_ror:8 row_mask:0xf bank_mask:0xf
    v_cvt_pk_bf16_f32 v191, v194, v195
    ds_write_b128 v14, v[188:191] offset:22528
    v_add_f32_dpp v17, v17, v17 row_ror:4 row_mask:0xf bank_mask:0xf
    v_pk_fma_f32 v[196:197], v[196:197], v[88:89], v[224:225] op_sel_hi:[1,0,1]
    v_pk_fma_f32 v[198:199], v[198:199], v[88:89], v[226:227] op_sel_hi:[1,0,1]
    v_add_f32_dpp v17, v17, v17 row_ror:2 row_mask:0xf bank_mask:0xf
    v_cvt_pk_bf16_f32 v196, v196, v197
    v_cvt_pk_bf16_f32 v197, v198, v199
    v_add_f32_dpp v17, v17, v17 row_ror:1 row_mask:0xf bank_mask:0xf
    ds_write_b64 v15, v[196:197] offset:14336
    v_mul_f32_e64 v17, s44, v17
    ds_read_b128 v[32:35], v6 offset:28672
    ds_read_b128 v[36:39], v7 offset:29696
    ds_read_b128 v[40:43], v6 offset:0
    ds_read_b128 v[44:47], v7 offset:1024
    v_dot2_f32_bf16 v172, v120, s41, v17 neg_lo:[0,0,1]
    v_dot2_f32_bf16 v173, v120, s42, v17 neg_lo:[0,0,1]
    v_dot2_f32_bf16 v174, v121, s41, v17 neg_lo:[0,0,1]
    v_dot2_f32_bf16 v175, v121, s42, v17 neg_lo:[0,0,1]
    v_dot2_f32_bf16 v176, v122, s41, v17 neg_lo:[0,0,1]
    v_dot2_f32_bf16 v177, v122, s42, v17 neg_lo:[0,0,1]
    v_dot2_f32_bf16 v178, v123, s41, v17 neg_lo:[0,0,1]
    v_dot2_f32_bf16 v179, v123, s42, v17 neg_lo:[0,0,1]
    v_dot2_f32_bf16 v180, v124, s41, v17 neg_lo:[0,0,1]
    v_dot2_f32_bf16 v181, v124, s42, v17 neg_lo:[0,0,1]
    v_dot2_f32_bf16 v182, v125, s41, v17 neg_lo:[0,0,1]
    v_dot2_f32_bf16 v183, v125, s42, v17 neg_lo:[0,0,1]
    v_dot2_f32_bf16 v184, v126, s41, v17 neg_lo:[0,0,1]
    v_dot2_f32_bf16 v185, v126, s42, v17 neg_lo:[0,0,1]
    v_dot2_f32_bf16 v186, v127, s41, v17 neg_lo:[0,0,1]
    v_dot2_f32_bf16 v187, v127, s42, v17 neg_lo:[0,0,1]
    v_dot2_f32_bf16 v188, v128, s41, v17 neg_lo:[0,0,1]
    v_dot2_f32_bf16 v189, v128, s42, v17 neg_lo:[0,0,1]
    v_dot2_f32_bf16 v190, v129, s41, v17 neg_lo:[0,0,1]
    v_dot2_f32_bf16 v191, v129, s42, v17 neg_lo:[0,0,1]
    v_dot2_f32_bf16 v192, v130, s41, v17 neg_lo:[0,0,1]
    v_dot2_f32_bf16 v193, v130, s42, v17 neg_lo:[0,0,1]
    v_dot2_f32_bf16 v194, v131, s41, v17 neg_lo:[0,0,1]
    v_dot2_f32_bf16 v195, v131, s42, v17 neg_lo:[0,0,1]
    v_dot2_f32_bf16 v196, v132, s41, v17 neg_lo:[0,0,1]
    v_dot2_f32_bf16 v197, v132, s42, v17 neg_lo:[0,0,1]
    v_dot2_f32_bf16 v198, v133, s41, v17 neg_lo:[0,0,1]
    v_dot2_f32_bf16 v199, v133, s42, v17 neg_lo:[0,0,1]
    v_pk_mul_f32 v[120:121], v[172:173], v[172:173]
    v_pk_fma_f32 v[120:121], v[174:175], v[174:175], v[120:121]
    v_pk_fma_f32 v[120:121], v[176:177], v[176:177], v[120:121]
    v_pk_fma_f32 v[120:121], v[178:179], v[178:179], v[120:121]
    v_pk_fma_f32 v[120:121], v[180:181], v[180:181], v[120:121]
    v_pk_fma_f32 v[120:121], v[182:183], v[182:183], v[120:121]
    v_pk_fma_f32 v[120:121], v[184:185], v[184:185], v[120:121]
    v_pk_fma_f32 v[120:121], v[186:187], v[186:187], v[120:121]
    v_pk_fma_f32 v[120:121], v[188:189], v[188:189], v[120:121]
    v_pk_fma_f32 v[120:121], v[190:191], v[190:191], v[120:121]
    v_pk_fma_f32 v[120:121], v[192:193], v[192:193], v[120:121]
    v_pk_fma_f32 v[120:121], v[194:195], v[194:195], v[120:121]
    v_pk_fma_f32 v[120:121], v[196:197], v[196:197], v[120:121]
    v_pk_fma_f32 v[120:121], v[198:199], v[198:199], v[120:121]
    v_add_f32_e64 v120, v120, v121
    v_pk_mul_f32 v[172:173], v[172:173], v[228:229]
    v_pk_mul_f32 v[174:175], v[174:175], v[230:231]
    v_add_f32_dpp v120, v120, v120 row_ror:8 row_mask:0xf bank_mask:0xf
    v_pk_mul_f32 v[176:177], v[176:177], v[232:233]
    v_pk_mul_f32 v[178:179], v[178:179], v[234:235]
    v_add_f32_dpp v120, v120, v120 row_ror:4 row_mask:0xf bank_mask:0xf
    v_pk_mul_f32 v[180:181], v[180:181], v[236:237]
    v_pk_mul_f32 v[182:183], v[182:183], v[238:239]
    v_add_f32_dpp v120, v120, v120 row_ror:2 row_mask:0xf bank_mask:0xf
    v_pk_mul_f32 v[184:185], v[184:185], v[240:241]
    v_pk_mul_f32 v[186:187], v[186:187], v[242:243]
    v_add_f32_dpp v120, v120, v120 row_ror:1 row_mask:0xf bank_mask:0xf
    s_mov_b32 s37, 0
    s_add_u32 m0, s38, 0
    s_nop 0
    buffer_load_dwordx4 v8, s[20:23], s37 offen lds
    v_fma_f32 v120, v120, s44, v16
    v_rsq_f32 v122, v120
    v_pk_mul_f32 v[188:189], v[188:189], v[244:245]
    v_pk_mul_f32 v[190:191], v[190:191], v[246:247]
    v_pk_mul_f32 v[192:193], v[192:193], v[248:249]
    v_pk_mul_f32 v[194:195], v[194:195], v[250:251]
    v_pk_mul_f32 v[196:197], v[196:197], v[252:253]
    v_pk_mul_f32 v[198:199], v[198:199], v[254:255]
    v_pk_fma_f32 v[172:173], v[172:173], v[122:123], v[200:201] op_sel_hi:[1,0,1]
    v_pk_fma_f32 v[174:175], v[174:175], v[122:123], v[202:203] op_sel_hi:[1,0,1]
    buffer_load_dwordx4 v9, s[20:23], s37 offen offset:1024 lds
    v_pk_fma_f32 v[176:177], v[176:177], v[122:123], v[204:205] op_sel_hi:[1,0,1]
    v_pk_fma_f32 v[178:179], v[178:179], v[122:123], v[206:207] op_sel_hi:[1,0,1]
    v_cvt_pk_bf16_f32 v172, v172, v173
    v_cvt_pk_bf16_f32 v173, v174, v175
    v_cvt_pk_bf16_f32 v174, v176, v177
    v_cvt_pk_bf16_f32 v175, v178, v179
    ds_write_b128 v14, v[172:175] offset:28672
    v_pk_fma_f32 v[180:181], v[180:181], v[122:123], v[208:209] op_sel_hi:[1,0,1]
    v_pk_fma_f32 v[182:183], v[182:183], v[122:123], v[210:211] op_sel_hi:[1,0,1]
    v_pk_fma_f32 v[184:185], v[184:185], v[122:123], v[212:213] op_sel_hi:[1,0,1]
    s_mov_b32 s37, 3584
    s_add_u32 m0, s38, 2048
    s_nop 0
    s_nop 0
    buffer_load_dwordx4 v8, s[20:23], s37 offen lds
    v_pk_fma_f32 v[186:187], v[186:187], v[122:123], v[214:215] op_sel_hi:[1,0,1]
    v_cvt_pk_bf16_f32 v180, v180, v181
    v_cvt_pk_bf16_f32 v181, v182, v183
    v_cvt_pk_bf16_f32 v182, v184, v185
    v_cvt_pk_bf16_f32 v183, v186, v187
    ds_write_b128 v14, v[180:183] offset:32768
    v_pk_fma_f32 v[188:189], v[188:189], v[122:123], v[216:217] op_sel_hi:[1,0,1]
    v_pk_fma_f32 v[190:191], v[190:191], v[122:123], v[218:219] op_sel_hi:[1,0,1]
    v_pk_fma_f32 v[192:193], v[192:193], v[122:123], v[220:221] op_sel_hi:[1,0,1]
    v_pk_fma_f32 v[194:195], v[194:195], v[122:123], v[222:223] op_sel_hi:[1,0,1]
    buffer_load_dwordx4 v9, s[20:23], s37 offen offset:1024 lds
    s_waitcnt vmcnt(4)
    s_nop 0
    v_dot2_f32_bf16 v17, v134, s43, 0
    v_dot2_f32_bf16 v17, v135, s43, v17
    v_dot2_f32_bf16 v17, v136, s43, v17
    v_dot2_f32_bf16 v17, v137, s43, v17
    v_dot2_f32_bf16 v17, v138, s43, v17
    v_dot2_f32_bf16 v17, v139, s43, v17
    v_dot2_f32_bf16 v17, v140, s43, v17
    v_dot2_f32_bf16 v17, v141, s43, v17
    v_dot2_f32_bf16 v17, v142, s43, v17
    v_dot2_f32_bf16 v17, v143, s43, v17
    v_dot2_f32_bf16 v17, v144, s43, v17
    v_dot2_f32_bf16 v17, v145, s43, v17
    v_dot2_f32_bf16 v17, v146, s43, v17
    v_dot2_f32_bf16 v17, v147, s43, v17
    v_cvt_pk_bf16_f32 v188, v188, v189
    v_cvt_pk_bf16_f32 v189, v190, v191
    v_cvt_pk_bf16_f32 v190, v192, v193
    v_add_f32_dpp v17, v17, v17 row_ror:8 row_mask:0xf bank_mask:0xf
    v_cvt_pk_bf16_f32 v191, v194, v195
    ds_write_b128 v14, v[188:191] offset:36864
    v_add_f32_dpp v17, v17, v17 row_ror:4 row_mask:0xf bank_mask:0xf
    v_pk_fma_f32 v[196:197], v[196:197], v[122:123], v[224:225] op_sel_hi:[1,0,1]
    v_pk_fma_f32 v[198:199], v[198:199], v[122:123], v[226:227] op_sel_hi:[1,0,1]
    v_add_f32_dpp v17, v17, v17 row_ror:2 row_mask:0xf bank_mask:0xf
    v_cvt_pk_bf16_f32 v196, v196, v197
    v_cvt_pk_bf16_f32 v197, v198, v199
    v_add_f32_dpp v17, v17, v17 row_ror:1 row_mask:0xf bank_mask:0xf
    ds_write_b64 v15, v[196:197] offset:28672
    v_mul_f32_e64 v17, s44, v17
    v_dot2_f32_bf16 v172, v134, s41, v17 neg_lo:[0,0,1]
    v_dot2_f32_bf16 v173, v134, s42, v17 neg_lo:[0,0,1]
    s_mov_b32 s37, 28672
    s_add_u32 m0, s38, 4096
    s_nop 0
    s_nop 0
    buffer_load_dwordx4 v8, s[20:23], s37 offen lds
    v_dot2_f32_bf16 v174, v135, s41, v17 neg_lo:[0,0,1]
    v_dot2_f32_bf16 v175, v135, s42, v17 neg_lo:[0,0,1]
    v_dot2_f32_bf16 v176, v136, s41, v17 neg_lo:[0,0,1]
    v_dot2_f32_bf16 v177, v136, s42, v17 neg_lo:[0,0,1]
    v_dot2_f32_bf16 v178, v137, s41, v17 neg_lo:[0,0,1]
    v_dot2_f32_bf16 v179, v137, s42, v17 neg_lo:[0,0,1]
    v_dot2_f32_bf16 v180, v138, s41, v17 neg_lo:[0,0,1]
    buffer_load_dwordx4 v9, s[20:23], s37 offen offset:1024 lds
    v_dot2_f32_bf16 v181, v138, s42, v17 neg_lo:[0,0,1]
    v_dot2_f32_bf16 v182, v139, s41, v17 neg_lo:[0,0,1]
    v_dot2_f32_bf16 v183, v139, s42, v17 neg_lo:[0,0,1]
    v_dot2_f32_bf16 v184, v140, s41, v17 neg_lo:[0,0,1]
    v_dot2_f32_bf16 v185, v140, s42, v17 neg_lo:[0,0,1]
    v_dot2_f32_bf16 v186, v141, s41, v17 neg_lo:[0,0,1]
    v_dot2_f32_bf16 v187, v141, s42, v17 neg_lo:[0,0,1]
    v_dot2_f32_bf16 v188, v142, s41, v17 neg_lo:[0,0,1]
    s_mov_b32 s37, 32256
    s_add_u32 m0, s38, 6144
    s_nop 0
    s_nop 0
    buffer_load_dwordx4 v8, s[20:23], s37 offen lds
    v_dot2_f32_bf16 v189, v142, s42, v17 neg_lo:[0,0,1]
    v_dot2_f32_bf16 v190, v143, s41, v17 neg_lo:[0,0,1]
    v_dot2_f32_bf16 v191, v143, s42, v17 neg_lo:[0,0,1]
    v_dot2_f32_bf16 v192, v144, s41, v17 neg_lo:[0,0,1]
    v_dot2_f32_bf16 v193, v144, s42, v17 neg_lo:[0,0,1]
    v_dot2_f32_bf16 v194, v145, s41, v17 neg_lo:[0,0,1]
    v_dot2_f32_bf16 v195, v145, s42, v17 neg_lo:[0,0,1]
    buffer_load_dwordx4 v9, s[20:23], s37 offen offset:1024 lds
    v_dot2_f32_bf16 v196, v146, s41, v17 neg_lo:[0,0,1]
    v_dot2_f32_bf16 v197, v146, s42, v17 neg_lo:[0,0,1]
    v_dot2_f32_bf16 v198, v147, s41, v17 neg_lo:[0,0,1]
    v_dot2_f32_bf16 v199, v147, s42, v17 neg_lo:[0,0,1]
    v_pk_mul_f32 v[134:135], v[172:173], v[172:173]
    v_pk_fma_f32 v[134:135], v[174:175], v[174:175], v[134:135]
    v_pk_fma_f32 v[134:135], v[176:177], v[176:177], v[134:135]
    v_pk_fma_f32 v[134:135], v[178:179], v[178:179], v[134:135]
    s_mov_b32 s37, 57344
    s_add_u32 m0, s38, 8192
    s_nop 0
    s_nop 0
    buffer_load_dwordx4 v8, s[20:23], s37 offen lds
    v_pk_fma_f32 v[134:135], v[180:181], v[180:181], v[134:135]
    v_pk_fma_f32 v[134:135], v[182:183], v[182:183], v[134:135]
    v_pk_fma_f32 v[134:135], v[184:185], v[184:185], v[134:135]
    v_pk_fma_f32 v[134:135], v[186:187], v[186:187], v[134:135]
    v_pk_fma_f32 v[134:135], v[188:189], v[188:189], v[134:135]
    v_pk_fma_f32 v[134:135], v[190:191], v[190:191], v[134:135]
    v_pk_fma_f32 v[134:135], v[192:193], v[192:193], v[134:135]
    v_pk_fma_f32 v[134:135], v[194:195], v[194:195], v[134:135]
    buffer_load_dwordx4 v9, s[20:23], s37 offen offset:1024 lds
    v_pk_fma_f32 v[134:135], v[196:197], v[196:197], v[134:135]
    v_pk_fma_f32 v[134:135], v[198:199], v[198:199], v[134:135]
    v_add_f32_e64 v134, v134, v135
    v_pk_mul_f32 v[172:173], v[172:173], v[228:229]
    v_pk_mul_f32 v[174:175], v[174:175], v[230:231]
    v_add_f32_dpp v134, v134, v134 row_ror:8 row_mask:0xf bank_mask:0xf
    v_pk_mul_f32 v[176:177], v[176:177], v[232:233]
    v_pk_mul_f32 v[178:179], v[178:179], v[234:235]
    v_add_f32_dpp v134, v134, v134 row_ror:4 row_mask:0xf bank_mask:0xf
    v_pk_mul_f32 v[180:181], v[180:181], v[236:237]
    v_pk_mul_f32 v[182:183], v[182:183], v[238:239]
    v_add_f32_dpp v134, v134, v134 row_ror:2 row_mask:0xf bank_mask:0xf
    v_pk_mul_f32 v[184:185], v[184:185], v[240:241]
    v_pk_mul_f32 v[186:187], v[186:187], v[242:243]
    v_add_f32_dpp v134, v134, v134 row_ror:1 row_mask:0xf bank_mask:0xf
    v_fma_f32 v134, v134, s44, v16
    v_rsq_f32_e64 v136, v134
    v_pk_mul_f32 v[188:189], v[188:189], v[244:245]
    v_pk_mul_f32 v[190:191], v[190:191], v[246:247]
    v_pk_mul_f32 v[192:193], v[192:193], v[248:249]
    v_pk_mul_f32 v[194:195], v[194:195], v[250:251]
    v_pk_mul_f32 v[196:197], v[196:197], v[252:253]
    v_pk_mul_f32 v[198:199], v[198:199], v[254:255]
    v_pk_fma_f32 v[172:173], v[172:173], v[136:137], v[200:201] op_sel_hi:[1,0,1]
    v_pk_fma_f32 v[174:175], v[174:175], v[136:137], v[202:203] op_sel_hi:[1,0,1]
    v_pk_fma_f32 v[176:177], v[176:177], v[136:137], v[204:205] op_sel_hi:[1,0,1]
    v_pk_fma_f32 v[178:179], v[178:179], v[136:137], v[206:207] op_sel_hi:[1,0,1]
    v_cvt_pk_bf16_f32 v172, v172, v173
    v_cvt_pk_bf16_f32 v173, v174, v175
    v_cvt_pk_bf16_f32 v174, v176, v177
    v_cvt_pk_bf16_f32 v175, v178, v179
    ds_write_b128 v14, v[172:175] offset:43008
    v_pk_fma_f32 v[180:181], v[180:181], v[136:137], v[208:209] op_sel_hi:[1,0,1]
    v_pk_fma_f32 v[182:183], v[182:183], v[136:137], v[210:211] op_sel_hi:[1,0,1]
    v_pk_fma_f32 v[184:185], v[184:185], v[136:137], v[212:213] op_sel_hi:[1,0,1]
    v_pk_fma_f32 v[186:187], v[186:187], v[136:137], v[214:215] op_sel_hi:[1,0,1]
    v_cvt_pk_bf16_f32 v180, v180, v181
    v_cvt_pk_bf16_f32 v181, v182, v183
    v_cvt_pk_bf16_f32 v182, v184, v185
    v_cvt_pk_bf16_f32 v183, v186, v187
    ds_write_b128 v14, v[180:183] offset:47104
    v_pk_fma_f32 v[188:189], v[188:189], v[136:137], v[216:217] op_sel_hi:[1,0,1]
    v_pk_fma_f32 v[190:191], v[190:191], v[136:137], v[218:219] op_sel_hi:[1,0,1]
    v_pk_fma_f32 v[192:193], v[192:193], v[136:137], v[220:221] op_sel_hi:[1,0,1]
    v_pk_fma_f32 v[194:195], v[194:195], v[136:137], v[222:223] op_sel_hi:[1,0,1]
    v_cvt_pk_bf16_f32 v188, v188, v189
    v_cvt_pk_bf16_f32 v189, v190, v191
    v_cvt_pk_bf16_f32 v190, v192, v193
    v_cvt_pk_bf16_f32 v191, v194, v195
    ds_write_b128 v14, v[188:191] offset:51200
    v_pk_fma_f32 v[196:197], v[196:197], v[136:137], v[224:225] op_sel_hi:[1,0,1]
    v_pk_fma_f32 v[198:199], v[198:199], v[136:137], v[226:227] op_sel_hi:[1,0,1]
    v_cvt_pk_bf16_f32 v196, v196, v197
    v_cvt_pk_bf16_f32 v197, v198, v199
    ds_write_b64 v15, v[196:197] offset:43008
    s_waitcnt vmcnt(8)
    ds_read_b64_tr_b16 a[0:1], v10 offset:0
    ds_read_b64_tr_b16 a[4:5], v11 offset:0
    ds_read_b64_tr_b16 a[8:9], v12 offset:0
    ds_read_b64_tr_b16 a[12:13], v13 offset:0
    s_waitcnt vmcnt(6)
    ds_read_b64_tr_b16 a[2:3], v10 offset:2048
    ds_read_b64_tr_b16 a[6:7], v11 offset:2048
    ds_read_b64_tr_b16 a[10:11], v12 offset:2048
    ds_read_b64_tr_b16 a[14:15], v13 offset:2048
    s_waitcnt vmcnt(4)
    ds_read_b64_tr_b16 a[16:17], v10 offset:4096
    ds_read_b64_tr_b16 a[20:21], v11 offset:4096
    ds_read_b64_tr_b16 a[24:25], v12 offset:4096
    ds_read_b64_tr_b16 a[28:29], v13 offset:4096
    s_waitcnt vmcnt(2)
    ds_read_b64_tr_b16 a[18:19], v10 offset:6144
    ds_read_b64_tr_b16 a[22:23], v11 offset:6144
    ds_read_b64_tr_b16 a[26:27], v12 offset:6144
    ds_read_b64_tr_b16 a[30:31], v13 offset:6144
    s_mov_b32 s37, 60928
    s_waitcnt lgkmcnt(12)
    s_add_u32 m0, s38, 0
    s_nop 0
    buffer_load_dwordx4 v8, s[20:23], s37 offen lds
    buffer_load_dwordx4 v9, s[20:23], s37 offen offset:1024 lds
    s_mov_b32 s37, 86016
    s_waitcnt lgkmcnt(8)
    s_add_u32 m0, s38, 2048
    s_nop 0
    buffer_load_dwordx4 v8, s[20:23], s37 offen lds
    buffer_load_dwordx4 v9, s[20:23], s37 offen offset:1024 lds
    s_mov_b32 s37, 89600
    s_waitcnt lgkmcnt(4)
    s_add_u32 m0, s38, 4096
    s_nop 0
    buffer_load_dwordx4 v8, s[20:23], s37 offen lds
    buffer_load_dwordx4 v9, s[20:23], s37 offen offset:1024 lds
    s_waitcnt lgkmcnt(0)
    v_mfma_f32_16x16x32_bf16 v[88:91], a[0:3], v[32:35], 0
    s_waitcnt vmcnt(6)
    ds_read_b64_tr_b16 a[32:33], v10 offset:8192
    v_mfma_f32_16x16x32_bf16 v[88:91], a[16:19], v[36:39], v[88:91]
    ds_read_b64_tr_b16 a[36:37], v11 offset:8192
    ds_read_b64_tr_b16 a[40:41], v12 offset:8192
    v_mfma_f32_16x16x32_bf16 v[92:95], a[4:7], v[32:35], 0
    ds_read_b64_tr_b16 a[44:45], v13 offset:8192
    v_mfma_f32_16x16x32_bf16 v[92:95], a[20:23], v[36:39], v[92:95]
    ds_read_b128 v[48:51], v6 offset:43008
    s_mov_b32 s37, 114688
    v_mfma_f32_16x16x32_bf16 v[96:99], a[8:11], v[32:35], 0
    ds_read_b128 v[52:55], v7 offset:44032
    v_mfma_f32_16x16x32_bf16 v[96:99], a[24:27], v[36:39], v[96:99]
    s_add_u32 m0, s38, 6144
    v_mfma_f32_16x16x32_bf16 v[100:103], a[12:15], v[32:35], 0
    buffer_load_dwordx4 v8, s[20:23], s37 offen lds
    v_mfma_f32_16x16x32_bf16 v[100:103], a[28:31], v[36:39], v[100:103]
    buffer_load_dwordx4 v9, s[20:23], s37 offen offset:1024 lds
    v_mfma_f32_16x16x32_bf16 v[56:59], a[0:3], v[40:43], 0
    s_waitcnt vmcnt(6)
    ds_read_b64_tr_b16 a[34:35], v10 offset:0
    v_mfma_f32_16x16x32_bf16 v[56:59], a[16:19], v[44:47], v[56:59]
    ds_read_b64_tr_b16 a[38:39], v11 offset:0
    ds_read_b64_tr_b16 a[42:43], v12 offset:0
    v_mfma_f32_16x16x32_bf16 v[60:63], a[4:7], v[40:43], 0
    ds_read_b64_tr_b16 a[46:47], v13 offset:0
    v_mfma_f32_16x16x32_bf16 v[60:63], a[20:23], v[44:47], v[60:63]
    ds_read_b128 v[32:35], v6 offset:14336
    s_mov_b32 s37, 118272
    v_mfma_f32_16x16x32_bf16 v[64:67], a[8:11], v[40:43], 0
    ds_read_b128 v[36:39], v7 offset:15360
    v_mfma_f32_16x16x32_bf16 v[64:67], a[24:27], v[44:47], v[64:67]
    s_waitcnt lgkmcnt(6)
    s_add_u32 m0, s38, 8192
    v_mfma_f32_16x16x32_bf16 v[68:71], a[12:15], v[40:43], 0
    buffer_load_dwordx4 v8, s[20:23], s37 offen lds
    v_mfma_f32_16x16x32_bf16 v[68:71], a[28:31], v[44:47], v[68:71]
    buffer_load_dwordx4 v9, s[20:23], s37 offen offset:1024 lds
    v_mfma_f32_16x16x32_bf16 v[104:107], a[0:3], v[48:51], 0
    s_waitcnt vmcnt(6)
    ds_read_b64_tr_b16 a[48:49], v10 offset:2048
    v_mfma_f32_16x16x32_bf16 v[104:107], a[16:19], v[52:55], v[104:107]
    ds_read_b64_tr_b16 a[52:53], v11 offset:2048
    ds_read_b64_tr_b16 a[56:57], v12 offset:2048
    v_mfma_f32_16x16x32_bf16 v[108:111], a[4:7], v[48:51], 0
    ds_read_b64_tr_b16 a[60:61], v13 offset:2048
    v_mfma_f32_16x16x32_bf16 v[108:111], a[20:23], v[52:55], v[108:111]
    ds_read_b128 v[40:43], v6 offset:30720
    s_mov_b32 s37, 143360
    v_mfma_f32_16x16x32_bf16 v[112:115], a[8:11], v[48:51], 0
    ds_read_b128 v[44:47], v7 offset:31744
    v_mfma_f32_16x16x32_bf16 v[112:115], a[24:27], v[52:55], v[112:115]
    s_waitcnt lgkmcnt(6)
    s_add_u32 m0, s38, 0
    v_mfma_f32_16x16x32_bf16 v[116:119], a[12:15], v[48:51], 0
    buffer_load_dwordx4 v8, s[20:23], s37 offen lds
    v_mfma_f32_16x16x32_bf16 v[116:119], a[28:31], v[52:55], v[116:119]
    buffer_load_dwordx4 v9, s[20:23], s37 offen offset:1024 lds
    v_mfma_f32_16x16x32_bf16 v[72:75], a[0:3], v[32:35], 0
    s_waitcnt vmcnt(6)
    ds_read_b64_tr_b16 a[50:51], v10 offset:4096
    v_mfma_f32_16x16x32_bf16 v[72:75], a[16:19], v[36:39], v[72:75]
    ds_read_b64_tr_b16 a[54:55], v11 offset:4096
    ds_read_b64_tr_b16 a[58:59], v12 offset:4096
    v_mfma_f32_16x16x32_bf16 v[76:79], a[4:7], v[32:35], 0
    ds_read_b64_tr_b16 a[62:63], v13 offset:4096
    v_mfma_f32_16x16x32_bf16 v[76:79], a[20:23], v[36:39], v[76:79]
    ds_read_b128 v[48:51], v6 offset:2048
    s_mov_b32 s37, 146944
    v_mfma_f32_16x16x32_bf16 v[80:83], a[8:11], v[32:35], 0
    ds_read_b128 v[52:55], v7 offset:3072
    v_mfma_f32_16x16x32_bf16 v[80:83], a[24:27], v[36:39], v[80:83]
    s_waitcnt lgkmcnt(6)
    s_add_u32 m0, s38, 2048
    v_mfma_f32_16x16x32_bf16 v[84:87], a[12:15], v[32:35], 0
    buffer_load_dwordx4 v8, s[20:23], s37 offen lds
    v_mfma_f32_16x16x32_bf16 v[84:87], a[28:31], v[36:39], v[84:87]
    s_barrier
    buffer_load_dwordx4 v9, s[20:23], s37 offen offset:1024 lds
    s_waitcnt lgkmcnt(2)
    v_mfma_f32_16x16x32_bf16 v[88:91], a[32:35], v[40:43], v[88:91]
    s_waitcnt vmcnt(6)
    ds_read_b64_tr_b16 a[64:65], v10 offset:6144
    v_mfma_f32_16x16x32_bf16 v[88:91], a[48:51], v[44:47], v[88:91]
    ds_read_b64_tr_b16 a[68:69], v11 offset:6144
    ds_read_b64_tr_b16 a[72:73], v12 offset:6144
    v_mfma_f32_16x16x32_bf16 v[92:95], a[36:39], v[40:43], v[92:95]
    ds_read_b64_tr_b16 a[76:77], v13 offset:6144
    v_mfma_f32_16x16x32_bf16 v[92:95], a[52:55], v[44:47], v[92:95]
    ds_read_b128 v[32:35], v6 offset:45056
    s_mov_b32 s37, 172032
    v_mfma_f32_16x16x32_bf16 v[96:99], a[40:43], v[40:43], v[96:99]
    ds_read_b128 v[36:39], v7 offset:46080
    v_mfma_f32_16x16x32_bf16 v[96:99], a[56:59], v[44:47], v[96:99]
    s_waitcnt lgkmcnt(6)
    s_add_u32 m0, s38, 4096
    v_mfma_f32_16x16x32_bf16 v[100:103], a[44:47], v[40:43], v[100:103]
    buffer_load_dwordx4 v8, s[20:23], s37 offen lds
    v_mfma_f32_16x16x32_bf16 v[100:103], a[60:63], v[44:47], v[100:103]
    buffer_load_dwordx4 v9, s[20:23], s37 offen offset:1024 lds
    v_mfma_f32_16x16x32_bf16 v[56:59], a[32:35], v[48:51], v[56:59]
    s_waitcnt vmcnt(6)
    ds_read_b64_tr_b16 a[66:67], v10 offset:8192
    v_mfma_f32_16x16x32_bf16 v[56:59], a[48:51], v[52:55], v[56:59]
    ds_read_b64_tr_b16 a[70:71], v11 offset:8192
    ds_read_b64_tr_b16 a[74:75], v12 offset:8192
    v_mfma_f32_16x16x32_bf16 v[60:63], a[36:39], v[48:51], v[60:63]
    ds_read_b64_tr_b16 a[78:79], v13 offset:8192
    v_mfma_f32_16x16x32_bf16 v[60:63], a[52:55], v[52:55], v[60:63]
    ds_read_b128 v[40:43], v6 offset:16384
    s_mov_b32 s37, 175616
    v_mfma_f32_16x16x32_bf16 v[64:67], a[40:43], v[48:51], v[64:67]
    ds_read_b128 v[44:47], v7 offset:17408
    v_mfma_f32_16x16x32_bf16 v[64:67], a[56:59], v[52:55], v[64:67]
    s_waitcnt lgkmcnt(6)
    s_add_u32 m0, s38, 6144
    v_mfma_f32_16x16x32_bf16 v[68:71], a[44:47], v[48:51], v[68:71]
    buffer_load_dwordx4 v8, s[20:23], s37 offen lds
    v_mfma_f32_16x16x32_bf16 v[68:71], a[60:63], v[52:55], v[68:71]
    buffer_load_dwordx4 v9, s[20:23], s37 offen offset:1024 lds
    v_mfma_f32_16x16x32_bf16 v[104:107], a[32:35], v[32:35], v[104:107]
    s_waitcnt vmcnt(6)
    ds_read_b64_tr_b16 a[80:81], v10 offset:0
    v_mfma_f32_16x16x32_bf16 v[104:107], a[48:51], v[36:39], v[104:107]
    ds_read_b64_tr_b16 a[84:85], v11 offset:0
    ds_read_b64_tr_b16 a[88:89], v12 offset:0
    v_mfma_f32_16x16x32_bf16 v[108:111], a[36:39], v[32:35], v[108:111]
    ds_read_b64_tr_b16 a[92:93], v13 offset:0
    v_mfma_f32_16x16x32_bf16 v[108:111], a[52:55], v[36:39], v[108:111]
    ds_read_b128 v[48:51], v6 offset:32768
    s_mov_b32 s37, 200704
    v_mfma_f32_16x16x32_bf16 v[112:115], a[40:43], v[32:35], v[112:115]
    ds_read_b128 v[52:55], v7 offset:33792
    v_mfma_f32_16x16x32_bf16 v[112:115], a[56:59], v[36:39], v[112:115]
    s_waitcnt lgkmcnt(6)
    s_add_u32 m0, s38, 8192
    v_mfma_f32_16x16x32_bf16 v[116:119], a[44:47], v[32:35], v[116:119]
    buffer_load_dwordx4 v8, s[20:23], s37 offen lds
    v_mfma_f32_16x16x32_bf16 v[116:119], a[60:63], v[36:39], v[116:119]
    buffer_load_dwordx4 v9, s[20:23], s37 offen offset:1024 lds
    v_mfma_f32_16x16x32_bf16 v[72:75], a[32:35], v[40:43], v[72:75]
    s_waitcnt vmcnt(6)
    ds_read_b64_tr_b16 a[82:83], v10 offset:2048
    v_mfma_f32_16x16x32_bf16 v[72:75], a[48:51], v[44:47], v[72:75]
    ds_read_b64_tr_b16 a[86:87], v11 offset:2048
    ds_read_b64_tr_b16 a[90:91], v12 offset:2048
    v_mfma_f32_16x16x32_bf16 v[76:79], a[36:39], v[40:43], v[76:79]
    ds_read_b64_tr_b16 a[94:95], v13 offset:2048
    v_mfma_f32_16x16x32_bf16 v[76:79], a[52:55], v[44:47], v[76:79]
    ds_read_b128 v[32:35], v6 offset:4096
    s_mov_b32 s37, 204288
    v_mfma_f32_16x16x32_bf16 v[80:83], a[40:43], v[40:43], v[80:83]
    ds_read_b128 v[36:39], v7 offset:5120
    v_mfma_f32_16x16x32_bf16 v[80:83], a[56:59], v[44:47], v[80:83]
    s_waitcnt lgkmcnt(6)
    s_add_u32 m0, s38, 0
    v_mfma_f32_16x16x32_bf16 v[84:87], a[44:47], v[40:43], v[84:87]
    buffer_load_dwordx4 v8, s[20:23], s37 offen lds
    v_mfma_f32_16x16x32_bf16 v[84:87], a[60:63], v[44:47], v[84:87]
    buffer_load_dwordx4 v9, s[20:23], s37 offen offset:1024 lds
    s_waitcnt lgkmcnt(2)
    v_mfma_f32_16x16x32_bf16 v[88:91], a[64:67], v[48:51], v[88:91]
    s_waitcnt vmcnt(6)
    ds_read_b64_tr_b16 a[96:97], v10 offset:4096
    v_mfma_f32_16x16x32_bf16 v[88:91], a[80:83], v[52:55], v[88:91]
    ds_read_b64_tr_b16 a[100:101], v11 offset:4096
    ds_read_b64_tr_b16 a[104:105], v12 offset:4096
    v_mfma_f32_16x16x32_bf16 v[92:95], a[68:71], v[48:51], v[92:95]
    ds_read_b64_tr_b16 a[108:109], v13 offset:4096
    v_mfma_f32_16x16x32_bf16 v[92:95], a[84:87], v[52:55], v[92:95]
    ds_read_b128 v[40:43], v6 offset:47104
    s_mov_b32 s37, 229376
    v_mfma_f32_16x16x32_bf16 v[96:99], a[72:75], v[48:51], v[96:99]
    ds_read_b128 v[44:47], v7 offset:48128
    v_mfma_f32_16x16x32_bf16 v[96:99], a[88:91], v[52:55], v[96:99]
    s_waitcnt lgkmcnt(6)
    s_add_u32 m0, s38, 2048
    v_mfma_f32_16x16x32_bf16 v[100:103], a[76:79], v[48:51], v[100:103]
    buffer_load_dwordx4 v8, s[20:23], s37 offen lds
    v_mfma_f32_16x16x32_bf16 v[100:103], a[92:95], v[52:55], v[100:103]
    buffer_load_dwordx4 v9, s[20:23], s37 offen offset:1024 lds
    v_mfma_f32_16x16x32_bf16 v[56:59], a[64:67], v[32:35], v[56:59]
    s_waitcnt vmcnt(6)
    ds_read_b64_tr_b16 a[98:99], v10 offset:6144
    v_mfma_f32_16x16x32_bf16 v[56:59], a[80:83], v[36:39], v[56:59]
    ds_read_b64_tr_b16 a[102:103], v11 offset:6144
    ds_read_b64_tr_b16 a[106:107], v12 offset:6144
    v_mfma_f32_16x16x32_bf16 v[60:63], a[68:71], v[32:35], v[60:63]
    ds_read_b64_tr_b16 a[110:111], v13 offset:6144
    v_mfma_f32_16x16x32_bf16 v[60:63], a[84:87], v[36:39], v[60:63]
    ds_read_b128 v[48:51], v6 offset:18432
    s_mov_b32 s37, 232960
    v_mfma_f32_16x16x32_bf16 v[64:67], a[72:75], v[32:35], v[64:67]
    ds_read_b128 v[52:55], v7 offset:19456
    v_mfma_f32_16x16x32_bf16 v[64:67], a[88:91], v[36:39], v[64:67]
    s_waitcnt lgkmcnt(6)
    s_add_u32 m0, s38, 4096
    v_mfma_f32_16x16x32_bf16 v[68:71], a[76:79], v[32:35], v[68:71]
    buffer_load_dwordx4 v8, s[20:23], s37 offen lds
    v_mfma_f32_16x16x32_bf16 v[68:71], a[92:95], v[36:39], v[68:71]
    buffer_load_dwordx4 v9, s[20:23], s37 offen offset:1024 lds
    v_mfma_f32_16x16x32_bf16 v[104:107], a[64:67], v[40:43], v[104:107]
    s_waitcnt vmcnt(6)
    ds_read_b64_tr_b16 a[112:113], v10 offset:8192
    v_mfma_f32_16x16x32_bf16 v[104:107], a[80:83], v[44:47], v[104:107]
    ds_read_b64_tr_b16 a[116:117], v11 offset:8192
    ds_read_b64_tr_b16 a[120:121], v12 offset:8192
    v_mfma_f32_16x16x32_bf16 v[108:111], a[68:71], v[40:43], v[108:111]
    ds_read_b64_tr_b16 a[124:125], v13 offset:8192
    v_mfma_f32_16x16x32_bf16 v[108:111], a[84:87], v[44:47], v[108:111]
    ds_read_b128 v[32:35], v6 offset:34816
    s_mov_b32 s37, 258048
    v_mfma_f32_16x16x32_bf16 v[112:115], a[72:75], v[40:43], v[112:115]
    ds_read_b128 v[36:39], v7 offset:35840
    v_mfma_f32_16x16x32_bf16 v[112:115], a[88:91], v[44:47], v[112:115]
    s_waitcnt lgkmcnt(6)
    s_add_u32 m0, s38, 6144
    v_mfma_f32_16x16x32_bf16 v[116:119], a[76:79], v[40:43], v[116:119]
    buffer_load_dwordx4 v8, s[20:23], s37 offen lds
    v_mfma_f32_16x16x32_bf16 v[116:119], a[92:95], v[44:47], v[116:119]
    buffer_load_dwordx4 v9, s[20:23], s37 offen offset:1024 lds
    v_mfma_f32_16x16x32_bf16 v[72:75], a[64:67], v[48:51], v[72:75]
    s_waitcnt vmcnt(6)
    ds_read_b64_tr_b16 a[114:115], v10 offset:0
    v_mfma_f32_16x16x32_bf16 v[72:75], a[80:83], v[52:55], v[72:75]
    ds_read_b64_tr_b16 a[118:119], v11 offset:0
    ds_read_b64_tr_b16 a[122:123], v12 offset:0
    v_mfma_f32_16x16x32_bf16 v[76:79], a[68:71], v[48:51], v[76:79]
    ds_read_b64_tr_b16 a[126:127], v13 offset:0
    v_mfma_f32_16x16x32_bf16 v[76:79], a[84:87], v[52:55], v[76:79]
    ds_read_b128 v[40:43], v6 offset:6144
    s_mov_b32 s37, 261632
    v_mfma_f32_16x16x32_bf16 v[80:83], a[72:75], v[48:51], v[80:83]
    ds_read_b128 v[44:47], v7 offset:7168
    v_mfma_f32_16x16x32_bf16 v[80:83], a[88:91], v[52:55], v[80:83]
    s_waitcnt lgkmcnt(6)
    s_add_u32 m0, s38, 8192
    v_mfma_f32_16x16x32_bf16 v[84:87], a[76:79], v[48:51], v[84:87]
    buffer_load_dwordx4 v8, s[20:23], s37 offen lds
    v_mfma_f32_16x16x32_bf16 v[84:87], a[92:95], v[52:55], v[84:87]
    buffer_load_dwordx4 v9, s[20:23], s37 offen offset:1024 lds
    s_waitcnt lgkmcnt(2)
    v_mfma_f32_16x16x32_bf16 v[88:91], a[96:99], v[32:35], v[88:91]
    s_waitcnt vmcnt(6)
    ds_read_b64_tr_b16 a[128:129], v10 offset:2048
    v_mfma_f32_16x16x32_bf16 v[88:91], a[112:115], v[36:39], v[88:91]
    ds_read_b64_tr_b16 a[132:133], v11 offset:2048
    ds_read_b64_tr_b16 a[136:137], v12 offset:2048
    v_mfma_f32_16x16x32_bf16 v[92:95], a[100:103], v[32:35], v[92:95]
    ds_read_b64_tr_b16 a[140:141], v13 offset:2048
    v_mfma_f32_16x16x32_bf16 v[92:95], a[116:119], v[36:39], v[92:95]
    ds_read_b128 v[48:51], v6 offset:49152
    s_mov_b32 s37, 286720
    v_mfma_f32_16x16x32_bf16 v[96:99], a[104:107], v[32:35], v[96:99]
    ds_read_b128 v[52:55], v7 offset:50176
    v_mfma_f32_16x16x32_bf16 v[96:99], a[120:123], v[36:39], v[96:99]
    s_waitcnt lgkmcnt(6)
    s_add_u32 m0, s38, 0
    v_mfma_f32_16x16x32_bf16 v[100:103], a[108:111], v[32:35], v[100:103]
    buffer_load_dwordx4 v8, s[20:23], s37 offen lds
    v_mfma_f32_16x16x32_bf16 v[100:103], a[124:127], v[36:39], v[100:103]
    buffer_load_dwordx4 v9, s[20:23], s37 offen offset:1024 lds
    v_mfma_f32_16x16x32_bf16 v[56:59], a[96:99], v[40:43], v[56:59]
    s_waitcnt vmcnt(6)
    ds_read_b64_tr_b16 a[130:131], v10 offset:4096
    v_mfma_f32_16x16x32_bf16 v[56:59], a[112:115], v[44:47], v[56:59]
    ds_read_b64_tr_b16 a[134:135], v11 offset:4096
    ds_read_b64_tr_b16 a[138:139], v12 offset:4096
    v_mfma_f32_16x16x32_bf16 v[60:63], a[100:103], v[40:43], v[60:63]
    ds_read_b64_tr_b16 a[142:143], v13 offset:4096
    v_mfma_f32_16x16x32_bf16 v[60:63], a[116:119], v[44:47], v[60:63]
    ds_read_b128 v[32:35], v6 offset:20480
    s_mov_b32 s37, 290304
    v_mfma_f32_16x16x32_bf16 v[64:67], a[104:107], v[40:43], v[64:67]
    ds_read_b128 v[36:39], v7 offset:21504
    v_mfma_f32_16x16x32_bf16 v[64:67], a[120:123], v[44:47], v[64:67]
    s_waitcnt lgkmcnt(6)
    s_add_u32 m0, s38, 2048
    v_mfma_f32_16x16x32_bf16 v[68:71], a[108:111], v[40:43], v[68:71]
    buffer_load_dwordx4 v8, s[20:23], s37 offen lds
    v_mfma_f32_16x16x32_bf16 v[68:71], a[124:127], v[44:47], v[68:71]
    buffer_load_dwordx4 v9, s[20:23], s37 offen offset:1024 lds
    v_mfma_f32_16x16x32_bf16 v[104:107], a[96:99], v[48:51], v[104:107]
    s_waitcnt vmcnt(6)
    ds_read_b64_tr_b16 a[144:145], v10 offset:6144
    v_mfma_f32_16x16x32_bf16 v[104:107], a[112:115], v[52:55], v[104:107]
    ds_read_b64_tr_b16 a[148:149], v11 offset:6144
    ds_read_b64_tr_b16 a[152:153], v12 offset:6144
    v_mfma_f32_16x16x32_bf16 v[108:111], a[100:103], v[48:51], v[108:111]
    ds_read_b64_tr_b16 a[156:157], v13 offset:6144
    v_mfma_f32_16x16x32_bf16 v[108:111], a[116:119], v[52:55], v[108:111]
    ds_read_b128 v[40:43], v6 offset:36864
    s_mov_b32 s37, 315392
    v_mfma_f32_16x16x32_bf16 v[112:115], a[104:107], v[48:51], v[112:115]
    ds_read_b128 v[44:47], v7 offset:37888
    v_mfma_f32_16x16x32_bf16 v[112:115], a[120:123], v[52:55], v[112:115]
    s_waitcnt lgkmcnt(6)
    s_add_u32 m0, s38, 4096
    v_mfma_f32_16x16x32_bf16 v[116:119], a[108:111], v[48:51], v[116:119]
    buffer_load_dwordx4 v8, s[20:23], s37 offen lds
    v_mfma_f32_16x16x32_bf16 v[116:119], a[124:127], v[52:55], v[116:119]
    buffer_load_dwordx4 v9, s[20:23], s37 offen offset:1024 lds
    v_mfma_f32_16x16x32_bf16 v[72:75], a[96:99], v[32:35], v[72:75]
    s_waitcnt vmcnt(6)
    ds_read_b64_tr_b16 a[146:147], v10 offset:8192
    v_mfma_f32_16x16x32_bf16 v[72:75], a[112:115], v[36:39], v[72:75]
    ds_read_b64_tr_b16 a[150:151], v11 offset:8192
    ds_read_b64_tr_b16 a[154:155], v12 offset:8192
    v_mfma_f32_16x16x32_bf16 v[76:79], a[100:103], v[32:35], v[76:79]
    ds_read_b64_tr_b16 a[158:159], v13 offset:8192
    v_mfma_f32_16x16x32_bf16 v[76:79], a[116:119], v[36:39], v[76:79]
    ds_read_b128 v[48:51], v6 offset:8192
    s_mov_b32 s37, 318976
    v_mfma_f32_16x16x32_bf16 v[80:83], a[104:107], v[32:35], v[80:83]
    ds_read_b128 v[52:55], v7 offset:9216
    v_mfma_f32_16x16x32_bf16 v[80:83], a[120:123], v[36:39], v[80:83]
    s_waitcnt lgkmcnt(6)
    s_add_u32 m0, s38, 6144
    v_mfma_f32_16x16x32_bf16 v[84:87], a[108:111], v[32:35], v[84:87]
    buffer_load_dwordx4 v8, s[20:23], s37 offen lds
    v_mfma_f32_16x16x32_bf16 v[84:87], a[124:127], v[36:39], v[84:87]
    buffer_load_dwordx4 v9, s[20:23], s37 offen offset:1024 lds
    s_waitcnt lgkmcnt(2)
    v_mfma_f32_16x16x32_bf16 v[88:91], a[128:131], v[40:43], v[88:91]
    s_waitcnt vmcnt(6)
    ds_read_b64_tr_b16 a[160:161], v10 offset:0
    v_mfma_f32_16x16x32_bf16 v[88:91], a[144:147], v[44:47], v[88:91]
    ds_read_b64_tr_b16 a[164:165], v11 offset:0
    ds_read_b64_tr_b16 a[168:169], v12 offset:0
    v_mfma_f32_16x16x32_bf16 v[92:95], a[132:135], v[40:43], v[92:95]
    ds_read_b64_tr_b16 a[172:173], v13 offset:0
    v_mfma_f32_16x16x32_bf16 v[92:95], a[148:151], v[44:47], v[92:95]
    ds_read_b128 v[32:35], v6 offset:51200
    s_mov_b32 s37, 344064
    v_mfma_f32_16x16x32_bf16 v[96:99], a[136:139], v[40:43], v[96:99]
    ds_read_b128 v[36:39], v7 offset:52224
    v_mfma_f32_16x16x32_bf16 v[96:99], a[152:155], v[44:47], v[96:99]
    s_waitcnt lgkmcnt(6)
    s_add_u32 m0, s38, 8192
    v_mfma_f32_16x16x32_bf16 v[100:103], a[140:143], v[40:43], v[100:103]
    buffer_load_dwordx4 v8, s[20:23], s37 offen lds
    v_mfma_f32_16x16x32_bf16 v[100:103], a[156:159], v[44:47], v[100:103]
    buffer_load_dwordx4 v9, s[20:23], s37 offen offset:1024 lds
    v_mfma_f32_16x16x32_bf16 v[56:59], a[128:131], v[48:51], v[56:59]
    s_waitcnt vmcnt(6)
    ds_read_b64_tr_b16 a[162:163], v10 offset:2048
    v_mfma_f32_16x16x32_bf16 v[56:59], a[144:147], v[52:55], v[56:59]
    ds_read_b64_tr_b16 a[166:167], v11 offset:2048
    ds_read_b64_tr_b16 a[170:171], v12 offset:2048
    v_mfma_f32_16x16x32_bf16 v[60:63], a[132:135], v[48:51], v[60:63]
    ds_read_b64_tr_b16 a[174:175], v13 offset:2048
    v_mfma_f32_16x16x32_bf16 v[60:63], a[148:151], v[52:55], v[60:63]
    ds_read_b128 v[40:43], v6 offset:22528
    s_mov_b32 s37, 347648
    v_mfma_f32_16x16x32_bf16 v[64:67], a[136:139], v[48:51], v[64:67]
    ds_read_b128 v[44:47], v7 offset:23552
    v_mfma_f32_16x16x32_bf16 v[64:67], a[152:155], v[52:55], v[64:67]
    s_waitcnt lgkmcnt(6)
    s_add_u32 m0, s38, 0
    v_mfma_f32_16x16x32_bf16 v[68:71], a[140:143], v[48:51], v[68:71]
    buffer_load_dwordx4 v8, s[20:23], s37 offen lds
    v_mfma_f32_16x16x32_bf16 v[68:71], a[156:159], v[52:55], v[68:71]
    buffer_load_dwordx4 v9, s[20:23], s37 offen offset:1024 lds
    v_mfma_f32_16x16x32_bf16 v[104:107], a[128:131], v[32:35], v[104:107]
    s_waitcnt vmcnt(6)
    ds_read_b64_tr_b16 a[176:177], v10 offset:4096
    v_mfma_f32_16x16x32_bf16 v[104:107], a[144:147], v[36:39], v[104:107]
    ds_read_b64_tr_b16 a[180:181], v11 offset:4096
    ds_read_b64_tr_b16 a[184:185], v12 offset:4096
    v_mfma_f32_16x16x32_bf16 v[108:111], a[132:135], v[32:35], v[108:111]
    ds_read_b64_tr_b16 a[188:189], v13 offset:4096
    v_mfma_f32_16x16x32_bf16 v[108:111], a[148:151], v[36:39], v[108:111]
    ds_read_b128 v[48:51], v6 offset:38912
    s_mov_b32 s37, 372736
    v_mfma_f32_16x16x32_bf16 v[112:115], a[136:139], v[32:35], v[112:115]
    ds_read_b128 v[52:55], v7 offset:39936
    v_mfma_f32_16x16x32_bf16 v[112:115], a[152:155], v[36:39], v[112:115]
    s_waitcnt lgkmcnt(6)
    s_add_u32 m0, s38, 2048
    v_mfma_f32_16x16x32_bf16 v[116:119], a[140:143], v[32:35], v[116:119]
    buffer_load_dwordx4 v8, s[20:23], s37 offen lds
    v_mfma_f32_16x16x32_bf16 v[116:119], a[156:159], v[36:39], v[116:119]
    buffer_load_dwordx4 v9, s[20:23], s37 offen offset:1024 lds
    v_mfma_f32_16x16x32_bf16 v[72:75], a[128:131], v[40:43], v[72:75]
    s_waitcnt vmcnt(6)
    ds_read_b64_tr_b16 a[178:179], v10 offset:6144
    v_mfma_f32_16x16x32_bf16 v[72:75], a[144:147], v[44:47], v[72:75]
    ds_read_b64_tr_b16 a[182:183], v11 offset:6144
    ds_read_b64_tr_b16 a[186:187], v12 offset:6144
    v_mfma_f32_16x16x32_bf16 v[76:79], a[132:135], v[40:43], v[76:79]
    ds_read_b64_tr_b16 a[190:191], v13 offset:6144
    v_mfma_f32_16x16x32_bf16 v[76:79], a[148:151], v[44:47], v[76:79]
    ds_read_b128 v[32:35], v6 offset:10240
    s_mov_b32 s37, 376320
    v_mfma_f32_16x16x32_bf16 v[80:83], a[136:139], v[40:43], v[80:83]
    ds_read_b128 v[36:39], v7 offset:11264
    v_mfma_f32_16x16x32_bf16 v[80:83], a[152:155], v[44:47], v[80:83]
    s_waitcnt lgkmcnt(6)
    s_add_u32 m0, s38, 4096
    v_mfma_f32_16x16x32_bf16 v[84:87], a[140:143], v[40:43], v[84:87]
    buffer_load_dwordx4 v8, s[20:23], s37 offen lds
    v_mfma_f32_16x16x32_bf16 v[84:87], a[156:159], v[44:47], v[84:87]
    buffer_load_dwordx4 v9, s[20:23], s37 offen offset:1024 lds
    s_waitcnt lgkmcnt(2)
    v_mfma_f32_16x16x32_bf16 v[88:91], a[160:163], v[48:51], v[88:91]
    s_waitcnt vmcnt(6)
    ds_read_b64_tr_b16 a[192:193], v10 offset:8192
    v_mfma_f32_16x16x32_bf16 v[88:91], a[176:179], v[52:55], v[88:91]
    ds_read_b64_tr_b16 a[196:197], v11 offset:8192
    ds_read_b64_tr_b16 a[200:201], v12 offset:8192
    v_mfma_f32_16x16x32_bf16 v[92:95], a[164:167], v[48:51], v[92:95]
    ds_read_b64_tr_b16 a[204:205], v13 offset:8192
    v_mfma_f32_16x16x32_bf16 v[92:95], a[180:183], v[52:55], v[92:95]
    ds_read_b128 v[40:43], v6 offset:53248
    v_mfma_f32_16x16x32_bf16 v[96:99], a[168:171], v[48:51], v[96:99]
    ds_read_b128 v[44:47], v7 offset:54272
    v_mfma_f32_16x16x32_bf16 v[96:99], a[184:187], v[52:55], v[96:99]
    s_waitcnt lgkmcnt(6)
    s_add_u32 m0, s38, 5120
    v_mfma_f32_16x16x32_bf16 v[100:103], a[172:175], v[48:51], v[100:103]
    buffer_load_dwordx4 v2, s[20:23], 0 offen offset:1024 lds
    s_add_u32 m0, s38, 5120
    v_mfma_f32_16x16x32_bf16 v[100:103], a[188:191], v[52:55], v[100:103]
    buffer_load_dwordx4 v3, s[20:23], 0 offen offset:2048 lds
    v_mfma_f32_16x16x32_bf16 v[56:59], a[160:163], v[32:35], v[56:59]
    s_waitcnt vmcnt(6)
    ds_read_b64_tr_b16 a[194:195], v10 offset:0
    v_mfma_f32_16x16x32_bf16 v[56:59], a[176:179], v[36:39], v[56:59]
    ds_read_b64_tr_b16 a[198:199], v11 offset:0
    ds_read_b64_tr_b16 a[202:203], v12 offset:0
    v_mfma_f32_16x16x32_bf16 v[60:63], a[164:167], v[32:35], v[60:63]
    ds_read_b64_tr_b16 a[206:207], v13 offset:0
    v_mfma_f32_16x16x32_bf16 v[60:63], a[180:183], v[36:39], v[60:63]
    ds_read_b128 v[48:51], v6 offset:24576
    v_mfma_f32_16x16x32_bf16 v[64:67], a[168:171], v[32:35], v[64:67]
    ds_read_b128 v[52:55], v7 offset:25600
    v_mfma_f32_16x16x32_bf16 v[64:67], a[184:187], v[36:39], v[64:67]
    s_waitcnt lgkmcnt(6)
    s_add_u32 m0, s38, 8192
    v_mfma_f32_16x16x32_bf16 v[68:71], a[172:175], v[32:35], v[68:71]
    buffer_load_dwordx4 v4, s[20:23], 0 offen offset:0 lds
    s_add_u32 m0, s38, 8192
    v_mfma_f32_16x16x32_bf16 v[68:71], a[188:191], v[36:39], v[68:71]
    buffer_load_dwordx4 v2, s[20:23], s28 offen offset:1024 lds
    v_mfma_f32_16x16x32_bf16 v[104:107], a[160:163], v[40:43], v[104:107]
    s_waitcnt vmcnt(6)
    ds_read_b64_tr_b16 a[208:209], v10 offset:2048
    v_mfma_f32_16x16x32_bf16 v[104:107], a[176:179], v[44:47], v[104:107]
    ds_read_b64_tr_b16 a[212:213], v11 offset:2048
    ds_read_b64_tr_b16 a[216:217], v12 offset:2048
    v_mfma_f32_16x16x32_bf16 v[108:111], a[164:167], v[40:43], v[108:111]
    ds_read_b64_tr_b16 a[220:221], v13 offset:2048
    v_mfma_f32_16x16x32_bf16 v[108:111], a[180:183], v[44:47], v[108:111]
    ds_read_b128 v[32:35], v6 offset:40960
    v_mfma_f32_16x16x32_bf16 v[112:115], a[168:171], v[40:43], v[112:115]
    ds_read_b128 v[36:39], v7 offset:41984
    v_mfma_f32_16x16x32_bf16 v[112:115], a[184:187], v[44:47], v[112:115]
    s_waitcnt lgkmcnt(6)
    s_add_u32 m0, s38, 4294965248
    v_mfma_f32_16x16x32_bf16 v[116:119], a[172:175], v[40:43], v[116:119]
    buffer_load_dwordx4 v3, s[20:23], s28 offen offset:2048 lds
    s_add_u32 m0, s38, 1024
    v_mfma_f32_16x16x32_bf16 v[116:119], a[188:191], v[44:47], v[116:119]
    buffer_load_dwordx4 v4, s[20:23], s28 offen offset:0 lds
    v_mfma_f32_16x16x32_bf16 v[72:75], a[160:163], v[48:51], v[72:75]
    s_waitcnt vmcnt(6)
    ds_read_b64_tr_b16 a[210:211], v10 offset:4096
    v_mfma_f32_16x16x32_bf16 v[72:75], a[176:179], v[52:55], v[72:75]
    ds_read_b64_tr_b16 a[214:215], v11 offset:4096
    ds_read_b64_tr_b16 a[218:219], v12 offset:4096
    v_mfma_f32_16x16x32_bf16 v[76:79], a[164:167], v[48:51], v[76:79]
    ds_read_b64_tr_b16 a[222:223], v13 offset:4096
    v_mfma_f32_16x16x32_bf16 v[76:79], a[180:183], v[52:55], v[76:79]
    ds_read_b128 v[40:43], v6 offset:12288
    v_mfma_f32_16x16x32_bf16 v[80:83], a[168:171], v[48:51], v[80:83]
    ds_read_b128 v[44:47], v7 offset:13312
    v_mfma_f32_16x16x32_bf16 v[80:83], a[184:187], v[52:55], v[80:83]
    s_waitcnt lgkmcnt(6)
    s_add_u32 m0, s38, 1024
    v_mfma_f32_16x16x32_bf16 v[84:87], a[172:175], v[48:51], v[84:87]
    buffer_load_dwordx4 v2, s[20:23], s29 offen offset:1024 lds
    s_add_u32 m0, s38, 1024
    v_mfma_f32_16x16x32_bf16 v[84:87], a[188:191], v[52:55], v[84:87]
    buffer_load_dwordx4 v3, s[20:23], s29 offen offset:2048 lds
    s_waitcnt lgkmcnt(2)
    v_mfma_f32_16x16x32_bf16 v[88:91], a[192:195], v[32:35], v[88:91]
    v_mfma_f32_16x16x32_bf16 v[88:91], a[208:211], v[36:39], v[88:91]
    v_mfma_f32_16x16x32_bf16 v[92:95], a[196:199], v[32:35], v[92:95]
    v_mfma_f32_16x16x32_bf16 v[92:95], a[212:215], v[36:39], v[92:95]
    ds_read_b128 v[48:51], v6 offset:55296
    v_mfma_f32_16x16x32_bf16 v[96:99], a[200:203], v[32:35], v[96:99]
    ds_read_b128 v[52:55], v7 offset:56320
    v_mfma_f32_16x16x32_bf16 v[96:99], a[216:219], v[36:39], v[96:99]
    s_waitcnt lgkmcnt(2)
    s_add_u32 m0, s38, 4096
    v_mfma_f32_16x16x32_bf16 v[100:103], a[204:207], v[32:35], v[100:103]
    buffer_load_dwordx4 v4, s[20:23], s29 offen offset:0 lds
    v_mfma_f32_16x16x32_bf16 v[100:103], a[220:223], v[36:39], v[100:103]
    v_mfma_f32_16x16x32_bf16 v[56:59], a[192:195], v[40:43], v[56:59]
    s_waitcnt vmcnt(8)
    ds_read_b64_tr_b16 a[224:225], v26 offset:6144
    v_mfma_f32_16x16x32_bf16 v[56:59], a[208:211], v[44:47], v[56:59]
    ds_read_b64_tr_b16 a[228:229], v27 offset:6144
    s_add_u32 m0, s38, 4096
    v_mfma_f32_16x16x32_bf16 v[60:63], a[196:199], v[40:43], v[60:63]
    buffer_load_dwordx4 v2, s[20:23], s30 offen offset:1024 lds
    v_mfma_f32_16x16x32_bf16 v[60:63], a[212:215], v[44:47], v[60:63]
    ds_read_b128 v[32:35], v6 offset:26624
    v_mfma_f32_16x16x32_bf16 v[64:67], a[200:203], v[40:43], v[64:67]
    ds_read_b128 v[36:39], v7 offset:27648
    v_mfma_f32_16x16x32_bf16 v[64:67], a[216:219], v[44:47], v[64:67]
    s_waitcnt lgkmcnt(4)
    s_waitcnt vmcnt(8)
    ds_read_b64_tr_b16 a[226:227], v26 offset:7168
    v_mfma_f32_16x16x32_bf16 v[68:71], a[204:207], v[40:43], v[68:71]
    ds_read_b64_tr_b16 a[230:231], v27 offset:7168
    s_waitcnt lgkmcnt(4)
    s_add_u32 m0, s38, 4096
    v_mfma_f32_16x16x32_bf16 v[68:71], a[220:223], v[44:47], v[68:71]
    buffer_load_dwordx4 v3, s[20:23], s30 offen offset:2048 lds
    v_mfma_f32_16x16x32_bf16 v[104:107], a[192:195], v[48:51], v[104:107]
    v_cvt_pk_bf16_f32 v88, v88, v89
    v_cvt_pk_bf16_f32 v89, v90, v91
    v_mfma_f32_16x16x32_bf16 v[104:107], a[208:211], v[52:55], v[104:107]
    s_waitcnt vmcnt(8)
    ds_read_b64_tr_b16 a[232:233], v5 offset:8192
    v_mfma_f32_16x16x32_bf16 v[108:111], a[196:199], v[48:51], v[108:111]
    ds_read_b64_tr_b16 a[234:235], v5 offset:8704
    v_add_u32 v6, 57344, v6
    v_mfma_f32_16x16x32_bf16 v[108:111], a[212:215], v[52:55], v[108:111]
    ds_read_b128 v[40:43], v6 offset:0
    v_add_u32 v7, 57344, v7
    v_mfma_f32_16x16x32_bf16 v[112:115], a[200:203], v[48:51], v[112:115]
    ds_read_b128 v[44:47], v7 offset:1024
    s_waitcnt lgkmcnt(4)
    s_add_u32 m0, s38, 7168
    v_mfma_f32_16x16x32_bf16 v[112:115], a[216:219], v[52:55], v[112:115]
    buffer_load_dwordx4 v4, s[20:23], s30 offen offset:0 lds
    v_mfma_f32_16x16x32_bf16 v[116:119], a[204:207], v[48:51], v[116:119]
    ds_write_b64 v28, v[88:89]
    v_mfma_f32_16x16x32_bf16 v[116:119], a[220:223], v[52:55], v[116:119]
    v_cvt_pk_bf16_f32 v92, v92, v93
    v_cvt_pk_bf16_f32 v93, v94, v95
    v_mfma_f32_16x16x32_bf16 v[72:75], a[192:195], v[32:35], v[72:75]
    s_waitcnt vmcnt(8)
    ds_read_b64_tr_b16 a[236:237], v26 offset:9216
    v_mfma_f32_16x16x32_bf16 v[72:75], a[208:211], v[36:39], v[72:75]
    ds_read_b64_tr_b16 a[240:241], v27 offset:9216
    s_waitcnt lgkmcnt(5)
    s_add_u32 m0, s38, 7168
    v_mfma_f32_16x16x32_bf16 v[76:79], a[196:199], v[32:35], v[76:79]
    buffer_load_dwordx4 v2, s[20:23], s31 offen offset:1024 lds
    v_mfma_f32_16x16x32_bf16 v[76:79], a[212:215], v[36:39], v[76:79]
    ds_read_b128 v[48:51], v6 offset:2048
    v_mfma_f32_16x16x32_bf16 v[80:83], a[200:203], v[32:35], v[80:83]
    ds_read_b128 v[52:55], v7 offset:3072
    v_mfma_f32_16x16x32_bf16 v[80:83], a[216:219], v[36:39], v[80:83]
    s_waitcnt lgkmcnt(5)
    s_waitcnt vmcnt(8)
    ds_read_b64_tr_b16 a[238:239], v26 offset:0
    v_mfma_f32_16x16x32_bf16 v[84:87], a[204:207], v[32:35], v[84:87]
    ds_read_b64_tr_b16 a[242:243], v27 offset:0
    s_waitcnt lgkmcnt(4)
    s_add_u32 m0, s38, 7168
    v_mfma_f32_16x16x32_bf16 v[84:87], a[220:223], v[36:39], v[84:87]
    buffer_load_dwordx4 v3, s[20:23], s31 offen offset:2048 lds
    v_mfma_f32_16x16x32_bf16 v[240:243], a[0:3], v[40:43], 0
    ds_write_b64 v29, v[92:93]
    v_mfma_f32_16x16x32_bf16 v[240:243], a[16:19], v[44:47], v[240:243]
    s_waitcnt vmcnt(8)
    ds_read_b64_tr_b16 a[244:245], v5 offset:1024
    v_mfma_f32_16x16x32_bf16 v[244:247], a[4:7], v[40:43], 0
    ds_read_b64_tr_b16 a[246:247], v5 offset:1536
    v_cvt_pk_bf16_f32 v96, v96, v97
    v_mfma_f32_16x16x32_bf16 v[244:247], a[20:23], v[44:47], v[244:247]
    ds_read_b128 v[32:35], v6 offset:4096
    v_cvt_pk_bf16_f32 v97, v98, v99
    v_mfma_f32_16x16x32_bf16 v[248:251], a[8:11], v[40:43], 0
    ds_read_b128 v[36:39], v7 offset:5120
    s_waitcnt lgkmcnt(5)
    s_add_u32 m0, s38, 0
    v_mfma_f32_16x16x32_bf16 v[248:251], a[24:27], v[44:47], v[248:251]
    buffer_load_dwordx4 v4, s[20:23], s31 offen offset:0 lds
    v_mfma_f32_16x16x32_bf16 v[252:255], a[12:15], v[40:43], 0
    ds_write_b64 v30, v[96:97]
    v_mfma_f32_16x16x32_bf16 v[252:255], a[28:31], v[44:47], v[252:255]
    v_cvt_pk_bf16_f32 v100, v100, v101
    v_cvt_pk_bf16_f32 v101, v102, v103
    v_mfma_f32_16x16x32_bf16 v[240:243], a[32:35], v[48:51], v[240:243]
    s_waitcnt vmcnt(8)
    ds_read_b64_tr_b16 a[248:249], v26 offset:2048
    v_mfma_f32_16x16x32_bf16 v[240:243], a[48:51], v[52:55], v[240:243]
    ds_read_b64_tr_b16 a[252:253], v27 offset:2048
    s_waitcnt lgkmcnt(5)
    s_add_u32 m0, s38, 0
    v_mfma_f32_16x16x32_bf16 v[244:247], a[36:39], v[48:51], v[244:247]
    buffer_load_dwordx4 v2, s[20:23], s32 offen offset:1024 lds
    v_mfma_f32_16x16x32_bf16 v[244:247], a[52:55], v[52:55], v[244:247]
    ds_read_b128 v[40:43], v6 offset:6144
    v_mfma_f32_16x16x32_bf16 v[248:251], a[40:43], v[48:51], v[248:251]
    ds_read_b128 v[44:47], v7 offset:7168
    v_mfma_f32_16x16x32_bf16 v[248:251], a[56:59], v[52:55], v[248:251]
    s_waitcnt lgkmcnt(5)
    s_waitcnt vmcnt(8)
    ds_read_b64_tr_b16 a[250:251], v26 offset:3072
    v_mfma_f32_16x16x32_bf16 v[252:255], a[44:47], v[48:51], v[252:255]
    ds_read_b64_tr_b16 a[254:255], v27 offset:3072
    s_waitcnt lgkmcnt(4)
    s_add_u32 m0, s38, 0
    v_mfma_f32_16x16x32_bf16 v[252:255], a[60:63], v[52:55], v[252:255]
    buffer_load_dwordx4 v3, s[20:23], s32 offen offset:2048 lds
    v_mfma_f32_16x16x32_bf16 v[240:243], a[64:67], v[32:35], v[240:243]
    ds_write_b64 v31, v[100:101]
    v_mfma_f32_16x16x32_bf16 v[240:243], a[80:83], v[36:39], v[240:243]
    s_waitcnt vmcnt(8)
    ds_read_b64_tr_b16 v[120:121], v5 offset:4096
    v_mfma_f32_16x16x32_bf16 v[244:247], a[68:71], v[32:35], v[244:247]
    ds_read_b64_tr_b16 v[122:123], v5 offset:4608
    v_mfma_f32_16x16x32_bf16 v[244:247], a[84:87], v[36:39], v[244:247]
    ds_read_b128 v[48:51], v6 offset:8192
    v_mfma_f32_16x16x32_bf16 v[248:251], a[72:75], v[32:35], v[248:251]
    ds_read_b128 v[52:55], v7 offset:9216
    s_waitcnt lgkmcnt(5)
    s_add_u32 m0, s38, 3072
    v_mfma_f32_16x16x32_bf16 v[248:251], a[88:91], v[36:39], v[248:251]
    buffer_load_dwordx4 v4, s[20:23], s32 offen offset:0 lds
    v_mfma_f32_16x16x32_bf16 v[252:255], a[76:79], v[32:35], v[252:255]
    ds_read_b128 v[8:11], v18
    v_mfma_f32_16x16x32_bf16 v[252:255], a[92:95], v[36:39], v[252:255]
    ds_read2_b64 v[12:15], v18 offset0:129 offset1:128
    v_mfma_f32_16x16x32_bf16 v[240:243], a[96:99], v[40:43], v[240:243]
    s_waitcnt vmcnt(8)
    ds_read_b64_tr_b16 v[124:125], v26 offset:5120
    v_mfma_f32_16x16x32_bf16 v[240:243], a[112:115], v[44:47], v[240:243]
    ds_read_b64_tr_b16 v[128:129], v27 offset:5120
    s_waitcnt lgkmcnt(6)
    s_add_u32 m0, s38, 3072
    v_mfma_f32_16x16x32_bf16 v[244:247], a[100:103], v[40:43], v[244:247]
    buffer_load_dwordx4 v2, s[20:23], s33 offen offset:1024 lds
    v_mfma_f32_16x16x32_bf16 v[244:247], a[116:119], v[44:47], v[244:247]
    ds_read_b128 v[32:35], v6 offset:10240
    v_mfma_f32_16x16x32_bf16 v[248:251], a[104:107], v[40:43], v[248:251]
    ds_read_b128 v[36:39], v7 offset:11264
    v_mfma_f32_16x16x32_bf16 v[248:251], a[120:123], v[44:47], v[248:251]
    s_waitcnt lgkmcnt(6)
    s_waitcnt vmcnt(8)
    ds_read_b64_tr_b16 v[126:127], v26 offset:6144
    v_mfma_f32_16x16x32_bf16 v[252:255], a[108:111], v[40:43], v[252:255]
    ds_read_b64_tr_b16 v[130:131], v27 offset:6144
    s_waitcnt lgkmcnt(4)
    s_add_u32 m0, s38, 3072
    v_mfma_f32_16x16x32_bf16 v[252:255], a[124:127], v[44:47], v[252:255]
    buffer_load_dwordx4 v3, s[20:23], s33 offen offset:2048 lds
    v_mfma_f32_16x16x32_bf16 v[240:243], a[128:131], v[48:51], v[240:243]
    v_mfma_f32_16x16x32_bf16 v[240:243], a[144:147], v[52:55], v[240:243]
    s_waitcnt vmcnt(8)
    ds_read_b64_tr_b16 v[132:133], v5 offset:7168
    v_mfma_f32_16x16x32_bf16 v[244:247], a[132:135], v[48:51], v[244:247]
    ds_read_b64_tr_b16 v[134:135], v5 offset:7680
    v_mfma_f32_16x16x32_bf16 v[244:247], a[148:151], v[52:55], v[244:247]
    ds_read_b128 v[40:43], v6 offset:12288
    v_mfma_f32_16x16x32_bf16 v[248:251], a[136:139], v[48:51], v[248:251]
    ds_read_b128 v[44:47], v7 offset:13312
    s_waitcnt lgkmcnt(4)
    s_add_u32 m0, s38, 6144
    v_mfma_f32_16x16x32_bf16 v[248:251], a[152:155], v[52:55], v[248:251]
    buffer_load_dwordx4 v4, s[20:23], s33 offen offset:0 lds
    v_mfma_f32_16x16x32_bf16 v[252:255], a[140:143], v[48:51], v[252:255]
    v_mfma_f32_16x16x32_bf16 v[252:255], a[156:159], v[52:55], v[252:255]
    v_mfma_f32_16x16x32_bf16 v[240:243], a[160:163], v[32:35], v[240:243]
    s_waitcnt vmcnt(8)
    ds_read_b64_tr_b16 v[136:137], v26 offset:8192
    v_mfma_f32_16x16x32_bf16 v[240:243], a[176:179], v[36:39], v[240:243]
    ds_read_b64_tr_b16 v[140:141], v27 offset:8192
    s_waitcnt lgkmcnt(4)
    s_add_u32 m0, s38, 6144
    v_mfma_f32_16x16x32_bf16 v[244:247], a[164:167], v[32:35], v[244:247]
    buffer_load_dwordx4 v2, s[20:23], s34 offen offset:1024 lds
    v_mfma_f32_16x16x32_bf16 v[244:247], a[180:183], v[36:39], v[244:247]
    ds_read_b128 v[48:51], v6 offset:14336
    v_mfma_f32_16x16x32_bf16 v[248:251], a[168:171], v[32:35], v[248:251]
    ds_read_b128 v[52:55], v7 offset:15360
    v_mfma_f32_16x16x32_bf16 v[248:251], a[184:187], v[36:39], v[248:251]
    s_waitcnt lgkmcnt(4)
    s_waitcnt vmcnt(8)
    ds_read_b64_tr_b16 v[138:139], v26 offset:9216
    v_mfma_f32_16x16x32_bf16 v[252:255], a[172:175], v[32:35], v[252:255]
    ds_read_b64_tr_b16 v[142:143], v27 offset:9216
    s_waitcnt lgkmcnt(4)
    s_add_u32 m0, s38, 6144
    v_mfma_f32_16x16x32_bf16 v[252:255], a[188:191], v[36:39], v[252:255]
    buffer_load_dwordx4 v3, s[20:23], s34 offen offset:2048 lds
    v_mfma_f32_16x16x32_bf16 v[240:243], a[192:195], v[40:43], v[240:243]
    v_mfma_f32_16x16x32_bf16 v[240:243], a[208:211], v[44:47], v[240:243]
    s_waitcnt vmcnt(8)
    ds_read_b64_tr_b16 v[144:145], v5 offset:0
    v_mfma_f32_16x16x32_bf16 v[244:247], a[196:199], v[40:43], v[244:247]
    ds_read_b64_tr_b16 v[146:147], v5 offset:512
    v_mfma_f32_16x16x32_bf16 v[244:247], a[212:215], v[44:47], v[244:247]
    ds_read_b128 v[32:35], v6 offset:16384
    v_mfma_f32_16x16x32_bf16 v[248:251], a[200:203], v[40:43], v[248:251]
    ds_read_b128 v[36:39], v7 offset:17408
    s_waitcnt lgkmcnt(4)
    s_add_u32 m0, s38, 9216
    v_mfma_f32_16x16x32_bf16 v[248:251], a[216:219], v[44:47], v[248:251]
    buffer_load_dwordx4 v4, s[20:23], s34 offen offset:0 lds
    v_mfma_f32_16x16x32_bf16 v[252:255], a[204:207], v[40:43], v[252:255]
    v_mfma_f32_16x16x32_bf16 v[252:255], a[220:223], v[44:47], v[252:255]
    v_mfma_f32_16x16x32_bf16 v[224:227], a[0:3], v[48:51], 0
    s_waitcnt vmcnt(8)
    ds_read_b64_tr_b16 v[148:149], v26 offset:1024
    v_mfma_f32_16x16x32_bf16 v[224:227], a[16:19], v[52:55], v[224:227]
    ds_read_b64_tr_b16 v[152:153], v27 offset:1024
    s_waitcnt lgkmcnt(4)
    s_add_u32 m0, s38, 4294966272
    v_mfma_f32_16x16x32_bf16 v[228:231], a[4:7], v[48:51], 0
    buffer_load_dwordx4 v2, s[20:23], s35 offen offset:1024 lds
    v_mfma_f32_16x16x32_bf16 v[228:231], a[20:23], v[52:55], v[228:231]
    ds_read_b128 v[40:43], v6 offset:18432
    v_mfma_f32_16x16x32_bf16 v[232:235], a[8:11], v[48:51], 0
    ds_read_b128 v[44:47], v7 offset:19456
    v_mfma_f32_16x16x32_bf16 v[232:235], a[24:27], v[52:55], v[232:235]
    s_waitcnt lgkmcnt(4)
    s_waitcnt vmcnt(8)
    ds_read_b64_tr_b16 v[150:151], v26 offset:2048
    v_mfma_f32_16x16x32_bf16 v[236:239], a[12:15], v[48:51], 0
    ds_read_b64_tr_b16 v[154:155], v27 offset:2048
    s_waitcnt lgkmcnt(4)
    s_add_u32 m0, s38, 4294966272
    v_mfma_f32_16x16x32_bf16 v[236:239], a[28:31], v[52:55], v[236:239]
    buffer_load_dwordx4 v3, s[20:23], s35 offen offset:2048 lds
    v_mfma_f32_16x16x32_bf16 v[224:227], a[32:35], v[32:35], v[224:227]
    v_mfma_f32_16x16x32_bf16 v[224:227], a[48:51], v[36:39], v[224:227]
    s_waitcnt vmcnt(8)
    ds_read_b64_tr_b16 v[156:157], v5 offset:3072
    v_mfma_f32_16x16x32_bf16 v[228:231], a[36:39], v[32:35], v[228:231]
    ds_read_b64_tr_b16 v[158:159], v5 offset:3584
    v_mfma_f32_16x16x32_bf16 v[228:231], a[52:55], v[36:39], v[228:231]
    ds_read_b128 v[48:51], v6 offset:20480
    v_mfma_f32_16x16x32_bf16 v[232:235], a[40:43], v[32:35], v[232:235]
    ds_read_b128 v[52:55], v7 offset:21504
    s_waitcnt lgkmcnt(4)
    s_add_u32 m0, s38, 2048
    v_mfma_f32_16x16x32_bf16 v[232:235], a[56:59], v[36:39], v[232:235]
    buffer_load_dwordx4 v4, s[20:23], s35 offen offset:0 lds
    v_mfma_f32_16x16x32_bf16 v[236:239], a[44:47], v[32:35], v[236:239]
    v_mfma_f32_16x16x32_bf16 v[236:239], a[60:63], v[36:39], v[236:239]
    v_mfma_f32_16x16x32_bf16 v[224:227], a[64:67], v[40:43], v[224:227]
    s_waitcnt vmcnt(8)
    ds_read_b64_tr_b16 v[160:161], v26 offset:4096
    v_mfma_f32_16x16x32_bf16 v[224:227], a[80:83], v[44:47], v[224:227]
    ds_read_b64_tr_b16 v[164:165], v27 offset:4096
    s_waitcnt lgkmcnt(4)
    s_add_u32 m0, s38, 2048
    v_mfma_f32_16x16x32_bf16 v[228:231], a[68:71], v[40:43], v[228:231]
    buffer_load_dwordx4 v2, s[20:23], s92 offen offset:1024 lds
    v_mfma_f32_16x16x32_bf16 v[228:231], a[84:87], v[44:47], v[228:231]
    ds_read_b128 v[32:35], v6 offset:22528
    v_mfma_f32_16x16x32_bf16 v[232:235], a[72:75], v[40:43], v[232:235]
    ds_read_b128 v[36:39], v7 offset:23552
    v_mfma_f32_16x16x32_bf16 v[232:235], a[88:91], v[44:47], v[232:235]
    s_waitcnt lgkmcnt(4)
    s_waitcnt vmcnt(8)
    ds_read_b64_tr_b16 v[162:163], v26 offset:5120
    v_mfma_f32_16x16x32_bf16 v[236:239], a[76:79], v[40:43], v[236:239]
    ds_read_b64_tr_b16 v[166:167], v27 offset:5120
    s_waitcnt lgkmcnt(4)
    s_add_u32 m0, s38, 2048
    v_mfma_f32_16x16x32_bf16 v[236:239], a[92:95], v[44:47], v[236:239]
    buffer_load_dwordx4 v3, s[20:23], s92 offen offset:2048 lds
    v_mfma_f32_16x16x32_bf16 v[224:227], a[96:99], v[48:51], v[224:227]
    v_mfma_f32_16x16x32_bf16 v[224:227], a[112:115], v[52:55], v[224:227]
    s_waitcnt vmcnt(8)
    ds_read_b64_tr_b16 v[168:169], v5 offset:6144
    v_mfma_f32_16x16x32_bf16 v[228:231], a[100:103], v[48:51], v[228:231]
    ds_read_b64_tr_b16 v[170:171], v5 offset:6656
    v_mfma_f32_16x16x32_bf16 v[228:231], a[116:119], v[52:55], v[228:231]
    ds_read_b128 v[40:43], v6 offset:24576
    v_mfma_f32_16x16x32_bf16 v[232:235], a[104:107], v[48:51], v[232:235]
    ds_read_b128 v[44:47], v7 offset:25600
    s_waitcnt lgkmcnt(4)
    s_add_u32 m0, s38, 5120
    v_mfma_f32_16x16x32_bf16 v[232:235], a[120:123], v[52:55], v[232:235]
    buffer_load_dwordx4 v4, s[20:23], s92 offen offset:0 lds
    v_mfma_f32_16x16x32_bf16 v[236:239], a[108:111], v[48:51], v[236:239]
    v_mfma_f32_16x16x32_bf16 v[236:239], a[124:127], v[52:55], v[236:239]
    v_mfma_f32_16x16x32_bf16 v[224:227], a[128:131], v[32:35], v[224:227]
    s_waitcnt vmcnt(8)
    ds_read_b64_tr_b16 v[172:173], v26 offset:7168
    v_mfma_f32_16x16x32_bf16 v[224:227], a[144:147], v[36:39], v[224:227]
    ds_read_b64_tr_b16 v[176:177], v27 offset:7168
    s_waitcnt lgkmcnt(4)
    s_add_u32 m0, s38, 5120
    v_mfma_f32_16x16x32_bf16 v[228:231], a[132:135], v[32:35], v[228:231]
    buffer_load_dwordx4 v2, s[20:23], s93 offen offset:1024 lds
    v_mfma_f32_16x16x32_bf16 v[228:231], a[148:151], v[36:39], v[228:231]
    ds_read_b128 v[48:51], v6 offset:26624
    v_mfma_f32_16x16x32_bf16 v[232:235], a[136:139], v[32:35], v[232:235]
    ds_read_b128 v[52:55], v7 offset:27648
    v_mfma_f32_16x16x32_bf16 v[232:235], a[152:155], v[36:39], v[232:235]
    s_waitcnt lgkmcnt(4)
    s_waitcnt vmcnt(8)
    ds_read_b64_tr_b16 v[174:175], v26 offset:8192
    v_mfma_f32_16x16x32_bf16 v[236:239], a[140:143], v[32:35], v[236:239]
    ds_read_b64_tr_b16 v[178:179], v27 offset:8192
    s_waitcnt lgkmcnt(4)
    s_add_u32 m0, s38, 5120
    v_mfma_f32_16x16x32_bf16 v[236:239], a[156:159], v[36:39], v[236:239]
    buffer_load_dwordx4 v3, s[20:23], s93 offen offset:2048 lds
    v_mfma_f32_16x16x32_bf16 v[224:227], a[160:163], v[40:43], v[224:227]
    v_mfma_f32_16x16x32_bf16 v[224:227], a[176:179], v[44:47], v[224:227]
    s_waitcnt vmcnt(8)
    ds_read_b64_tr_b16 v[180:181], v5 offset:9216
    v_mfma_f32_16x16x32_bf16 v[228:231], a[164:167], v[40:43], v[228:231]
    ds_read_b64_tr_b16 v[182:183], v5 offset:9728
    v_mfma_f32_16x16x32_bf16 v[228:231], a[180:183], v[44:47], v[228:231]
    ds_read_b128 v[32:35], v6 offset:28672
    v_mfma_f32_16x16x32_bf16 v[232:235], a[168:171], v[40:43], v[232:235]
    ds_read_b128 v[36:39], v7 offset:29696
    s_waitcnt lgkmcnt(4)
    s_add_u32 m0, s38, 8192
    v_mfma_f32_16x16x32_bf16 v[232:235], a[184:187], v[44:47], v[232:235]
    buffer_load_dwordx4 v4, s[20:23], s93 offen offset:0 lds
    v_mfma_f32_16x16x32_bf16 v[236:239], a[172:175], v[40:43], v[236:239]
    v_mfma_f32_16x16x32_bf16 v[236:239], a[188:191], v[44:47], v[236:239]
    v_mfma_f32_16x16x32_bf16 v[224:227], a[192:195], v[48:51], v[224:227]
    s_waitcnt vmcnt(8)
    ds_read_b64_tr_b16 v[184:185], v26 offset:0
    v_mfma_f32_16x16x32_bf16 v[224:227], a[208:211], v[52:55], v[224:227]
    ds_read_b64_tr_b16 v[188:189], v27 offset:0
    s_waitcnt lgkmcnt(4)
    s_add_u32 m0, s38, 8192
    v_mfma_f32_16x16x32_bf16 v[228:231], a[196:199], v[48:51], v[228:231]
    buffer_load_dwordx4 v2, s[20:23], s94 offen offset:1024 lds
    v_mfma_f32_16x16x32_bf16 v[228:231], a[212:215], v[52:55], v[228:231]
    ds_read_b128 v[40:43], v6 offset:30720
    v_mfma_f32_16x16x32_bf16 v[232:235], a[200:203], v[48:51], v[232:235]
    ds_read_b128 v[44:47], v7 offset:31744
    v_mfma_f32_16x16x32_bf16 v[232:235], a[216:219], v[52:55], v[232:235]
    s_waitcnt lgkmcnt(4)
    s_waitcnt vmcnt(8)
    ds_read_b64_tr_b16 v[186:187], v26 offset:1024
    v_mfma_f32_16x16x32_bf16 v[236:239], a[204:207], v[48:51], v[236:239]
    ds_read_b64_tr_b16 v[190:191], v27 offset:1024
    s_waitcnt lgkmcnt(4)
    s_add_u32 m0, s38, 4294965248
    v_mfma_f32_16x16x32_bf16 v[236:239], a[220:223], v[52:55], v[236:239]
    buffer_load_dwordx4 v3, s[20:23], s94 offen offset:2048 lds
    v_mfma_f32_16x16x32_bf16 v[88:91], a[0:3], v[32:35], 0
    v_mfma_f32_16x16x32_bf16 v[88:91], a[16:19], v[36:39], v[88:91]
    s_waitcnt vmcnt(8)
    ds_read_b64_tr_b16 v[192:193], v5 offset:2048
    v_mfma_f32_16x16x32_bf16 v[92:95], a[4:7], v[32:35], 0
    ds_read_b64_tr_b16 v[194:195], v5 offset:2560
    v_mfma_f32_16x16x32_bf16 v[92:95], a[20:23], v[36:39], v[92:95]
    ds_read_b128 v[48:51], v6 offset:32768
    v_mfma_f32_16x16x32_bf16 v[96:99], a[8:11], v[32:35], 0
    ds_read_b128 v[52:55], v7 offset:33792
    s_waitcnt lgkmcnt(4)
    s_add_u32 m0, s38, 1024
    v_mfma_f32_16x16x32_bf16 v[96:99], a[24:27], v[36:39], v[96:99]
    buffer_load_dwordx4 v4, s[20:23], s94 offen offset:0 lds
    v_mfma_f32_16x16x32_bf16 v[100:103], a[12:15], v[32:35], 0
    v_mfma_f32_16x16x32_bf16 v[100:103], a[28:31], v[36:39], v[100:103]
    v_mfma_f32_16x16x32_bf16 v[88:91], a[32:35], v[40:43], v[88:91]
    s_waitcnt vmcnt(8)
    ds_read_b64_tr_b16 v[196:197], v26 offset:3072
    v_mfma_f32_16x16x32_bf16 v[88:91], a[48:51], v[44:47], v[88:91]
    ds_read_b64_tr_b16 v[200:201], v27 offset:3072
    s_waitcnt lgkmcnt(4)
    s_add_u32 m0, s38, 1024
    v_mfma_f32_16x16x32_bf16 v[92:95], a[36:39], v[40:43], v[92:95]
    buffer_load_dwordx4 v2, s[20:23], s98 offen offset:1024 lds
    v_mfma_f32_16x16x32_bf16 v[92:95], a[52:55], v[44:47], v[92:95]
    ds_read_b128 v[32:35], v6 offset:34816
    v_mfma_f32_16x16x32_bf16 v[96:99], a[40:43], v[40:43], v[96:99]
    ds_read_b128 v[36:39], v7 offset:35840
    v_mfma_f32_16x16x32_bf16 v[96:99], a[56:59], v[44:47], v[96:99]
    s_waitcnt lgkmcnt(4)
    s_waitcnt vmcnt(8)
    ds_read_b64_tr_b16 v[198:199], v26 offset:4096
    v_mfma_f32_16x16x32_bf16 v[100:103], a[44:47], v[40:43], v[100:103]
    ds_read_b64_tr_b16 v[202:203], v27 offset:4096
    s_waitcnt lgkmcnt(4)
    s_add_u32 m0, s38, 1024
    v_mfma_f32_16x16x32_bf16 v[100:103], a[60:63], v[44:47], v[100:103]
    buffer_load_dwordx4 v3, s[20:23], s98 offen offset:2048 lds
    v_mfma_f32_16x16x32_bf16 v[88:91], a[64:67], v[48:51], v[88:91]
    v_mfma_f32_16x16x32_bf16 v[88:91], a[80:83], v[52:55], v[88:91]
    s_waitcnt vmcnt(8)
    ds_read_b64_tr_b16 v[204:205], v5 offset:5120
    v_mfma_f32_16x16x32_bf16 v[92:95], a[68:71], v[48:51], v[92:95]
    ds_read_b64_tr_b16 v[206:207], v5 offset:5632
    v_mfma_f32_16x16x32_bf16 v[92:95], a[84:87], v[52:55], v[92:95]
    ds_read_b128 v[40:43], v6 offset:36864
    v_mfma_f32_16x16x32_bf16 v[96:99], a[72:75], v[48:51], v[96:99]
    ds_read_b128 v[44:47], v7 offset:37888
    s_waitcnt lgkmcnt(4)
    s_add_u32 m0, s38, 4096
    v_mfma_f32_16x16x32_bf16 v[96:99], a[88:91], v[52:55], v[96:99]
    buffer_load_dwordx4 v4, s[20:23], s98 offen offset:0 lds
    v_mfma_f32_16x16x32_bf16 v[100:103], a[76:79], v[48:51], v[100:103]
    v_mfma_f32_16x16x32_bf16 v[100:103], a[92:95], v[52:55], v[100:103]
    v_mfma_f32_16x16x32_bf16 v[88:91], a[96:99], v[32:35], v[88:91]
    s_waitcnt vmcnt(8)
    ds_read_b64_tr_b16 v[208:209], v26 offset:6144
    v_mfma_f32_16x16x32_bf16 v[88:91], a[112:115], v[36:39], v[88:91]
    ds_read_b64_tr_b16 v[212:213], v27 offset:6144
    s_waitcnt lgkmcnt(4)
    s_add_u32 m0, s38, 4096
    v_mfma_f32_16x16x32_bf16 v[92:95], a[100:103], v[32:35], v[92:95]
    buffer_load_dwordx4 v2, s[20:23], s99 offen offset:1024 lds
    v_mfma_f32_16x16x32_bf16 v[92:95], a[116:119], v[36:39], v[92:95]
    ds_read_b128 v[48:51], v6 offset:38912
    v_mfma_f32_16x16x32_bf16 v[96:99], a[104:107], v[32:35], v[96:99]
    ds_read_b128 v[52:55], v7 offset:39936
    v_mfma_f32_16x16x32_bf16 v[96:99], a[120:123], v[36:39], v[96:99]
    s_waitcnt lgkmcnt(4)
    s_waitcnt vmcnt(8)
    ds_read_b64_tr_b16 v[210:211], v26 offset:7168
    v_mfma_f32_16x16x32_bf16 v[100:103], a[108:111], v[32:35], v[100:103]
    ds_read_b64_tr_b16 v[214:215], v27 offset:7168
    s_waitcnt lgkmcnt(4)
    s_add_u32 m0, s38, 4096
    v_mfma_f32_16x16x32_bf16 v[100:103], a[124:127], v[36:39], v[100:103]
    buffer_load_dwordx4 v3, s[20:23], s99 offen offset:2048 lds
    v_mfma_f32_16x16x32_bf16 v[88:91], a[128:131], v[40:43], v[88:91]
    v_mfma_f32_16x16x32_bf16 v[88:91], a[144:147], v[44:47], v[88:91]
    s_waitcnt vmcnt(8)
    ds_read_b64_tr_b16 v[216:217], v5 offset:8192
    v_mfma_f32_16x16x32_bf16 v[92:95], a[132:135], v[40:43], v[92:95]
    ds_read_b64_tr_b16 v[218:219], v5 offset:8704
    v_mfma_f32_16x16x32_bf16 v[92:95], a[148:151], v[44:47], v[92:95]
    ds_read_b128 v[32:35], v6 offset:40960
    v_cvt_pk_bf16_f32 v56, v56, v57
    v_mfma_f32_16x16x32_bf16 v[96:99], a[136:139], v[40:43], v[96:99]
    ds_read_b128 v[36:39], v7 offset:41984
    s_waitcnt lgkmcnt(4)
    s_add_u32 m0, s38, 7168
    v_mfma_f32_16x16x32_bf16 v[96:99], a[152:155], v[44:47], v[96:99]
    buffer_load_dwordx4 v4, s[20:23], s99 offen offset:0 lds
    v_mfma_f32_16x16x32_bf16 v[100:103], a[140:143], v[40:43], v[100:103]
    v_cvt_pk_bf16_f32 v57, v58, v59
    v_mfma_f32_16x16x32_bf16 v[100:103], a[156:159], v[44:47], v[100:103]
    ds_write_b64 v28, v[56:57]
    v_mfma_f32_16x16x32_bf16 v[88:91], a[160:163], v[48:51], v[88:91]
    buffer_store_dwordx4 v[8:11], v19, s[24:27], s52 offen nt sc1
    v_mfma_f32_16x16x32_bf16 v[88:91], a[176:179], v[52:55], v[88:91]
    v_cvt_pk_bf16_f32 v60, v60, v61
    v_cvt_pk_bf16_f32 v61, v62, v63
    v_mfma_f32_16x16x32_bf16 v[92:95], a[164:167], v[48:51], v[92:95]
    ds_write_b64 v29, v[60:61]
    v_mfma_f32_16x16x32_bf16 v[92:95], a[180:183], v[52:55], v[92:95]
    ds_read_b128 v[40:43], v6 offset:43008
    v_cvt_pk_bf16_f32 v64, v64, v65
    v_mfma_f32_16x16x32_bf16 v[96:99], a[168:171], v[48:51], v[96:99]
    ds_read_b128 v[44:47], v7 offset:44032
    v_cvt_pk_bf16_f32 v65, v66, v67
    v_mfma_f32_16x16x32_bf16 v[96:99], a[184:187], v[52:55], v[96:99]
    s_waitcnt lgkmcnt(4)
    ds_write_b64 v30, v[64:65]
    v_mfma_f32_16x16x32_bf16 v[100:103], a[172:175], v[48:51], v[100:103]
    buffer_store_dwordx4 v[12:15], v20, s[24:27], s52 offen nt sc1
    v_mfma_f32_16x16x32_bf16 v[100:103], a[188:191], v[52:55], v[100:103]
    v_cvt_pk_bf16_f32 v68, v68, v69
    v_cvt_pk_bf16_f32 v69, v70, v71
    v_mfma_f32_16x16x32_bf16 v[88:91], a[192:195], v[32:35], v[88:91]
    ds_write_b64 v31, v[68:69]
    v_mfma_f32_16x16x32_bf16 v[88:91], a[208:211], v[36:39], v[88:91]
    ds_read_b128 v[8:11], v18
    v_mfma_f32_16x16x32_bf16 v[92:95], a[196:199], v[32:35], v[92:95]
    ds_read2_b64 v[12:15], v18 offset0:129 offset1:128
    v_cvt_pk_bf16_f32 v104, v104, v105
    v_mfma_f32_16x16x32_bf16 v[92:95], a[212:215], v[36:39], v[92:95]
    ds_read_b128 v[48:51], v6 offset:45056
    v_cvt_pk_bf16_f32 v105, v106, v107
    v_mfma_f32_16x16x32_bf16 v[96:99], a[200:203], v[32:35], v[96:99]
    ds_read_b128 v[52:55], v7 offset:46080
    v_mfma_f32_16x16x32_bf16 v[96:99], a[216:219], v[36:39], v[96:99]
    s_waitcnt lgkmcnt(6)
    ds_write_b64 v28, v[104:105]
    v_mfma_f32_16x16x32_bf16 v[100:103], a[204:207], v[32:35], v[100:103]
    v_cvt_pk_bf16_f32 v108, v108, v109
    v_cvt_pk_bf16_f32 v109, v110, v111
    v_mfma_f32_16x16x32_bf16 v[100:103], a[220:223], v[36:39], v[100:103]
    ds_write_b64 v29, v[108:109]
    v_mfma_f32_16x16x32_bf16 v[56:59], a[0:3], v[40:43], 0
    v_cvt_pk_bf16_f32 v112, v112, v113
    v_cvt_pk_bf16_f32 v113, v114, v115
    v_mfma_f32_16x16x32_bf16 v[56:59], a[16:19], v[44:47], v[56:59]
    ds_write_b64 v30, v[112:113]
    v_mfma_f32_16x16x32_bf16 v[60:63], a[4:7], v[40:43], 0
    s_waitcnt lgkmcnt(6)
    buffer_store_dwordx4 v[8:11], v19, s[24:27], s50 offen nt sc1
    v_mfma_f32_16x16x32_bf16 v[60:63], a[20:23], v[44:47], v[60:63]
    ds_read_b128 v[32:35], v6 offset:47104
    v_cvt_pk_bf16_f32 v116, v116, v117
    v_mfma_f32_16x16x32_bf16 v[64:67], a[8:11], v[40:43], 0
    ds_read_b128 v[36:39], v7 offset:48128
    v_cvt_pk_bf16_f32 v117, v118, v119
    v_mfma_f32_16x16x32_bf16 v[64:67], a[24:27], v[44:47], v[64:67]
    s_waitcnt lgkmcnt(5)
    ds_write_b64 v31, v[116:117]
    v_mfma_f32_16x16x32_bf16 v[68:71], a[12:15], v[40:43], 0
    buffer_store_dwordx4 v[12:15], v20, s[24:27], s50 offen nt sc1
    v_mfma_f32_16x16x32_bf16 v[68:71], a[28:31], v[44:47], v[68:71]
    ds_read_b128 v[104:107], v18
    v_mfma_f32_16x16x32_bf16 v[56:59], a[32:35], v[48:51], v[56:59]
    ds_read2_b64 v[108:111], v18 offset0:129 offset1:128
    v_cvt_pk_bf16_f32 v224, v224, v225
    v_mfma_f32_16x16x32_bf16 v[56:59], a[48:51], v[52:55], v[56:59]
    v_cvt_pk_bf16_f32 v225, v226, v227
    v_mfma_f32_16x16x32_bf16 v[60:63], a[36:39], v[48:51], v[60:63]
    ds_write_b64 v28, v[224:225]
    v_mfma_f32_16x16x32_bf16 v[60:63], a[52:55], v[52:55], v[60:63]
    ds_read_b128 v[40:43], v6 offset:49152
    v_cvt_pk_bf16_f32 v228, v228, v229
    v_mfma_f32_16x16x32_bf16 v[64:67], a[40:43], v[48:51], v[64:67]
    ds_read_b128 v[44:47], v7 offset:50176
    v_cvt_pk_bf16_f32 v229, v230, v231
    v_mfma_f32_16x16x32_bf16 v[64:67], a[56:59], v[52:55], v[64:67]
    s_waitcnt lgkmcnt(6)
    ds_write_b64 v29, v[228:229]
    v_mfma_f32_16x16x32_bf16 v[68:71], a[44:47], v[48:51], v[68:71]
    v_cvt_pk_bf16_f32 v232, v232, v233
    v_cvt_pk_bf16_f32 v233, v234, v235
    v_mfma_f32_16x16x32_bf16 v[68:71], a[60:63], v[52:55], v[68:71]
    ds_write_b64 v30, v[232:233]
    v_mfma_f32_16x16x32_bf16 v[56:59], a[64:67], v[32:35], v[56:59]
    s_waitcnt lgkmcnt(6)
    buffer_store_dwordx4 v[104:107], v19, s[24:27], s53 offen nt sc1
    v_mfma_f32_16x16x32_bf16 v[56:59], a[80:83], v[36:39], v[56:59]
    v_cvt_pk_bf16_f32 v236, v236, v237
    v_cvt_pk_bf16_f32 v237, v238, v239
    v_mfma_f32_16x16x32_bf16 v[60:63], a[68:71], v[32:35], v[60:63]
    ds_write_b64 v31, v[236:237]
    v_mfma_f32_16x16x32_bf16 v[60:63], a[84:87], v[36:39], v[60:63]
    ds_read_b128 v[48:51], v6 offset:51200
    v_mfma_f32_16x16x32_bf16 v[64:67], a[72:75], v[32:35], v[64:67]
    ds_read_b128 v[52:55], v7 offset:52224
    v_mfma_f32_16x16x32_bf16 v[64:67], a[88:91], v[36:39], v[64:67]
    s_waitcnt lgkmcnt(5)
    v_mfma_f32_16x16x32_bf16 v[68:71], a[76:79], v[32:35], v[68:71]
    buffer_store_dwordx4 v[108:111], v20, s[24:27], s53 offen nt sc1
    v_mfma_f32_16x16x32_bf16 v[68:71], a[92:95], v[36:39], v[68:71]
    ds_read_b128 v[112:115], v18
    v_mfma_f32_16x16x32_bf16 v[56:59], a[96:99], v[40:43], v[56:59]
    ds_read2_b64 v[116:119], v18 offset0:129 offset1:128
    v_cvt_pk_bf16_f32 v240, v240, v241
    v_mfma_f32_16x16x32_bf16 v[56:59], a[112:115], v[44:47], v[56:59]
    v_cvt_pk_bf16_f32 v241, v242, v243
    v_mfma_f32_16x16x32_bf16 v[60:63], a[100:103], v[40:43], v[60:63]
    ds_write_b64 v28, v[240:241]
    v_mfma_f32_16x16x32_bf16 v[60:63], a[116:119], v[44:47], v[60:63]
    ds_read_b128 v[32:35], v6 offset:53248
    v_cvt_pk_bf16_f32 v244, v244, v245
    v_mfma_f32_16x16x32_bf16 v[64:67], a[104:107], v[40:43], v[64:67]
    ds_read_b128 v[36:39], v7 offset:54272
    v_cvt_pk_bf16_f32 v245, v246, v247
    v_mfma_f32_16x16x32_bf16 v[64:67], a[120:123], v[44:47], v[64:67]
    s_waitcnt lgkmcnt(5)
    ds_write_b64 v29, v[244:245]
    v_mfma_f32_16x16x32_bf16 v[68:71], a[108:111], v[40:43], v[68:71]
    v_cvt_pk_bf16_f32 v248, v248, v249
    v_cvt_pk_bf16_f32 v249, v250, v251
    v_mfma_f32_16x16x32_bf16 v[68:71], a[124:127], v[44:47], v[68:71]
    ds_write_b64 v30, v[248:249]
    v_mfma_f32_16x16x32_bf16 v[56:59], a[128:131], v[48:51], v[56:59]
    s_waitcnt lgkmcnt(6)
    buffer_store_dwordx4 v[112:115], v19, s[24:27], s55 offen nt sc1
    v_mfma_f32_16x16x32_bf16 v[56:59], a[144:147], v[52:55], v[56:59]
    v_cvt_pk_bf16_f32 v252, v252, v253
    v_cvt_pk_bf16_f32 v253, v254, v255
    v_mfma_f32_16x16x32_bf16 v[60:63], a[132:135], v[48:51], v[60:63]
    ds_write_b64 v31, v[252:253]
    v_mfma_f32_16x16x32_bf16 v[60:63], a[148:151], v[52:55], v[60:63]
    ds_read_b128 v[40:43], v6 offset:55296
    v_mfma_f32_16x16x32_bf16 v[64:67], a[136:139], v[48:51], v[64:67]
    ds_read_b128 v[44:47], v7 offset:56320
    v_mfma_f32_16x16x32_bf16 v[64:67], a[152:155], v[52:55], v[64:67]
    s_waitcnt lgkmcnt(5)
    v_mfma_f32_16x16x32_bf16 v[68:71], a[140:143], v[48:51], v[68:71]
    buffer_store_dwordx4 v[116:119], v20, s[24:27], s55 offen nt sc1
    v_mfma_f32_16x16x32_bf16 v[68:71], a[156:159], v[52:55], v[68:71]
    ds_read_b128 v[8:11], v18
    v_mfma_f32_16x16x32_bf16 v[56:59], a[160:163], v[32:35], v[56:59]
    ds_read2_b64 v[12:15], v18 offset0:129 offset1:128
    v_mfma_f32_16x16x32_bf16 v[56:59], a[176:179], v[36:39], v[56:59]
    s_waitcnt vmcnt(16)
    ds_read_b64_tr_b16 v[220:221], v26 offset:9216
    v_mfma_f32_16x16x32_bf16 v[60:63], a[164:167], v[32:35], v[60:63]
    ds_read_b64_tr_b16 v[224:225], v27 offset:9216
    v_subrev_u32 v6, 57344, v6
    v_mfma_f32_16x16x32_bf16 v[60:63], a[180:183], v[36:39], v[60:63]
    ds_read_b128 v[48:51], v6 offset:0
    v_subrev_u32 v7, 57344, v7
    v_mfma_f32_16x16x32_bf16 v[64:67], a[168:171], v[32:35], v[64:67]
    ds_read_b128 v[52:55], v7 offset:1024
    v_mfma_f32_16x16x32_bf16 v[64:67], a[184:187], v[36:39], v[64:67]
    s_waitcnt lgkmcnt(6)
    v_mfma_f32_16x16x32_bf16 v[68:71], a[172:175], v[32:35], v[68:71]
    s_waitcnt vmcnt(15)
    ds_read_b64_tr_b16 v[222:223], v26 offset:0
    v_mfma_f32_16x16x32_bf16 v[68:71], a[188:191], v[36:39], v[68:71]
    ds_read_b64_tr_b16 v[226:227], v27 offset:0
    v_mfma_f32_16x16x32_bf16 v[56:59], a[192:195], v[40:43], v[56:59]
    s_waitcnt vmcnt(14)
    ds_read_b64_tr_b16 v[228:229], v5 offset:1024
    v_mfma_f32_16x16x32_bf16 v[56:59], a[208:211], v[44:47], v[56:59]
    ds_read_b64_tr_b16 v[230:231], v5 offset:1536
    v_mfma_f32_16x16x32_bf16 v[60:63], a[196:199], v[40:43], v[60:63]
    s_waitcnt vmcnt(13)
    ds_read_b64_tr_b16 v[232:233], v26 offset:2048
    v_mfma_f32_16x16x32_bf16 v[60:63], a[212:215], v[44:47], v[60:63]
    ds_read_b128 v[32:35], v6 offset:2048
    v_mfma_f32_16x16x32_bf16 v[64:67], a[200:203], v[40:43], v[64:67]
    ds_read_b128 v[36:39], v7 offset:3072
    v_mfma_f32_16x16x32_bf16 v[64:67], a[216:219], v[44:47], v[64:67]
    s_waitcnt lgkmcnt(7)
    ds_read_b64_tr_b16 v[236:237], v27 offset:2048
    v_mfma_f32_16x16x32_bf16 v[68:71], a[204:207], v[40:43], v[68:71]
    s_waitcnt vmcnt(12)
    ds_read_b64_tr_b16 v[234:235], v26 offset:3072
    v_mfma_f32_16x16x32_bf16 v[68:71], a[220:223], v[44:47], v[68:71]
    buffer_store_dwordx4 v[8:11], v19, s[24:27], s54 offen nt sc1
    v_mfma_f32_16x16x32_bf16 v[104:107], a[224:227], v[48:51], 0
    ds_read_b64_tr_b16 v[238:239], v27 offset:3072
    v_mfma_f32_16x16x32_bf16 v[104:107], a[236:239], v[52:55], v[104:107]
    ds_read_b128 v[40:43], v6 offset:4096
    v_mfma_f32_16x16x32_bf16 v[108:111], a[228:231], v[48:51], 0
    ds_read_b128 v[44:47], v7 offset:5120
    v_mfma_f32_16x16x32_bf16 v[108:111], a[240:243], v[52:55], v[108:111]
    s_waitcnt vmcnt(12)
    ds_read_b64_tr_b16 v[240:241], v5 offset:4096
    v_mfma_f32_16x16x32_bf16 v[112:115], a[232:235], v[48:51], 0
    ds_read_b64_tr_b16 v[242:243], v5 offset:4608
    v_mfma_f32_16x16x32_bf16 v[112:115], a[244:247], v[52:55], v[112:115]
    s_waitcnt lgkmcnt(7)
    v_mfma_f32_16x16x32_bf16 v[104:107], a[248:251], v[32:35], v[104:107]
    buffer_store_dwordx4 v[12:15], v20, s[24:27], s54 offen nt sc1
    v_mfma_f32_16x16x32_bf16 v[104:107], v[124:127], v[36:39], v[104:107]
    ds_read_b128 v[48:51], v6 offset:6144
    v_mfma_f32_16x16x32_bf16 v[108:111], a[252:255], v[32:35], v[108:111]
    ds_read_b128 v[52:55], v7 offset:7168
    v_mfma_f32_16x16x32_bf16 v[108:111], v[128:131], v[36:39], v[108:111]
    s_waitcnt vmcnt(12)
    ds_read_b64_tr_b16 v[244:245], v26 offset:5120
    v_mfma_f32_16x16x32_bf16 v[112:115], v[120:123], v[32:35], v[112:115]
    ds_read_b64_tr_b16 v[248:249], v27 offset:5120
    v_mfma_f32_16x16x32_bf16 v[112:115], v[132:135], v[36:39], v[112:115]
    s_waitcnt lgkmcnt(6)
    v_mfma_f32_16x16x32_bf16 v[104:107], v[136:139], v[40:43], v[104:107]
    s_waitcnt vmcnt(11)
    ds_read_b64_tr_b16 v[246:247], v26 offset:6144
    v_mfma_f32_16x16x32_bf16 v[104:107], v[148:151], v[44:47], v[104:107]
    ds_read_b128 v[32:35], v6 offset:8192
    v_mfma_f32_16x16x32_bf16 v[108:111], v[140:143], v[40:43], v[108:111]
    ds_read_b128 v[36:39], v7 offset:9216
    v_mfma_f32_16x16x32_bf16 v[108:111], v[152:155], v[44:47], v[108:111]
    ds_read_b64_tr_b16 v[250:251], v27 offset:6144
    v_mfma_f32_16x16x32_bf16 v[112:115], v[144:147], v[40:43], v[112:115]
    s_waitcnt vmcnt(10)
    ds_read_b64_tr_b16 v[252:253], v5 offset:7168
    v_mfma_f32_16x16x32_bf16 v[112:115], v[156:159], v[44:47], v[112:115]
    s_waitcnt lgkmcnt(7)
    ds_read_b64_tr_b16 v[254:255], v5 offset:7680
    v_mfma_f32_16x16x32_bf16 v[104:107], v[160:163], v[48:51], v[104:107]
    v_cvt_pk_bf16_f32 v72, v72, v73
    v_cvt_pk_bf16_f32 v73, v74, v75
    v_mfma_f32_16x16x32_bf16 v[104:107], v[172:175], v[52:55], v[104:107]
    ds_read_b128 v[40:43], v6 offset:10240
    v_mfma_f32_16x16x32_bf16 v[108:111], v[164:167], v[48:51], v[108:111]
    ds_read_b128 v[44:47], v7 offset:11264
    v_mfma_f32_16x16x32_bf16 v[108:111], v[176:179], v[52:55], v[108:111]
    ds_write_b64 v28, v[72:73]
    v_mfma_f32_16x16x32_bf16 v[112:115], v[168:171], v[48:51], v[112:115]
    v_cvt_pk_bf16_f32 v76, v76, v77
    v_cvt_pk_bf16_f32 v77, v78, v79
    v_mfma_f32_16x16x32_bf16 v[112:115], v[180:183], v[52:55], v[112:115]
    s_waitcnt lgkmcnt(6)
    ds_write_b64 v29, v[76:77]
    v_mfma_f32_16x16x32_bf16 v[104:107], v[184:187], v[32:35], v[104:107]
    v_cvt_pk_bf16_f32 v80, v80, v81
    v_cvt_pk_bf16_f32 v81, v82, v83
    v_mfma_f32_16x16x32_bf16 v[104:107], v[196:199], v[36:39], v[104:107]
    ds_read_b128 v[48:51], v6 offset:12288
    v_mfma_f32_16x16x32_bf16 v[108:111], v[188:191], v[32:35], v[108:111]
    ds_read_b128 v[52:55], v7 offset:13312
    v_mfma_f32_16x16x32_bf16 v[108:111], v[200:203], v[36:39], v[108:111]
    ds_write_b64 v30, v[80:81]
    v_mfma_f32_16x16x32_bf16 v[112:115], v[192:195], v[32:35], v[112:115]
    v_cvt_pk_bf16_f32 v84, v84, v85
    v_cvt_pk_bf16_f32 v85, v86, v87
    v_mfma_f32_16x16x32_bf16 v[112:115], v[204:207], v[36:39], v[112:115]
    s_waitcnt lgkmcnt(5)
    ds_write_b64 v31, v[84:85]
    v_mfma_f32_16x16x32_bf16 v[104:107], v[208:211], v[40:43], v[104:107]
    ds_read_b128 v[8:11], v18
    v_mfma_f32_16x16x32_bf16 v[104:107], v[220:223], v[44:47], v[104:107]
    ds_read_b128 v[32:35], v6 offset:14336
    v_mfma_f32_16x16x32_bf16 v[108:111], v[212:215], v[40:43], v[108:111]
    ds_read_b128 v[36:39], v7 offset:15360
    v_mfma_f32_16x16x32_bf16 v[108:111], v[224:227], v[44:47], v[108:111]
    ds_read2_b64 v[12:15], v18 offset0:129 offset1:128
    v_cvt_pk_bf16_f32 v88, v88, v89
    v_mfma_f32_16x16x32_bf16 v[112:115], v[216:219], v[40:43], v[112:115]
    v_cvt_pk_bf16_f32 v89, v90, v91
    v_mfma_f32_16x16x32_bf16 v[112:115], v[228:231], v[44:47], v[112:115]
    s_waitcnt lgkmcnt(6)
    ds_write_b64 v28, v[88:89]
    v_mfma_f32_16x16x32_bf16 v[104:107], v[232:235], v[48:51], v[104:107]
    v_cvt_pk_bf16_f32 v92, v92, v93
    v_cvt_pk_bf16_f32 v93, v94, v95
    v_mfma_f32_16x16x32_bf16 v[104:107], v[244:247], v[52:55], v[104:107]
    ds_read_b128 v[40:43], v6 offset:16384
    v_mfma_f32_16x16x32_bf16 v[108:111], v[236:239], v[48:51], v[108:111]
    ds_read_b128 v[44:47], v7 offset:17408
    v_mfma_f32_16x16x32_bf16 v[108:111], v[248:251], v[52:55], v[108:111]
    ds_write_b64 v29, v[92:93]
    v_mfma_f32_16x16x32_bf16 v[112:115], v[240:243], v[48:51], v[112:115]
    v_cvt_pk_bf16_f32 v96, v96, v97
    v_cvt_pk_bf16_f32 v97, v98, v99
    v_mfma_f32_16x16x32_bf16 v[112:115], v[252:255], v[52:55], v[112:115]
    s_waitcnt lgkmcnt(5)
    ds_write_b64 v30, v[96:97]
    v_mfma_f32_16x16x32_bf16 v[72:75], a[224:227], v[32:35], 0
    buffer_store_dwordx4 v[8:11], v19, s[24:27], s51 offen nt sc1
    v_mfma_f32_16x16x32_bf16 v[72:75], a[236:239], v[36:39], v[72:75]
    ds_read_b128 v[48:51], v6 offset:18432
    v_cvt_pk_bf16_f32 v100, v100, v101
    v_mfma_f32_16x16x32_bf16 v[76:79], a[228:231], v[32:35], 0
    ds_read_b128 v[52:55], v7 offset:19456
    v_cvt_pk_bf16_f32 v101, v102, v103
    v_mfma_f32_16x16x32_bf16 v[76:79], a[240:243], v[36:39], v[76:79]
    ds_write_b64 v31, v[100:101]
    v_mfma_f32_16x16x32_bf16 v[80:83], a[232:235], v[32:35], 0
    s_waitcnt lgkmcnt(8)
    buffer_store_dwordx4 v[12:15], v20, s[24:27], s51 offen nt sc1
    v_mfma_f32_16x16x32_bf16 v[80:83], a[244:247], v[36:39], v[80:83]
    s_waitcnt lgkmcnt(5)
    ds_read_b128 v[88:91], v18
    v_mfma_f32_16x16x32_bf16 v[72:75], a[248:251], v[40:43], v[72:75]
    ds_read2_b64 v[92:95], v18 offset0:129 offset1:128
    v_cvt_pk_bf16_f32 v56, v56, v57
    v_mfma_f32_16x16x32_bf16 v[72:75], v[124:127], v[44:47], v[72:75]
    ds_read_b128 v[32:35], v6 offset:20480
    v_cvt_pk_bf16_f32 v57, v58, v59
    v_mfma_f32_16x16x32_bf16 v[76:79], a[252:255], v[40:43], v[76:79]
    ds_read_b128 v[36:39], v7 offset:21504
    v_mfma_f32_16x16x32_bf16 v[76:79], v[128:131], v[44:47], v[76:79]
    ds_write_b64 v28, v[56:57]
    v_mfma_f32_16x16x32_bf16 v[80:83], v[120:123], v[40:43], v[80:83]
    v_cvt_pk_bf16_f32 v60, v60, v61
    v_cvt_pk_bf16_f32 v61, v62, v63
    v_mfma_f32_16x16x32_bf16 v[80:83], v[132:135], v[44:47], v[80:83]
    s_waitcnt lgkmcnt(6)
    ds_write_b64 v29, v[60:61]
    v_mfma_f32_16x16x32_bf16 v[72:75], v[136:139], v[48:51], v[72:75]
    v_cvt_pk_bf16_f32 v64, v64, v65
    v_cvt_pk_bf16_f32 v65, v66, v67
    v_mfma_f32_16x16x32_bf16 v[72:75], v[148:151], v[52:55], v[72:75]
    ds_read_b128 v[40:43], v6 offset:22528
    v_mfma_f32_16x16x32_bf16 v[76:79], v[140:143], v[48:51], v[76:79]
    ds_read_b128 v[44:47], v7 offset:23552
    v_mfma_f32_16x16x32_bf16 v[76:79], v[152:155], v[52:55], v[76:79]
    ds_write_b64 v30, v[64:65]
    v_mfma_f32_16x16x32_bf16 v[80:83], v[144:147], v[48:51], v[80:83]
    s_waitcnt lgkmcnt(8)
    buffer_store_dwordx4 v[88:91], v19, s[24:27], s56 offen nt sc1
    v_mfma_f32_16x16x32_bf16 v[80:83], v[156:159], v[52:55], v[80:83]
    s_waitcnt lgkmcnt(5)
    v_cvt_pk_bf16_f32 v68, v68, v69
    v_cvt_pk_bf16_f32 v69, v70, v71
    v_mfma_f32_16x16x32_bf16 v[72:75], v[160:163], v[32:35], v[72:75]
    ds_write_b64 v31, v[68:69]
    v_mfma_f32_16x16x32_bf16 v[72:75], v[172:175], v[36:39], v[72:75]
    ds_read_b128 v[48:51], v6 offset:24576
    v_mfma_f32_16x16x32_bf16 v[76:79], v[164:167], v[32:35], v[76:79]
    ds_read_b128 v[52:55], v7 offset:25600
    v_mfma_f32_16x16x32_bf16 v[76:79], v[176:179], v[36:39], v[76:79]
    buffer_store_dwordx4 v[92:95], v20, s[24:27], s56 offen nt sc1
    v_mfma_f32_16x16x32_bf16 v[80:83], v[168:171], v[32:35], v[80:83]
    ds_read_b128 v[56:59], v18
    v_mfma_f32_16x16x32_bf16 v[80:83], v[180:183], v[36:39], v[80:83]
    s_waitcnt lgkmcnt(5)
    ds_read2_b64 v[60:63], v18 offset0:129 offset1:128
    v_mfma_f32_16x16x32_bf16 v[72:75], v[184:187], v[40:43], v[72:75]
    s_barrier
    v_cvt_pk_bf16_f32 v104, v104, v105
    v_mfma_f32_16x16x32_bf16 v[72:75], v[196:199], v[44:47], v[72:75]
    ds_read_b128 v[32:35], v6 offset:26624
    v_cvt_pk_bf16_f32 v105, v106, v107
    v_mfma_f32_16x16x32_bf16 v[76:79], v[188:191], v[40:43], v[76:79]
    ds_read_b128 v[36:39], v7 offset:27648
    v_mfma_f32_16x16x32_bf16 v[76:79], v[200:203], v[44:47], v[76:79]
    ds_write_b64 v21, v[104:105] offset:0
    v_mfma_f32_16x16x32_bf16 v[80:83], v[192:195], v[40:43], v[80:83]
    v_cvt_pk_bf16_f32 v108, v108, v109
    v_cvt_pk_bf16_f32 v109, v110, v111
    v_mfma_f32_16x16x32_bf16 v[80:83], v[204:207], v[44:47], v[80:83]
    s_waitcnt lgkmcnt(5)
    ds_write_b64 v21, v[108:109] offset:32
    v_mfma_f32_16x16x32_bf16 v[72:75], v[208:211], v[48:51], v[72:75]
    v_cvt_pk_bf16_f32 v112, v112, v113
    v_cvt_pk_bf16_f32 v113, v114, v115
    v_mfma_f32_16x16x32_bf16 v[72:75], v[220:223], v[52:55], v[72:75]
    ds_read_b128 v[40:43], v6 offset:28672
    v_mfma_f32_16x16x32_bf16 v[76:79], v[212:215], v[48:51], v[76:79]
    ds_read_b128 v[44:47], v7 offset:29696
    v_mfma_f32_16x16x32_bf16 v[76:79], v[224:227], v[52:55], v[76:79]
    s_waitcnt lgkmcnt(7)
    buffer_store_dwordx4 v[56:59], v19, s[24:27], s57 offen nt sc1
    v_mfma_f32_16x16x32_bf16 v[80:83], v[216:219], v[48:51], v[80:83]
    ds_write_b64 v22, v[112:113] offset:0
    v_mfma_f32_16x16x32_bf16 v[80:83], v[228:231], v[52:55], v[80:83]
    s_waitcnt lgkmcnt(5)
    v_mfma_f32_16x16x32_bf16 v[72:75], v[232:235], v[32:35], v[72:75]
    v_mfma_f32_16x16x32_bf16 v[72:75], v[244:247], v[36:39], v[72:75]
    ds_read_b128 v[48:51], v6 offset:30720
    v_mfma_f32_16x16x32_bf16 v[76:79], v[236:239], v[32:35], v[76:79]
    ds_read_b128 v[52:55], v7 offset:31744
    v_mfma_f32_16x16x32_bf16 v[76:79], v[248:251], v[36:39], v[76:79]
    buffer_store_dwordx4 v[60:63], v20, s[24:27], s57 offen nt sc1
    v_mfma_f32_16x16x32_bf16 v[80:83], v[240:243], v[32:35], v[80:83]
    v_mfma_f32_16x16x32_bf16 v[80:83], v[252:255], v[36:39], v[80:83]
    s_waitcnt lgkmcnt(3)
    v_mfma_f32_16x16x32_bf16 v[88:91], a[224:227], v[40:43], 0
    v_mfma_f32_16x16x32_bf16 v[88:91], a[236:239], v[44:47], v[88:91]
    ds_read_b128 v[32:35], v6 offset:32768
    v_mfma_f32_16x16x32_bf16 v[92:95], a[228:231], v[40:43], 0
    ds_read_b128 v[36:39], v7 offset:33792
    v_mfma_f32_16x16x32_bf16 v[92:95], a[240:243], v[44:47], v[92:95]
    v_mfma_f32_16x16x32_bf16 v[96:99], a[232:235], v[40:43], 0
    v_cvt_pk_bf16_f32 v72, v72, v73
    v_cvt_pk_bf16_f32 v73, v74, v75
    v_mfma_f32_16x16x32_bf16 v[96:99], a[244:247], v[44:47], v[96:99]
    s_waitcnt lgkmcnt(2)
    ds_write_b64 v21, v[72:73] offset:12288
    v_mfma_f32_16x16x32_bf16 v[88:91], a[248:251], v[48:51], v[88:91]
    v_cvt_pk_bf16_f32 v76, v76, v77
    v_cvt_pk_bf16_f32 v77, v78, v79
    v_mfma_f32_16x16x32_bf16 v[88:91], v[124:127], v[52:55], v[88:91]
    ds_read_b128 v[40:43], v6 offset:34816
    v_mfma_f32_16x16x32_bf16 v[92:95], a[252:255], v[48:51], v[92:95]
    ds_read_b128 v[44:47], v7 offset:35840
    v_mfma_f32_16x16x32_bf16 v[92:95], v[128:131], v[52:55], v[92:95]
    ds_write_b64 v21, v[76:77] offset:12320
    v_mfma_f32_16x16x32_bf16 v[96:99], v[120:123], v[48:51], v[96:99]
    v_cvt_pk_bf16_f32 v80, v80, v81
    v_cvt_pk_bf16_f32 v81, v82, v83
    v_mfma_f32_16x16x32_bf16 v[96:99], v[132:135], v[52:55], v[96:99]
    s_waitcnt lgkmcnt(4)
    ds_write_b64 v22, v[80:81] offset:12288
    v_mfma_f32_16x16x32_bf16 v[88:91], v[136:139], v[32:35], v[88:91]
    v_mfma_f32_16x16x32_bf16 v[88:91], v[148:151], v[36:39], v[88:91]
    ds_read_b128 v[48:51], v6 offset:36864
    v_mfma_f32_16x16x32_bf16 v[92:95], v[140:143], v[32:35], v[92:95]
    ds_read_b128 v[52:55], v7 offset:37888
    v_mfma_f32_16x16x32_bf16 v[92:95], v[152:155], v[36:39], v[92:95]
    v_mfma_f32_16x16x32_bf16 v[96:99], v[144:147], v[32:35], v[96:99]
    v_mfma_f32_16x16x32_bf16 v[96:99], v[156:159], v[36:39], v[96:99]
    s_waitcnt lgkmcnt(4)
    s_waitcnt lgkmcnt(2)
    s_barrier
    v_mfma_f32_16x16x32_bf16 v[88:91], v[160:163], v[40:43], v[88:91]
    ds_read_b128 v[104:107], v23 offset:0
    v_mfma_f32_16x16x32_bf16 v[88:91], v[172:175], v[44:47], v[88:91]
    ds_read_b128 v[32:35], v6 offset:38912
    v_mfma_f32_16x16x32_bf16 v[92:95], v[164:167], v[40:43], v[92:95]
    ds_read_b128 v[36:39], v7 offset:39936
    v_mfma_f32_16x16x32_bf16 v[92:95], v[176:179], v[44:47], v[92:95]
    ds_read_b64 v[108:109], v24 offset:0
    v_mfma_f32_16x16x32_bf16 v[96:99], v[168:171], v[40:43], v[96:99]
    ds_read_b128 v[112:115], v23 offset:12288
    v_mfma_f32_16x16x32_bf16 v[96:99], v[180:183], v[44:47], v[96:99]
    s_waitcnt lgkmcnt(5)
    ds_read_b64 v[116:117], v24 offset:12288
    v_mfma_f32_16x16x32_bf16 v[88:91], v[184:187], v[48:51], v[88:91]
    v_mfma_f32_16x16x32_bf16 v[88:91], v[196:199], v[52:55], v[88:91]
    ds_read_b128 v[40:43], v6 offset:40960
    v_mfma_f32_16x16x32_bf16 v[92:95], v[188:191], v[48:51], v[92:95]
    ds_read_b128 v[44:47], v7 offset:41984
    v_mfma_f32_16x16x32_bf16 v[92:95], v[200:203], v[52:55], v[92:95]
    v_mfma_f32_16x16x32_bf16 v[96:99], v[192:195], v[48:51], v[96:99]
    v_mfma_f32_16x16x32_bf16 v[96:99], v[204:207], v[52:55], v[96:99]
    s_waitcnt lgkmcnt(5)
    v_mfma_f32_16x16x32_bf16 v[88:91], v[208:211], v[32:35], v[88:91]
    v_mfma_f32_16x16x32_bf16 v[88:91], v[220:223], v[36:39], v[88:91]
    ds_read_b128 v[48:51], v6 offset:43008
    v_mfma_f32_16x16x32_bf16 v[92:95], v[212:215], v[32:35], v[92:95]
    ds_read_b128 v[52:55], v7 offset:44032
    v_mfma_f32_16x16x32_bf16 v[92:95], v[224:227], v[36:39], v[92:95]
    buffer_store_dwordx4 v[104:107], v0, s[24:27], s50 offen offset:512 nt sc1
    v_mfma_f32_16x16x32_bf16 v[96:99], v[216:219], v[32:35], v[96:99]
    v_mfma_f32_16x16x32_bf16 v[96:99], v[228:231], v[36:39], v[96:99]
    s_waitcnt lgkmcnt(2)
    v_mfma_f32_16x16x32_bf16 v[88:91], v[232:235], v[40:43], v[88:91]
    v_mfma_f32_16x16x32_bf16 v[88:91], v[244:247], v[44:47], v[88:91]
    ds_read_b128 v[32:35], v6 offset:45056
    v_mfma_f32_16x16x32_bf16 v[92:95], v[236:239], v[40:43], v[92:95]
    ds_read_b128 v[36:39], v7 offset:46080
    v_mfma_f32_16x16x32_bf16 v[92:95], v[248:251], v[44:47], v[92:95]
    v_mfma_f32_16x16x32_bf16 v[96:99], v[240:243], v[40:43], v[96:99]
    v_mfma_f32_16x16x32_bf16 v[96:99], v[252:255], v[44:47], v[96:99]
    s_waitcnt lgkmcnt(2)
    v_mfma_f32_16x16x32_bf16 v[56:59], a[224:227], v[48:51], 0
    buffer_store_dwordx2 v[108:109], v1, s[24:27], s50 offen nt sc1
    v_mfma_f32_16x16x32_bf16 v[56:59], a[236:239], v[52:55], v[56:59]
    ds_read_b128 v[40:43], v6 offset:47104
    v_mfma_f32_16x16x32_bf16 v[60:63], a[228:231], v[48:51], 0
    ds_read_b128 v[44:47], v7 offset:48128
    v_mfma_f32_16x16x32_bf16 v[60:63], a[240:243], v[52:55], v[60:63]
    v_mfma_f32_16x16x32_bf16 v[64:67], a[232:235], v[48:51], 0
    v_cvt_pk_bf16_f32 v88, v88, v89
    v_cvt_pk_bf16_f32 v89, v90, v91
    v_mfma_f32_16x16x32_bf16 v[64:67], a[244:247], v[52:55], v[64:67]
    s_waitcnt lgkmcnt(2)
    ds_write_b64 v21, v[88:89] offset:24576
    v_mfma_f32_16x16x32_bf16 v[56:59], a[248:251], v[32:35], v[56:59]
    v_cvt_pk_bf16_f32 v92, v92, v93
    v_cvt_pk_bf16_f32 v93, v94, v95
    v_mfma_f32_16x16x32_bf16 v[56:59], v[124:127], v[36:39], v[56:59]
    ds_read_b128 v[48:51], v6 offset:49152
    v_mfma_f32_16x16x32_bf16 v[60:63], a[252:255], v[32:35], v[60:63]
    ds_read_b128 v[52:55], v7 offset:50176
    v_mfma_f32_16x16x32_bf16 v[60:63], v[128:131], v[36:39], v[60:63]
    buffer_store_dwordx4 v[112:115], v0, s[24:27], s51 offen offset:512 nt sc1
    v_mfma_f32_16x16x32_bf16 v[64:67], v[120:123], v[32:35], v[64:67]
    ds_write_b64 v21, v[92:93] offset:24608
    v_mfma_f32_16x16x32_bf16 v[64:67], v[132:135], v[36:39], v[64:67]
    s_waitcnt lgkmcnt(4)
    v_cvt_pk_bf16_f32 v96, v96, v97
    v_cvt_pk_bf16_f32 v97, v98, v99
    v_mfma_f32_16x16x32_bf16 v[56:59], v[136:139], v[40:43], v[56:59]
    ds_write_b64 v22, v[96:97] offset:24576
    v_mfma_f32_16x16x32_bf16 v[56:59], v[148:151], v[44:47], v[56:59]
    ds_read_b128 v[32:35], v6 offset:51200
    v_mfma_f32_16x16x32_bf16 v[60:63], v[140:143], v[40:43], v[60:63]
    ds_read_b128 v[36:39], v7 offset:52224
    v_mfma_f32_16x16x32_bf16 v[60:63], v[152:155], v[44:47], v[60:63]
    v_mfma_f32_16x16x32_bf16 v[64:67], v[144:147], v[40:43], v[64:67]
    v_mfma_f32_16x16x32_bf16 v[64:67], v[156:159], v[44:47], v[64:67]
    s_waitcnt lgkmcnt(4)
    v_mfma_f32_16x16x32_bf16 v[56:59], v[160:163], v[48:51], v[56:59]
    buffer_store_dwordx2 v[116:117], v1, s[24:27], s51 offen nt sc1
    v_mfma_f32_16x16x32_bf16 v[56:59], v[172:175], v[52:55], v[56:59]
    ds_read_b128 v[40:43], v6 offset:53248
    v_mfma_f32_16x16x32_bf16 v[60:63], v[164:167], v[48:51], v[60:63]
    ds_read_b128 v[44:47], v7 offset:54272
    v_mfma_f32_16x16x32_bf16 v[60:63], v[176:179], v[52:55], v[60:63]
    v_mfma_f32_16x16x32_bf16 v[64:67], v[168:171], v[48:51], v[64:67]
    v_mfma_f32_16x16x32_bf16 v[64:67], v[180:183], v[52:55], v[64:67]
    s_waitcnt lgkmcnt(2)
    v_mfma_f32_16x16x32_bf16 v[56:59], v[184:187], v[32:35], v[56:59]
    v_mfma_f32_16x16x32_bf16 v[56:59], v[196:199], v[36:39], v[56:59]
    ds_read_b128 v[48:51], v6 offset:55296
    v_mfma_f32_16x16x32_bf16 v[60:63], v[188:191], v[32:35], v[60:63]
    ds_read_b128 v[52:55], v7 offset:56320
    v_mfma_f32_16x16x32_bf16 v[60:63], v[200:203], v[36:39], v[60:63]
    v_mfma_f32_16x16x32_bf16 v[64:67], v[192:195], v[32:35], v[64:67]
    v_mfma_f32_16x16x32_bf16 v[64:67], v[204:207], v[36:39], v[64:67]
    s_waitcnt lgkmcnt(2)
    v_mfma_f32_16x16x32_bf16 v[56:59], v[208:211], v[40:43], v[56:59]
    v_add_u32 v6, 57344, v6
    v_mfma_f32_16x16x32_bf16 v[56:59], v[220:223], v[44:47], v[56:59]
    ds_read_b128 v[32:35], v6 offset:0
    v_add_u32 v7, 57344, v7
    v_mfma_f32_16x16x32_bf16 v[60:63], v[212:215], v[40:43], v[60:63]
    ds_read_b128 v[36:39], v7 offset:1024
    v_mfma_f32_16x16x32_bf16 v[60:63], v[224:227], v[44:47], v[60:63]
    v_mfma_f32_16x16x32_bf16 v[64:67], v[216:219], v[40:43], v[64:67]
    v_mfma_f32_16x16x32_bf16 v[64:67], v[228:231], v[44:47], v[64:67]
    s_waitcnt lgkmcnt(2)
    v_mfma_f32_16x16x32_bf16 v[56:59], v[232:235], v[48:51], v[56:59]
    v_mfma_f32_16x16x32_bf16 v[56:59], v[244:247], v[52:55], v[56:59]
    ds_read_b128 v[40:43], v6 offset:2048
    v_mfma_f32_16x16x32_bf16 v[60:63], v[236:239], v[48:51], v[60:63]
    ds_read_b128 v[44:47], v7 offset:3072
    v_mfma_f32_16x16x32_bf16 v[60:63], v[248:251], v[52:55], v[60:63]
    v_mfma_f32_16x16x32_bf16 v[64:67], v[240:243], v[48:51], v[64:67]
    v_mfma_f32_16x16x32_bf16 v[64:67], v[252:255], v[52:55], v[64:67]
    s_waitcnt lgkmcnt(2)
    v_mfma_f32_16x16x32_bf16 v[72:75], a[224:227], v[32:35], 0
    v_mfma_f32_16x16x32_bf16 v[72:75], a[236:239], v[36:39], v[72:75]
    ds_read_b128 v[48:51], v6 offset:4096
    v_mfma_f32_16x16x32_bf16 v[76:79], a[228:231], v[32:35], 0
    ds_read_b128 v[52:55], v7 offset:5120
    v_mfma_f32_16x16x32_bf16 v[76:79], a[240:243], v[36:39], v[76:79]
    v_mfma_f32_16x16x32_bf16 v[80:83], a[232:235], v[32:35], 0
    v_cvt_pk_bf16_f32 v56, v56, v57
    v_cvt_pk_bf16_f32 v57, v58, v59
    v_mfma_f32_16x16x32_bf16 v[80:83], a[244:247], v[36:39], v[80:83]
    s_waitcnt lgkmcnt(2)
    ds_write_b64 v21, v[56:57] offset:36864
    v_mfma_f32_16x16x32_bf16 v[72:75], a[248:251], v[40:43], v[72:75]
    v_cvt_pk_bf16_f32 v60, v60, v61
    v_cvt_pk_bf16_f32 v61, v62, v63
    v_mfma_f32_16x16x32_bf16 v[72:75], v[124:127], v[44:47], v[72:75]
    ds_read_b128 v[32:35], v6 offset:6144
    v_mfma_f32_16x16x32_bf16 v[76:79], a[252:255], v[40:43], v[76:79]
    ds_read_b128 v[36:39], v7 offset:7168
    v_mfma_f32_16x16x32_bf16 v[76:79], v[128:131], v[44:47], v[76:79]
    ds_write_b64 v21, v[60:61] offset:36896
    v_mfma_f32_16x16x32_bf16 v[80:83], v[120:123], v[40:43], v[80:83]
    v_cvt_pk_bf16_f32 v64, v64, v65
    v_cvt_pk_bf16_f32 v65, v66, v67
    v_mfma_f32_16x16x32_bf16 v[80:83], v[132:135], v[44:47], v[80:83]
    s_waitcnt lgkmcnt(4)
    ds_write_b64 v22, v[64:65] offset:36864
    v_mfma_f32_16x16x32_bf16 v[72:75], v[136:139], v[48:51], v[72:75]
    v_mfma_f32_16x16x32_bf16 v[72:75], v[148:151], v[52:55], v[72:75]
    ds_read_b128 v[40:43], v6 offset:8192
    v_mfma_f32_16x16x32_bf16 v[76:79], v[140:143], v[48:51], v[76:79]
    ds_read_b128 v[44:47], v7 offset:9216
    v_mfma_f32_16x16x32_bf16 v[76:79], v[152:155], v[52:55], v[76:79]
    v_mfma_f32_16x16x32_bf16 v[80:83], v[144:147], v[48:51], v[80:83]
    v_mfma_f32_16x16x32_bf16 v[80:83], v[156:159], v[52:55], v[80:83]
    s_waitcnt lgkmcnt(4)
    s_waitcnt lgkmcnt(2)
    s_barrier
    v_mfma_f32_16x16x32_bf16 v[72:75], v[160:163], v[32:35], v[72:75]
    ds_read_b128 v[104:107], v23 offset:24576
    v_mfma_f32_16x16x32_bf16 v[72:75], v[172:175], v[36:39], v[72:75]
    ds_read_b128 v[48:51], v6 offset:10240
    v_mfma_f32_16x16x32_bf16 v[76:79], v[164:167], v[32:35], v[76:79]
    ds_read_b128 v[52:55], v7 offset:11264
    v_mfma_f32_16x16x32_bf16 v[76:79], v[176:179], v[36:39], v[76:79]
    ds_read_b64 v[108:109], v24 offset:24576
    v_mfma_f32_16x16x32_bf16 v[80:83], v[168:171], v[32:35], v[80:83]
    ds_read_b128 v[112:115], v23 offset:36864
    v_mfma_f32_16x16x32_bf16 v[80:83], v[180:183], v[36:39], v[80:83]
    s_waitcnt lgkmcnt(5)
    ds_read_b64 v[116:117], v24 offset:36864
    v_mfma_f32_16x16x32_bf16 v[72:75], v[184:187], v[40:43], v[72:75]
    v_mfma_f32_16x16x32_bf16 v[72:75], v[196:199], v[44:47], v[72:75]
    ds_read_b128 v[32:35], v6 offset:12288
    v_mfma_f32_16x16x32_bf16 v[76:79], v[188:191], v[40:43], v[76:79]
    ds_read_b128 v[36:39], v7 offset:13312
    v_mfma_f32_16x16x32_bf16 v[76:79], v[200:203], v[44:47], v[76:79]
    v_mfma_f32_16x16x32_bf16 v[80:83], v[192:195], v[40:43], v[80:83]
    v_mfma_f32_16x16x32_bf16 v[80:83], v[204:207], v[44:47], v[80:83]
    s_waitcnt lgkmcnt(5)
    v_mfma_f32_16x16x32_bf16 v[72:75], v[208:211], v[48:51], v[72:75]
    v_mfma_f32_16x16x32_bf16 v[72:75], v[220:223], v[52:55], v[72:75]
    ds_read_b128 v[40:43], v6 offset:14336
    v_mfma_f32_16x16x32_bf16 v[76:79], v[212:215], v[48:51], v[76:79]
    ds_read_b128 v[44:47], v7 offset:15360
    v_mfma_f32_16x16x32_bf16 v[76:79], v[224:227], v[52:55], v[76:79]
    buffer_store_dwordx4 v[104:107], v0, s[24:27], s52 offen offset:512 nt sc1
    v_mfma_f32_16x16x32_bf16 v[80:83], v[216:219], v[48:51], v[80:83]
    v_mfma_f32_16x16x32_bf16 v[80:83], v[228:231], v[52:55], v[80:83]
    s_waitcnt lgkmcnt(2)
    v_mfma_f32_16x16x32_bf16 v[72:75], v[232:235], v[32:35], v[72:75]
    v_mfma_f32_16x16x32_bf16 v[72:75], v[244:247], v[36:39], v[72:75]
    ds_read_b128 v[48:51], v6 offset:16384
    v_mfma_f32_16x16x32_bf16 v[76:79], v[236:239], v[32:35], v[76:79]
    ds_read_b128 v[52:55], v7 offset:17408
    v_mfma_f32_16x16x32_bf16 v[76:79], v[248:251], v[36:39], v[76:79]
    v_mfma_f32_16x16x32_bf16 v[80:83], v[240:243], v[32:35], v[80:83]
    v_mfma_f32_16x16x32_bf16 v[80:83], v[252:255], v[36:39], v[80:83]
    s_waitcnt lgkmcnt(2)
    v_mfma_f32_16x16x32_bf16 v[88:91], a[224:227], v[40:43], 0
    buffer_store_dwordx2 v[108:109], v1, s[24:27], s52 offen nt sc1
    v_mfma_f32_16x16x32_bf16 v[88:91], a[236:239], v[44:47], v[88:91]
    ds_read_b128 v[32:35], v6 offset:18432
    v_mfma_f32_16x16x32_bf16 v[92:95], a[228:231], v[40:43], 0
    ds_read_b128 v[36:39], v7 offset:19456
    v_mfma_f32_16x16x32_bf16 v[92:95], a[240:243], v[44:47], v[92:95]
    v_mfma_f32_16x16x32_bf16 v[96:99], a[232:235], v[40:43], 0
    v_cvt_pk_bf16_f32 v72, v72, v73
    v_cvt_pk_bf16_f32 v73, v74, v75
    v_mfma_f32_16x16x32_bf16 v[96:99], a[244:247], v[44:47], v[96:99]
    s_waitcnt lgkmcnt(2)
    ds_write_b64 v21, v[72:73] offset:0
    v_mfma_f32_16x16x32_bf16 v[88:91], a[248:251], v[48:51], v[88:91]
    v_cvt_pk_bf16_f32 v76, v76, v77
    v_cvt_pk_bf16_f32 v77, v78, v79
    v_mfma_f32_16x16x32_bf16 v[88:91], v[124:127], v[52:55], v[88:91]
    ds_read_b128 v[40:43], v6 offset:20480
    v_mfma_f32_16x16x32_bf16 v[92:95], a[252:255], v[48:51], v[92:95]
    ds_read_b128 v[44:47], v7 offset:21504
    v_mfma_f32_16x16x32_bf16 v[92:95], v[128:131], v[52:55], v[92:95]
    buffer_store_dwordx4 v[112:115], v0, s[24:27], s53 offen offset:512 nt sc1
    v_mfma_f32_16x16x32_bf16 v[96:99], v[120:123], v[48:51], v[96:99]
    ds_write_b64 v21, v[76:77] offset:32
    v_mfma_f32_16x16x32_bf16 v[96:99], v[132:135], v[52:55], v[96:99]
    s_waitcnt lgkmcnt(4)
    v_cvt_pk_bf16_f32 v80, v80, v81
    v_cvt_pk_bf16_f32 v81, v82, v83
    v_mfma_f32_16x16x32_bf16 v[88:91], v[136:139], v[32:35], v[88:91]
    ds_write_b64 v22, v[80:81] offset:0
    v_mfma_f32_16x16x32_bf16 v[88:91], v[148:151], v[36:39], v[88:91]
    ds_read_b128 v[48:51], v6 offset:22528
    v_mfma_f32_16x16x32_bf16 v[92:95], v[140:143], v[32:35], v[92:95]
    ds_read_b128 v[52:55], v7 offset:23552
    v_mfma_f32_16x16x32_bf16 v[92:95], v[152:155], v[36:39], v[92:95]
    v_mfma_f32_16x16x32_bf16 v[96:99], v[144:147], v[32:35], v[96:99]
    v_mfma_f32_16x16x32_bf16 v[96:99], v[156:159], v[36:39], v[96:99]
    s_waitcnt lgkmcnt(4)
    v_mfma_f32_16x16x32_bf16 v[88:91], v[160:163], v[40:43], v[88:91]
    buffer_store_dwordx2 v[116:117], v1, s[24:27], s53 offen nt sc1
    v_mfma_f32_16x16x32_bf16 v[88:91], v[172:175], v[44:47], v[88:91]
    ds_read_b128 v[32:35], v6 offset:24576
    v_mfma_f32_16x16x32_bf16 v[92:95], v[164:167], v[40:43], v[92:95]
    ds_read_b128 v[36:39], v7 offset:25600
    v_mfma_f32_16x16x32_bf16 v[92:95], v[176:179], v[44:47], v[92:95]
    v_mfma_f32_16x16x32_bf16 v[96:99], v[168:171], v[40:43], v[96:99]
    v_mfma_f32_16x16x32_bf16 v[96:99], v[180:183], v[44:47], v[96:99]
    s_waitcnt lgkmcnt(2)
    v_mfma_f32_16x16x32_bf16 v[88:91], v[184:187], v[48:51], v[88:91]
    v_mfma_f32_16x16x32_bf16 v[88:91], v[196:199], v[52:55], v[88:91]
    ds_read_b128 v[40:43], v6 offset:26624
    v_mfma_f32_16x16x32_bf16 v[92:95], v[188:191], v[48:51], v[92:95]
    ds_read_b128 v[44:47], v7 offset:27648
    v_mfma_f32_16x16x32_bf16 v[92:95], v[200:203], v[52:55], v[92:95]
    v_mfma_f32_16x16x32_bf16 v[96:99], v[192:195], v[48:51], v[96:99]
    v_mfma_f32_16x16x32_bf16 v[96:99], v[204:207], v[52:55], v[96:99]
    s_waitcnt lgkmcnt(2)
    v_mfma_f32_16x16x32_bf16 v[88:91], v[208:211], v[32:35], v[88:91]
    v_mfma_f32_16x16x32_bf16 v[88:91], v[220:223], v[36:39], v[88:91]
    ds_read_b128 v[48:51], v6 offset:28672
    v_mfma_f32_16x16x32_bf16 v[92:95], v[212:215], v[32:35], v[92:95]
    ds_read_b128 v[52:55], v7 offset:29696
    v_mfma_f32_16x16x32_bf16 v[92:95], v[224:227], v[36:39], v[92:95]
    v_mfma_f32_16x16x32_bf16 v[96:99], v[216:219], v[32:35], v[96:99]
    v_mfma_f32_16x16x32_bf16 v[96:99], v[228:231], v[36:39], v[96:99]
    s_waitcnt lgkmcnt(2)
    v_mfma_f32_16x16x32_bf16 v[88:91], v[232:235], v[40:43], v[88:91]
    v_mfma_f32_16x16x32_bf16 v[88:91], v[244:247], v[44:47], v[88:91]
    ds_read_b128 v[32:35], v6 offset:30720
    v_mfma_f32_16x16x32_bf16 v[92:95], v[236:239], v[40:43], v[92:95]
    ds_read_b128 v[36:39], v7 offset:31744
    v_mfma_f32_16x16x32_bf16 v[92:95], v[248:251], v[44:47], v[92:95]
    v_mfma_f32_16x16x32_bf16 v[96:99], v[240:243], v[40:43], v[96:99]
    v_mfma_f32_16x16x32_bf16 v[96:99], v[252:255], v[44:47], v[96:99]
    s_waitcnt lgkmcnt(2)
    v_mfma_f32_16x16x32_bf16 v[56:59], a[224:227], v[48:51], 0
    v_mfma_f32_16x16x32_bf16 v[56:59], a[236:239], v[52:55], v[56:59]
    ds_read_b128 v[40:43], v6 offset:32768
    v_mfma_f32_16x16x32_bf16 v[60:63], a[228:231], v[48:51], 0
    ds_read_b128 v[44:47], v7 offset:33792
    v_mfma_f32_16x16x32_bf16 v[60:63], a[240:243], v[52:55], v[60:63]
    v_mfma_f32_16x16x32_bf16 v[64:67], a[232:235], v[48:51], 0
    v_cvt_pk_bf16_f32 v88, v88, v89
    v_cvt_pk_bf16_f32 v89, v90, v91
    v_mfma_f32_16x16x32_bf16 v[64:67], a[244:247], v[52:55], v[64:67]
    s_waitcnt lgkmcnt(2)
    ds_write_b64 v21, v[88:89] offset:12288
    v_mfma_f32_16x16x32_bf16 v[56:59], a[248:251], v[32:35], v[56:59]
    v_cvt_pk_bf16_f32 v92, v92, v93
    v_cvt_pk_bf16_f32 v93, v94, v95
    v_mfma_f32_16x16x32_bf16 v[56:59], v[124:127], v[36:39], v[56:59]
    ds_read_b128 v[48:51], v6 offset:34816
    v_mfma_f32_16x16x32_bf16 v[60:63], a[252:255], v[32:35], v[60:63]
    ds_read_b128 v[52:55], v7 offset:35840
    v_mfma_f32_16x16x32_bf16 v[60:63], v[128:131], v[36:39], v[60:63]
    ds_write_b64 v21, v[92:93] offset:12320
    v_mfma_f32_16x16x32_bf16 v[64:67], v[120:123], v[32:35], v[64:67]
    v_cvt_pk_bf16_f32 v96, v96, v97
    v_cvt_pk_bf16_f32 v97, v98, v99
    v_mfma_f32_16x16x32_bf16 v[64:67], v[132:135], v[36:39], v[64:67]
    s_waitcnt lgkmcnt(4)
    ds_write_b64 v22, v[96:97] offset:12288
    v_mfma_f32_16x16x32_bf16 v[56:59], v[136:139], v[40:43], v[56:59]
    v_mfma_f32_16x16x32_bf16 v[56:59], v[148:151], v[44:47], v[56:59]
    ds_read_b128 v[32:35], v6 offset:36864
    v_mfma_f32_16x16x32_bf16 v[60:63], v[140:143], v[40:43], v[60:63]
    ds_read_b128 v[36:39], v7 offset:37888
    v_mfma_f32_16x16x32_bf16 v[60:63], v[152:155], v[44:47], v[60:63]
    v_mfma_f32_16x16x32_bf16 v[64:67], v[144:147], v[40:43], v[64:67]
    v_mfma_f32_16x16x32_bf16 v[64:67], v[156:159], v[44:47], v[64:67]
    s_waitcnt lgkmcnt(4)
    s_waitcnt lgkmcnt(2)
    s_barrier
    v_mfma_f32_16x16x32_bf16 v[56:59], v[160:163], v[48:51], v[56:59]
    ds_read_b128 v[104:107], v23 offset:0
    v_mfma_f32_16x16x32_bf16 v[56:59], v[172:175], v[52:55], v[56:59]
    ds_read_b128 v[40:43], v6 offset:38912
    v_mfma_f32_16x16x32_bf16 v[60:63], v[164:167], v[48:51], v[60:63]
    ds_read_b128 v[44:47], v7 offset:39936
    v_mfma_f32_16x16x32_bf16 v[60:63], v[176:179], v[52:55], v[60:63]
    ds_read_b64 v[108:109], v24 offset:0
    v_mfma_f32_16x16x32_bf16 v[64:67], v[168:171], v[48:51], v[64:67]
    ds_read_b128 v[112:115], v23 offset:12288
    v_mfma_f32_16x16x32_bf16 v[64:67], v[180:183], v[52:55], v[64:67]
    s_waitcnt lgkmcnt(5)
    ds_read_b64 v[116:117], v24 offset:12288
    v_mfma_f32_16x16x32_bf16 v[56:59], v[184:187], v[32:35], v[56:59]
    v_mfma_f32_16x16x32_bf16 v[56:59], v[196:199], v[36:39], v[56:59]
    ds_read_b128 v[48:51], v6 offset:40960
    v_mfma_f32_16x16x32_bf16 v[60:63], v[188:191], v[32:35], v[60:63]
    ds_read_b128 v[52:55], v7 offset:41984
    v_mfma_f32_16x16x32_bf16 v[60:63], v[200:203], v[36:39], v[60:63]
    v_mfma_f32_16x16x32_bf16 v[64:67], v[192:195], v[32:35], v[64:67]
    v_mfma_f32_16x16x32_bf16 v[64:67], v[204:207], v[36:39], v[64:67]
    s_waitcnt lgkmcnt(5)
    v_mfma_f32_16x16x32_bf16 v[56:59], v[208:211], v[40:43], v[56:59]
    v_mfma_f32_16x16x32_bf16 v[56:59], v[220:223], v[44:47], v[56:59]
    ds_read_b128 v[32:35], v6 offset:43008
    v_mfma_f32_16x16x32_bf16 v[60:63], v[212:215], v[40:43], v[60:63]
    ds_read_b128 v[36:39], v7 offset:44032
    v_mfma_f32_16x16x32_bf16 v[60:63], v[224:227], v[44:47], v[60:63]
    buffer_store_dwordx4 v[104:107], v0, s[24:27], s54 offen offset:512 nt sc1
    v_mfma_f32_16x16x32_bf16 v[64:67], v[216:219], v[40:43], v[64:67]
    v_mfma_f32_16x16x32_bf16 v[64:67], v[228:231], v[44:47], v[64:67]
    s_waitcnt lgkmcnt(2)
    v_mfma_f32_16x16x32_bf16 v[56:59], v[232:235], v[48:51], v[56:59]
    v_mfma_f32_16x16x32_bf16 v[56:59], v[244:247], v[52:55], v[56:59]
    ds_read_b128 v[40:43], v6 offset:45056
    v_mfma_f32_16x16x32_bf16 v[60:63], v[236:239], v[48:51], v[60:63]
    ds_read_b128 v[44:47], v7 offset:46080
    v_mfma_f32_16x16x32_bf16 v[60:63], v[248:251], v[52:55], v[60:63]
    v_mfma_f32_16x16x32_bf16 v[64:67], v[240:243], v[48:51], v[64:67]
    buffer_store_dwordx2 v[108:109], v1, s[24:27], s54 offen nt sc1
    v_mfma_f32_16x16x32_bf16 v[64:67], v[252:255], v[52:55], v[64:67]
    s_waitcnt lgkmcnt(2)
    v_mfma_f32_16x16x32_bf16 v[72:75], a[224:227], v[32:35], 0
    v_mfma_f32_16x16x32_bf16 v[72:75], a[236:239], v[36:39], v[72:75]
    ds_read_b128 v[48:51], v6 offset:47104
    v_mfma_f32_16x16x32_bf16 v[76:79], a[228:231], v[32:35], 0
    ds_read_b128 v[52:55], v7 offset:48128
    v_mfma_f32_16x16x32_bf16 v[76:79], a[240:243], v[36:39], v[76:79]
    v_mfma_f32_16x16x32_bf16 v[80:83], a[232:235], v[32:35], 0
    v_cvt_pk_bf16_f32 v56, v56, v57
    v_cvt_pk_bf16_f32 v57, v58, v59
    v_mfma_f32_16x16x32_bf16 v[80:83], a[244:247], v[36:39], v[80:83]
    s_waitcnt lgkmcnt(2)
    ds_write_b64 v21, v[56:57] offset:24576
    v_mfma_f32_16x16x32_bf16 v[72:75], a[248:251], v[40:43], v[72:75]
    buffer_store_dwordx4 v[112:115], v0, s[24:27], s55 offen offset:512 nt sc1
    v_mfma_f32_16x16x32_bf16 v[72:75], v[124:127], v[44:47], v[72:75]
    ds_read_b128 v[32:35], v6 offset:49152
    v_cvt_pk_bf16_f32 v60, v60, v61
    v_mfma_f32_16x16x32_bf16 v[76:79], a[252:255], v[40:43], v[76:79]
    ds_read_b128 v[36:39], v7 offset:50176
    v_cvt_pk_bf16_f32 v61, v62, v63
    v_mfma_f32_16x16x32_bf16 v[76:79], v[128:131], v[44:47], v[76:79]
    ds_write_b64 v21, v[60:61] offset:24608
    v_mfma_f32_16x16x32_bf16 v[80:83], v[120:123], v[40:43], v[80:83]
    v_cvt_pk_bf16_f32 v64, v64, v65
    v_cvt_pk_bf16_f32 v65, v66, v67
    v_mfma_f32_16x16x32_bf16 v[80:83], v[132:135], v[44:47], v[80:83]
    s_waitcnt lgkmcnt(4)
    ds_write_b64 v22, v[64:65] offset:24576
    v_mfma_f32_16x16x32_bf16 v[72:75], v[136:139], v[48:51], v[72:75]
    v_mfma_f32_16x16x32_bf16 v[72:75], v[148:151], v[52:55], v[72:75]
    ds_read_b128 v[40:43], v6 offset:51200
    v_mfma_f32_16x16x32_bf16 v[76:79], v[140:143], v[48:51], v[76:79]
    ds_read_b128 v[44:47], v7 offset:52224
    v_mfma_f32_16x16x32_bf16 v[76:79], v[152:155], v[52:55], v[76:79]
    buffer_store_dwordx2 v[116:117], v1, s[24:27], s55 offen nt sc1
    v_mfma_f32_16x16x32_bf16 v[80:83], v[144:147], v[48:51], v[80:83]
    v_mfma_f32_16x16x32_bf16 v[80:83], v[156:159], v[52:55], v[80:83]
    s_waitcnt lgkmcnt(4)
    s_waitcnt lgkmcnt(2)
    s_barrier
    v_mfma_f32_16x16x32_bf16 v[72:75], v[160:163], v[32:35], v[72:75]
    ds_read_b128 v[104:107], v23 offset:24576
    v_mfma_f32_16x16x32_bf16 v[72:75], v[172:175], v[36:39], v[72:75]
    ds_read_b128 v[48:51], v6 offset:53248
    v_mfma_f32_16x16x32_bf16 v[76:79], v[164:167], v[32:35], v[76:79]
    ds_read_b128 v[52:55], v7 offset:54272
    v_mfma_f32_16x16x32_bf16 v[76:79], v[176:179], v[36:39], v[76:79]
    ds_read_b64 v[108:109], v24 offset:24576
    v_mfma_f32_16x16x32_bf16 v[80:83], v[168:171], v[32:35], v[80:83]
    v_mfma_f32_16x16x32_bf16 v[80:83], v[180:183], v[36:39], v[80:83]
    s_waitcnt lgkmcnt(4)
    v_mfma_f32_16x16x32_bf16 v[72:75], v[184:187], v[40:43], v[72:75]
    v_mfma_f32_16x16x32_bf16 v[72:75], v[196:199], v[44:47], v[72:75]
    ds_read_b128 v[32:35], v6 offset:55296
    v_mfma_f32_16x16x32_bf16 v[76:79], v[188:191], v[40:43], v[76:79]
    ds_read_b128 v[36:39], v7 offset:56320
    v_mfma_f32_16x16x32_bf16 v[76:79], v[200:203], v[44:47], v[76:79]
    v_mfma_f32_16x16x32_bf16 v[80:83], v[192:195], v[40:43], v[80:83]
    v_mfma_f32_16x16x32_bf16 v[80:83], v[204:207], v[44:47], v[80:83]
    s_waitcnt lgkmcnt(3)
    v_mfma_f32_16x16x32_bf16 v[72:75], v[208:211], v[48:51], v[72:75]
    buffer_store_dwordx4 v[104:107], v0, s[24:27], s56 offen offset:512 nt sc1
    v_mfma_f32_16x16x32_bf16 v[72:75], v[220:223], v[52:55], v[72:75]
    v_mfma_f32_16x16x32_bf16 v[76:79], v[212:215], v[48:51], v[76:79]
    v_mfma_f32_16x16x32_bf16 v[76:79], v[224:227], v[52:55], v[76:79]
    v_mfma_f32_16x16x32_bf16 v[80:83], v[216:219], v[48:51], v[80:83]
    s_waitcnt lgkmcnt(2)
    buffer_store_dwordx2 v[108:109], v1, s[24:27], s56 offen nt sc1
    v_mfma_f32_16x16x32_bf16 v[80:83], v[228:231], v[52:55], v[80:83]
    s_waitcnt lgkmcnt(0)
    v_mfma_f32_16x16x32_bf16 v[72:75], v[232:235], v[32:35], v[72:75]
    v_mfma_f32_16x16x32_bf16 v[72:75], v[244:247], v[36:39], v[72:75]
    v_mfma_f32_16x16x32_bf16 v[76:79], v[236:239], v[32:35], v[76:79]
    v_mfma_f32_16x16x32_bf16 v[76:79], v[248:251], v[36:39], v[76:79]
    v_mfma_f32_16x16x32_bf16 v[80:83], v[240:243], v[32:35], v[80:83]
    v_mfma_f32_16x16x32_bf16 v[80:83], v[252:255], v[36:39], v[80:83]
    s_nop 3
    v_cvt_pk_bf16_f32 v72, v72, v73
    v_cvt_pk_bf16_f32 v73, v74, v75
    ds_write_b64 v21, v[72:73] offset:36864
    v_cvt_pk_bf16_f32 v76, v76, v77
    v_cvt_pk_bf16_f32 v77, v78, v79
    ds_write_b64 v21, v[76:77] offset:36896
    v_cvt_pk_bf16_f32 v80, v80, v81
    v_cvt_pk_bf16_f32 v81, v82, v83
    ds_write_b64 v22, v[80:81] offset:36864
    s_waitcnt lgkmcnt(0)
    s_barrier
    ds_read_b128 v[112:115], v23 offset:36864
    ds_read_b64 v[116:117], v24 offset:36864
    s_waitcnt lgkmcnt(1)
    buffer_store_dwordx4 v[112:115], v0, s[24:27], s57 offen offset:512 nt sc1
    s_waitcnt lgkmcnt(0)
    buffer_store_dwordx2 v[116:117], v1, s[24:27], s57 offen nt sc1
    s_endpgm
.p2align 6
L_cls1:
    v_dot2_f32_bf16 v193, v130, s42, v17 neg_lo:[0,0,1]
    v_dot2_f32_bf16 v194, v131, s41, v17 neg_lo:[0,0,1]
    v_dot2_f32_bf16 v195, v131, s42, v17 neg_lo:[0,0,1]
    v_dot2_f32_bf16 v196, v132, s41, v17 neg_lo:[0,0,1]
    v_dot2_f32_bf16 v197, v132, s42, v17 neg_lo:[0,0,1]
    v_dot2_f32_bf16 v198, v133, s41, v17 neg_lo:[0,0,1]
    v_dot2_f32_bf16 v199, v133, s42, v17 neg_lo:[0,0,1]
    s_waitcnt vmcnt(8)
    s_nop 0
    ds_read_b128 v[72:75], v68 offset:0
    ds_read_b128 v[76:79], v68 offset:256
    ds_read_b128 v[80:83], v68 offset:512
    ds_read_b64 v[84:85], v69 offset:768
    ds_read_b128 v[86:89], v68 offset:1024
    ds_read_b128 v[90:93], v68 offset:1280
    ds_read_b128 v[94:97], v68 offset:1536
    ds_read_b64 v[98:99], v69 offset:1792
    v_pk_mul_f32 v[120:121], v[172:173], v[172:173]
    v_pk_fma_f32 v[120:121], v[174:175], v[174:175], v[120:121]
    v_pk_fma_f32 v[120:121], v[176:177], v[176:177], v[120:121]
    v_pk_fma_f32 v[120:121], v[178:179], v[178:179], v[120:121]
    v_pk_fma_f32 v[120:121], v[180:181], v[180:181], v[120:121]
    v_pk_fma_f32 v[120:121], v[182:183], v[182:183], v[120:121]
    v_pk_fma_f32 v[120:121], v[184:185], v[184:185], v[120:121]
    v_pk_fma_f32 v[120:121], v[186:187], v[186:187], v[120:121]
    v_pk_fma_f32 v[120:121], v[188:189], v[188:189], v[120:121]
    v_pk_fma_f32 v[120:121], v[190:191], v[190:191], v[120:121]
    v_pk_fma_f32 v[120:121], v[192:193], v[192:193], v[120:121]
    v_pk_fma_f32 v[120:121], v[194:195], v[194:195], v[120:121]
    v_pk_fma_f32 v[120:121], v[196:197], v[196:197], v[120:121]
    v_pk_fma_f32 v[120:121], v[198:199], v[198:199], v[120:121]
    s_waitcnt lgkmcnt(0)
    v_lshlrev_b32 v228, 16, v72
    v_and_b32 v229, s40, v72
    v_lshlrev_b32 v230, 16, v73
    v_and_b32 v231, s40, v73
    v_lshlrev_b32 v232, 16, v74
    v_and_b32 v233, s40, v74
    v_lshlrev_b32 v234, 16, v75
    v_and_b32 v235, s40, v75
    v_lshlrev_b32 v236, 16, v76
    v_and_b32 v237, s40, v76
    v_lshlrev_b32 v238, 16, v77
    v_and_b32 v239, s40, v77
    v_lshlrev_b32 v240, 16, v78
    v_and_b32 v241, s40, v78
    v_lshlrev_b32 v242, 16, v79
    v_and_b32 v243, s40, v79
    v_lshlrev_b32 v244, 16, v80
    v_and_b32 v245, s40, v80
    v_lshlrev_b32 v246, 16, v81
    v_and_b32 v247, s40, v81
    v_lshlrev_b32 v248, 16, v82
    v_and_b32 v249, s40, v82
    v_lshlrev_b32 v250, 16, v83
    v_and_b32 v251, s40, v83
    v_lshlrev_b32 v252, 16, v84
    v_and_b32 v253, s40, v84
    v_lshlrev_b32 v254, 16, v85
    v_and_b32 v255, s40, v85
    v_lshlrev_b32 v200, 16, v86
    v_and_b32 v201, s40, v86
    v_lshlrev_b32 v202, 16, v87
    v_and_b32 v203, s40, v87
    v_lshlrev_b32 v204, 16, v88
    v_and_b32 v205, s40, v88
    v_lshlrev_b32 v206, 16, v89
    v_and_b32 v207, s40, v89
    v_lshlrev_b32 v208, 16, v90
    v_and_b32 v209, s40, v90
    v_lshlrev_b32 v210, 16, v91
    v_and_b32 v211, s40, v91
    v_lshlrev_b32 v212, 16, v92
    v_and_b32 v213, s40, v92
    v_lshlrev_b32 v214, 16, v93
    v_and_b32 v215, s40, v93
    v_lshlrev_b32 v216, 16, v94
    v_and_b32 v217, s40, v94
    v_lshlrev_b32 v218, 16, v95
    v_and_b32 v219, s40, v95
    v_lshlrev_b32 v220, 16, v96
    v_and_b32 v221, s40, v96
    v_lshlrev_b32 v222, 16, v97
    v_and_b32 v223, s40, v97
    v_lshlrev_b32 v224, 16, v98
    v_and_b32 v225, s40, v98
    v_lshlrev_b32 v226, 16, v99
    v_and_b32 v227, s40, v99
    v_add_f32 v120, v120, v121
    v_pk_mul_f32 v[172:173], v[172:173], v[228:229]
    v_pk_mul_f32 v[174:175], v[174:175], v[230:231]
    v_add_f32_dpp v120, v120, v120 row_ror:8 row_mask:0xf bank_mask:0xf
    v_pk_mul_f32 v[176:177], v[176:177], v[232:233]
    v_pk_mul_f32 v[178:179], v[178:179], v[234:235]
    v_add_f32_dpp v120, v120, v120 row_ror:4 row_mask:0xf bank_mask:0xf
    v_pk_mul_f32 v[180:181], v[180:181], v[236:237]
    v_pk_mul_f32 v[182:183], v[182:183], v[238:239]
    v_add_f32_dpp v120, v120, v120 row_ror:2 row_mask:0xf bank_mask:0xf
    v_pk_mul_f32 v[184:185], v[184:185], v[240:241]
    v_pk_mul_f32 v[186:187], v[186:187], v[242:243]
    v_add_f32_dpp v120, v120, v120 row_ror:1 row_mask:0xf bank_mask:0xf
    v_fma_f32 v120, v120, s44, v16
    v_rsq_f32_e64 v122, v120
    v_pk_mul_f32 v[188:189], v[188:189], v[244:245]
    v_pk_mul_f32 v[190:191], v[190:191], v[246:247]
    v_pk_mul_f32 v[192:193], v[192:193], v[248:249]
    v_pk_mul_f32 v[194:195], v[194:195], v[250:251]
    v_pk_mul_f32 v[196:197], v[196:197], v[252:253]
    v_pk_mul_f32 v[198:199], v[198:199], v[254:255]
    v_pk_fma_f32 v[172:173], v[172:173], v[122:123], v[200:201] op_sel_hi:[1,0,1]
    v_pk_fma_f32 v[174:175], v[174:175], v[122:123], v[202:203] op_sel_hi:[1,0,1]
    v_pk_fma_f32 v[176:177], v[176:177], v[122:123], v[204:205] op_sel_hi:[1,0,1]
    v_pk_fma_f32 v[178:179], v[178:179], v[122:123], v[206:207] op_sel_hi:[1,0,1]
    v_cvt_pk_bf16_f32 v172, v172, v173
    v_cvt_pk_bf16_f32 v173, v174, v175
    v_cvt_pk_bf16_f32 v174, v176, v177
    v_cvt_pk_bf16_f32 v175, v178, v179
    ds_write_b128 v14, v[172:175] offset:0
    v_pk_fma_f32 v[180:181], v[180:181], v[122:123], v[208:209] op_sel_hi:[1,0,1]
    v_pk_fma_f32 v[182:183], v[182:183], v[122:123], v[210:211] op_sel_hi:[1,0,1]
    v_pk_fma_f32 v[184:185], v[184:185], v[122:123], v[212:213] op_sel_hi:[1,0,1]
    v_pk_fma_f32 v[186:187], v[186:187], v[122:123], v[214:215] op_sel_hi:[1,0,1]
    v_cvt_pk_bf16_f32 v180, v180, v181
    v_cvt_pk_bf16_f32 v181, v182, v183
    v_cvt_pk_bf16_f32 v182, v184, v185
    v_cvt_pk_bf16_f32 v183, v186, v187
    ds_write_b128 v14, v[180:183] offset:4096
    v_pk_fma_f32 v[188:189], v[188:189], v[122:123], v[216:217] op_sel_hi:[1,0,1]
    v_pk_fma_f32 v[190:191], v[190:191], v[122:123], v[218:219] op_sel_hi:[1,0,1]
    v_pk_fma_f32 v[192:193], v[192:193], v[122:123], v[220:221] op_sel_hi:[1,0,1]
    v_pk_fma_f32 v[194:195], v[194:195], v[122:123], v[222:223] op_sel_hi:[1,0,1]
    s_waitcnt vmcnt(4)
    s_nop 0
    v_dot2_f32_bf16 v17, v134, s43, 0
    v_dot2_f32_bf16 v17, v135, s43, v17
    v_dot2_f32_bf16 v17, v136, s43, v17
    v_dot2_f32_bf16 v17, v137, s43, v17
    v_dot2_f32_bf16 v17, v138, s43, v17
    v_dot2_f32_bf16 v17, v139, s43, v17
    v_dot2_f32_bf16 v17, v140, s43, v17
    v_dot2_f32_bf16 v17, v141, s43, v17
    v_dot2_f32_bf16 v17, v142, s43, v17
    v_dot2_f32_bf16 v17, v143, s43, v17
    v_dot2_f32_bf16 v17, v144, s43, v17
    v_dot2_f32_bf16 v17, v145, s43, v17
    v_dot2_f32_bf16 v17, v146, s43, v17
    v_dot2_f32_bf16 v17, v147, s43, v17
    v_cvt_pk_bf16_f32 v188, v188, v189
    v_cvt_pk_bf16_f32 v189, v190, v191
    v_cvt_pk_bf16_f32 v190, v192, v193
    v_add_f32_dpp v17, v17, v17 row_ror:8 row_mask:0xf bank_mask:0xf
    v_cvt_pk_bf16_f32 v191, v194, v195
    ds_write_b128 v14, v[188:191] offset:8192
    v_add_f32_dpp v17, v17, v17 row_ror:4 row_mask:0xf bank_mask:0xf
    v_pk_fma_f32 v[196:197], v[196:197], v[122:123], v[224:225] op_sel_hi:[1,0,1]
    v_pk_fma_f32 v[198:199], v[198:199], v[122:123], v[226:227] op_sel_hi:[1,0,1]
    v_add_f32_dpp v17, v17, v17 row_ror:2 row_mask:0xf bank_mask:0xf
    v_cvt_pk_bf16_f32 v196, v196, v197
    v_cvt_pk_bf16_f32 v197, v198, v199
    v_add_f32_dpp v17, v17, v17 row_ror:1 row_mask:0xf bank_mask:0xf
    ds_write_b64 v15, v[196:197] offset:0
    v_mul_f32 v17, s44, v17
    s_mov_b64 s[24:25], s[12:13]
    s_mov_b32 s28, 28672
    s_mov_b32 s29, 57344
    s_mov_b32 s30, 86016
    s_mov_b32 s31, 114688
    s_mov_b32 s32, 143360
    s_mov_b32 s33, 172032
    s_mov_b32 s34, 200704
    s_mov_b32 s35, 229376
    s_mov_b32 s92, 258048
    s_mov_b32 s93, 286720
    s_mov_b32 s94, 315392
    s_mov_b32 s98, 344064
    s_mov_b32 s99, 372736
    s_mov_b32 s37, 0
    s_add_u32 m0, s38, 0
    s_nop 0
    buffer_load_dwordx4 v8, s[20:23], s37 offen lds
    buffer_load_dwordx4 v9, s[20:23], s37 offen offset:1024 lds
    s_mov_b32 s37, 3584
    s_add_u32 m0, s38, 2048
    s_nop 0
    buffer_load_dwordx4 v8, s[20:23], s37 offen lds
    buffer_load_dwordx4 v9, s[20:23], s37 offen offset:1024 lds
    v_dot2_f32_bf16 v172, v134, s41, v17 neg_lo:[0,0,1]
    v_dot2_f32_bf16 v173, v134, s42, v17 neg_lo:[0,0,1]
    v_dot2_f32_bf16 v174, v135, s41, v17 neg_lo:[0,0,1]
    v_dot2_f32_bf16 v175, v135, s42, v17 neg_lo:[0,0,1]
    v_dot2_f32_bf16 v176, v136, s41, v17 neg_lo:[0,0,1]
    v_dot2_f32_bf16 v177, v136, s42, v17 neg_lo:[0,0,1]
    v_dot2_f32_bf16 v178, v137, s41, v17 neg_lo:[0,0,1]
    v_dot2_f32_bf16 v179, v137, s42, v17 neg_lo:[0,0,1]
    v_dot2_f32_bf16 v180, v138, s41, v17 neg_lo:[0,0,1]
    v_dot2_f32_bf16 v181, v138, s42, v17 neg_lo:[0,0,1]
    v_dot2_f32_bf16 v182, v139, s41, v17 neg_lo:[0,0,1]
    v_dot2_f32_bf16 v183, v139, s42, v17 neg_lo:[0,0,1]
    v_dot2_f32_bf16 v184, v140, s41, v17 neg_lo:[0,0,1]
    v_dot2_f32_bf16 v185, v140, s42, v17 neg_lo:[0,0,1]
    v_dot2_f32_bf16 v186, v141, s41, v17 neg_lo:[0,0,1]
    v_dot2_f32_bf16 v187, v141, s42, v17 neg_lo:[0,0,1]
    v_dot2_f32_bf16 v188, v142, s41, v17 neg_lo:[0,0,1]
    v_dot2_f32_bf16 v189, v142, s42, v17 neg_lo:[0,0,1]
    v_dot2_f32_bf16 v190, v143, s41, v17 neg_lo:[0,0,1]
    v_dot2_f32_bf16 v191, v143, s42, v17 neg_lo:[0,0,1]
    v_dot2_f32_bf16 v192, v144, s41, v17 neg_lo:[0,0,1]
    v_dot2_f32_bf16 v193, v144, s42, v17 neg_lo:[0,0,1]
    v_dot2_f32_bf16 v194, v145, s41, v17 neg_lo:[0,0,1]
    v_dot2_f32_bf16 v195, v145, s42, v17 neg_lo:[0,0,1]
    v_dot2_f32_bf16 v196, v146, s41, v17 neg_lo:[0,0,1]
    v_dot2_f32_bf16 v197, v146, s42, v17 neg_lo:[0,0,1]
    v_dot2_f32_bf16 v198, v147, s41, v17 neg_lo:[0,0,1]
    v_dot2_f32_bf16 v199, v147, s42, v17 neg_lo:[0,0,1]
    v_pk_mul_f32 v[134:135], v[172:173], v[172:173]
    v_pk_fma_f32 v[134:135], v[174:175], v[174:175], v[134:135]
    s_mov_b32 s37, 28672
    s_add_u32 m0, s38, 4096
    s_nop 0
    s_nop 0
    buffer_load_dwordx4 v8, s[20:23], s37 offen lds
    v_pk_fma_f32 v[134:135], v[176:177], v[176:177], v[134:135]
    v_pk_fma_f32 v[134:135], v[178:179], v[178:179], v[134:135]
    v_pk_fma_f32 v[134:135], v[180:181], v[180:181], v[134:135]
    v_pk_fma_f32 v[134:135], v[182:183], v[182:183], v[134:135]
    v_pk_fma_f32 v[134:135], v[184:185], v[184:185], v[134:135]
    v_pk_fma_f32 v[134:135], v[186:187], v[186:187], v[134:135]
    v_pk_fma_f32 v[134:135], v[188:189], v[188:189], v[134:135]
    v_pk_fma_f32 v[134:135], v[190:191], v[190:191], v[134:135]
    v_pk_fma_f32 v[134:135], v[192:193], v[192:193], v[134:135]
    v_pk_fma_f32 v[134:135], v[194:195], v[194:195], v[134:135]
    v_pk_fma_f32 v[134:135], v[196:197], v[196:197], v[134:135]
    v_pk_fma_f32 v[134:135], v[198:199], v[198:199], v[134:135]
    v_add_f32_e64 v134, v134, v135
    v_pk_mul_f32 v[172:173], v[172:173], v[228:229]
    v_pk_mul_f32 v[174:175], v[174:175], v[230:231]
    v_add_f32_dpp v134, v134, v134 row_ror:8 row_mask:0xf bank_mask:0xf
    v_pk_mul_f32 v[176:177], v[176:177], v[232:233]
    v_pk_mul_f32 v[178:179], v[178:179], v[234:235]
    buffer_load_dwordx4 v9, s[20:23], s37 offen offset:1024 lds
    v_add_f32_dpp v134, v134, v134 row_ror:4 row_mask:0xf bank_mask:0xf
    v_pk_mul_f32 v[180:181], v[180:181], v[236:237]
    v_pk_mul_f32 v[182:183], v[182:183], v[238:239]
    v_add_f32_dpp v134, v134, v134 row_ror:2 row_mask:0xf bank_mask:0xf
    v_pk_mul_f32 v[184:185], v[184:185], v[240:241]
    v_pk_mul_f32 v[186:187], v[186:187], v[242:243]
    v_add_f32_dpp v134, v134, v134 row_ror:1 row_mask:0xf bank_mask:0xf
    v_fma_f32 v134, v134, s44, v16
    v_rsq_f32_e64 v136, v134
    v_pk_mul_f32 v[188:189], v[188:189], v[244:245]
    v_pk_mul_f32 v[190:191], v[190:191], v[246:247]
    v_pk_mul_f32 v[192:193], v[192:193], v[248:249]
    v_pk_mul_f32 v[194:195], v[194:195], v[250:251]
    v_pk_mul_f32 v[196:197], v[196:197], v[252:253]
    v_pk_mul_f32 v[198:199], v[198:199], v[254:255]
    v_pk_fma_f32 v[172:173], v[172:173], v[136:137], v[200:201] op_sel_hi:[1,0,1]
    v_pk_fma_f32 v[174:175], v[174:175], v[136:137], v[202:203] op_sel_hi:[1,0,1]
    v_pk_fma_f32 v[176:177], v[176:177], v[136:137], v[204:205] op_sel_hi:[1,0,1]
    s_mov_b32 s37, 32256
    s_add_u32 m0, s38, 6144
    s_nop 0
    s_nop 0
    buffer_load_dwordx4 v8, s[20:23], s37 offen lds
    v_pk_fma_f32 v[178:179], v[178:179], v[136:137], v[206:207] op_sel_hi:[1,0,1]
    v_cvt_pk_bf16_f32 v172, v172, v173
    v_cvt_pk_bf16_f32 v173, v174, v175
    v_cvt_pk_bf16_f32 v174, v176, v177
    v_cvt_pk_bf16_f32 v175, v178, v179
    ds_write_b128 v14, v[172:175] offset:14336
    v_pk_fma_f32 v[180:181], v[180:181], v[136:137], v[208:209] op_sel_hi:[1,0,1]
    v_pk_fma_f32 v[182:183], v[182:183], v[136:137], v[210:211] op_sel_hi:[1,0,1]
    v_pk_fma_f32 v[184:185], v[184:185], v[136:137], v[212:213] op_sel_hi:[1,0,1]
    v_pk_fma_f32 v[186:187], v[186:187], v[136:137], v[214:215] op_sel_hi:[1,0,1]
    v_cvt_pk_bf16_f32 v180, v180, v181
    v_cvt_pk_bf16_f32 v181, v182, v183
    v_cvt_pk_bf16_f32 v182, v184, v185
    v_cvt_pk_bf16_f32 v183, v186, v187
    ds_write_b128 v14, v[180:183] offset:18432
    v_pk_fma_f32 v[188:189], v[188:189], v[136:137], v[216:217] op_sel_hi:[1,0,1]
    v_pk_fma_f32 v[190:191], v[190:191], v[136:137], v[218:219] op_sel_hi:[1,0,1]
    v_pk_fma_f32 v[192:193], v[192:193], v[136:137], v[220:221] op_sel_hi:[1,0,1]
    v_pk_fma_f32 v[194:195], v[194:195], v[136:137], v[222:223] op_sel_hi:[1,0,1]
    buffer_load_dwordx4 v9, s[20:23], s37 offen offset:1024 lds
    s_waitcnt vmcnt(8)
    s_nop 0
    v_dot2_f32_bf16 v17, v148, s43, 0
    v_dot2_f32_bf16 v17, v149, s43, v17
    v_dot2_f32_bf16 v17, v150, s43, v17
    v_dot2_f32_bf16 v17, v151, s43, v17
    v_dot2_f32_bf16 v17, v152, s43, v17
    v_dot2_f32_bf16 v17, v153, s43, v17
    v_dot2_f32_bf16 v17, v154, s43, v17
    v_dot2_f32_bf16 v17, v155, s43, v17
    v_dot2_f32_bf16 v17, v156, s43, v17
    v_dot2_f32_bf16 v17, v157, s43, v17
    v_dot2_f32_bf16 v17, v158, s43, v17
    v_dot2_f32_bf16 v17, v159, s43, v17
    v_dot2_f32_bf16 v17, v160, s43, v17
    v_dot2_f32_bf16 v17, v161, s43, v17
    v_cvt_pk_bf16_f32 v188, v188, v189
    v_cvt_pk_bf16_f32 v189, v190, v191
    v_cvt_pk_bf16_f32 v190, v192, v193
    v_add_f32_dpp v17, v17, v17 row_ror:8 row_mask:0xf bank_mask:0xf
    v_cvt_pk_bf16_f32 v191, v194, v195
    ds_write_b128 v14, v[188:191] offset:22528
    v_add_f32_dpp v17, v17, v17 row_ror:4 row_mask:0xf bank_mask:0xf
    v_pk_fma_f32 v[196:197], v[196:197], v[136:137], v[224:225] op_sel_hi:[1,0,1]
    v_pk_fma_f32 v[198:199], v[198:199], v[136:137], v[226:227] op_sel_hi:[1,0,1]
    v_add_f32_dpp v17, v17, v17 row_ror:2 row_mask:0xf bank_mask:0xf
    v_cvt_pk_bf16_f32 v196, v196, v197
    v_cvt_pk_bf16_f32 v197, v198, v199
    v_add_f32_dpp v17, v17, v17 row_ror:1 row_mask:0xf bank_mask:0xf
    ds_write_b64 v15, v[196:197] offset:14336
    v_mul_f32_e64 v17, s44, v17
    v_dot2_f32_bf16 v172, v148, s41, v17 neg_lo:[0,0,1]
    v_dot2_f32_bf16 v173, v148, s42, v17 neg_lo:[0,0,1]
    s_mov_b32 s37, 57344
    s_add_u32 m0, s38, 8192
    s_nop 0
    s_nop 0
    buffer_load_dwordx4 v8, s[20:23], s37 offen lds
    v_dot2_f32_bf16 v174, v149, s41, v17 neg_lo:[0,0,1]
    v_dot2_f32_bf16 v175, v149, s42, v17 neg_lo:[0,0,1]
    v_dot2_f32_bf16 v176, v150, s41, v17 neg_lo:[0,0,1]
    v_dot2_f32_bf16 v177, v150, s42, v17 neg_lo:[0,0,1]
    v_dot2_f32_bf16 v178, v151, s41, v17 neg_lo:[0,0,1]
    v_dot2_f32_bf16 v179, v151, s42, v17 neg_lo:[0,0,1]
    v_dot2_f32_bf16 v180, v152, s41, v17 neg_lo:[0,0,1]
    v_dot2_f32_bf16 v181, v152, s42, v17 neg_lo:[0,0,1]
    v_dot2_f32_bf16 v182, v153, s41, v17 neg_lo:[0,0,1]
    buffer_load_dwordx4 v9, s[20:23], s37 offen offset:1024 lds
    v_dot2_f32_bf16 v183, v153, s42, v17 neg_lo:[0,0,1]
    v_dot2_f32_bf16 v184, v154, s41, v17 neg_lo:[0,0,1]
    v_dot2_f32_bf16 v185, v154, s42, v17 neg_lo:[0,0,1]
    v_dot2_f32_bf16 v186, v155, s41, v17 neg_lo:[0,0,1]
    v_dot2_f32_bf16 v187, v155, s42, v17 neg_lo:[0,0,1]
    v_dot2_f32_bf16 v188, v156, s41, v17 neg_lo:[0,0,1]
    v_dot2_f32_bf16 v189, v156, s42, v17 neg_lo:[0,0,1]
    v_dot2_f32_bf16 v190, v157, s41, v17 neg_lo:[0,0,1]
    v_dot2_f32_bf16 v191, v157, s42, v17 neg_lo:[0,0,1]
    s_mov_b32 s37, 60928
    s_add_u32 m0, s38, 10240
    s_nop 0
    s_nop 0
    buffer_load_dwordx4 v8, s[20:23], s37 offen lds
    v_dot2_f32_bf16 v192, v158, s41, v17 neg_lo:[0,0,1]
    v_dot2_f32_bf16 v193, v158, s42, v17 neg_lo:[0,0,1]
    v_dot2_f32_bf16 v194, v159, s41, v17 neg_lo:[0,0,1]
    v_dot2_f32_bf16 v195, v159, s42, v17 neg_lo:[0,0,1]
    v_dot2_f32_bf16 v196, v160, s41, v17 neg_lo:[0,0,1]
    v_dot2_f32_bf16 v197, v160, s42, v17 neg_lo:[0,0,1]
    v_dot2_f32_bf16 v198, v161, s41, v17 neg_lo:[0,0,1]
    v_dot2_f32_bf16 v199, v161, s42, v17 neg_lo:[0,0,1]
    v_pk_mul_f32 v[148:149], v[172:173], v[172:173]
    v_pk_fma_f32 v[148:149], v[174:175], v[174:175], v[148:149]
    buffer_load_dwordx4 v9, s[20:23], s37 offen offset:1024 lds
    v_pk_fma_f32 v[148:149], v[176:177], v[176:177], v[148:149]
    v_pk_fma_f32 v[148:149], v[178:179], v[178:179], v[148:149]
    v_pk_fma_f32 v[148:149], v[180:181], v[180:181], v[148:149]
    v_pk_fma_f32 v[148:149], v[182:183], v[182:183], v[148:149]
    v_pk_fma_f32 v[148:149], v[184:185], v[184:185], v[148:149]
    v_pk_fma_f32 v[148:149], v[186:187], v[186:187], v[148:149]
    v_pk_fma_f32 v[148:149], v[188:189], v[188:189], v[148:149]
    v_pk_fma_f32 v[148:149], v[190:191], v[190:191], v[148:149]
    v_pk_fma_f32 v[148:149], v[192:193], v[192:193], v[148:149]
    v_pk_fma_f32 v[148:149], v[194:195], v[194:195], v[148:149]
    v_pk_fma_f32 v[148:149], v[196:197], v[196:197], v[148:149]
    v_pk_fma_f32 v[148:149], v[198:199], v[198:199], v[148:149]
    v_add_f32_e64 v148, v148, v149
    v_pk_mul_f32 v[172:173], v[172:173], v[228:229]
    v_pk_mul_f32 v[174:175], v[174:175], v[230:231]
    v_add_f32_dpp v148, v148, v148 row_ror:8 row_mask:0xf bank_mask:0xf
    v_pk_mul_f32 v[176:177], v[176:177], v[232:233]
    v_pk_mul_f32 v[178:179], v[178:179], v[234:235]
    v_add_f32_dpp v148, v148, v148 row_ror:4 row_mask:0xf bank_mask:0xf
    v_pk_mul_f32 v[180:181], v[180:181], v[236:237]
    v_pk_mul_f32 v[182:183], v[182:183], v[238:239]
    v_add_f32_dpp v148, v148, v148 row_ror:2 row_mask:0xf bank_mask:0xf
    v_pk_mul_f32 v[184:185], v[184:185], v[240:241]
    v_pk_mul_f32 v[186:187], v[186:187], v[242:243]
    v_add_f32_dpp v148, v148, v148 row_ror:1 row_mask:0xf bank_mask:0xf
    v_fma_f32 v148, v148, s44, v16
    v_rsq_f32_e64 v150, v148
    v_pk_mul_f32 v[188:189], v[188:189], v[244:245]
    v_pk_mul_f32 v[190:191], v[190:191], v[246:247]
    v_pk_mul_f32 v[192:193], v[192:193], v[248:249]
    v_pk_mul_f32 v[194:195], v[194:195], v[250:251]
    v_pk_mul_f32 v[196:197], v[196:197], v[252:253]
    v_pk_mul_f32 v[198:199], v[198:199], v[254:255]
    v_pk_fma_f32 v[172:173], v[172:173], v[150:151], v[200:201] op_sel_hi:[1,0,1]
    v_pk_fma_f32 v[174:175], v[174:175], v[150:151], v[202:203] op_sel_hi:[1,0,1]
    v_pk_fma_f32 v[176:177], v[176:177], v[150:151], v[204:205] op_sel_hi:[1,0,1]
    v_pk_fma_f32 v[178:179], v[178:179], v[150:151], v[206:207] op_sel_hi:[1,0,1]
    v_cvt_pk_bf16_f32 v172, v172, v173
    v_cvt_pk_bf16_f32 v173, v174, v175
    v_cvt_pk_bf16_f32 v174, v176, v177
    v_cvt_pk_bf16_f32 v175, v178, v179
    ds_write_b128 v14, v[172:175] offset:28672
    v_pk_fma_f32 v[180:181], v[180:181], v[150:151], v[208:209] op_sel_hi:[1,0,1]
    v_pk_fma_f32 v[182:183], v[182:183], v[150:151], v[210:211] op_sel_hi:[1,0,1]
    v_pk_fma_f32 v[184:185], v[184:185], v[150:151], v[212:213] op_sel_hi:[1,0,1]
    v_pk_fma_f32 v[186:187], v[186:187], v[150:151], v[214:215] op_sel_hi:[1,0,1]
    v_cvt_pk_bf16_f32 v180, v180, v181
    v_cvt_pk_bf16_f32 v181, v182, v183
    v_cvt_pk_bf16_f32 v182, v184, v185
    v_cvt_pk_bf16_f32 v183, v186, v187
    ds_write_b128 v14, v[180:183] offset:32768
    v_pk_fma_f32 v[188:189], v[188:189], v[150:151], v[216:217] op_sel_hi:[1,0,1]
    v_pk_fma_f32 v[190:191], v[190:191], v[150:151], v[218:219] op_sel_hi:[1,0,1]
    v_pk_fma_f32 v[192:193], v[192:193], v[150:151], v[220:221] op_sel_hi:[1,0,1]
    v_pk_fma_f32 v[194:195], v[194:195], v[150:151], v[222:223] op_sel_hi:[1,0,1]
    v_cvt_pk_bf16_f32 v188, v188, v189
    v_cvt_pk_bf16_f32 v189, v190, v191
    v_cvt_pk_bf16_f32 v190, v192, v193
    v_cvt_pk_bf16_f32 v191, v194, v195
    ds_write_b128 v14, v[188:191] offset:36864
    v_pk_fma_f32 v[196:197], v[196:197], v[150:151], v[224:225] op_sel_hi:[1,0,1]
    v_pk_fma_f32 v[198:199], v[198:199], v[150:151], v[226:227] op_sel_hi:[1,0,1]
    v_cvt_pk_bf16_f32 v196, v196, v197
    v_cvt_pk_bf16_f32 v197, v198, v199
    ds_write_b64 v15, v[196:197] offset:28672
    s_waitcnt vmcnt(10)
    ds_read_b64_tr_b16 a[0:1], v10 offset:0
    ds_read_b64_tr_b16 a[4:5], v11 offset:0
    ds_read_b64_tr_b16 a[8:9], v12 offset:0
    ds_read_b64_tr_b16 a[12:13], v13 offset:0
    s_waitcnt vmcnt(8)
    ds_read_b64_tr_b16 a[2:3], v10 offset:2048
    ds_read_b64_tr_b16 a[6:7], v11 offset:2048
    ds_read_b64_tr_b16 a[10:11], v12 offset:2048
    ds_read_b64_tr_b16 a[14:15], v13 offset:2048
    s_waitcnt vmcnt(6)
    ds_read_b64_tr_b16 a[16:17], v10 offset:4096
    ds_read_b64_tr_b16 a[20:21], v11 offset:4096
    ds_read_b64_tr_b16 a[24:25], v12 offset:4096
    ds_read_b64_tr_b16 a[28:29], v13 offset:4096
    s_waitcnt vmcnt(4)
    ds_read_b64_tr_b16 a[18:19], v10 offset:6144
    ds_read_b64_tr_b16 a[22:23], v11 offset:6144
    ds_read_b64_tr_b16 a[26:27], v12 offset:6144
    ds_read_b64_tr_b16 a[30:31], v13 offset:6144
    s_mov_b32 s37, 86016
    s_waitcnt lgkmcnt(12)
    s_add_u32 m0, s38, 0
    s_nop 0
    buffer_load_dwordx4 v8, s[20:23], s37 offen lds
    buffer_load_dwordx4 v9, s[20:23], s37 offen offset:1024 lds
    s_mov_b32 s37, 89600
    s_waitcnt lgkmcnt(8)
    s_add_u32 m0, s38, 2048
    s_nop 0
    buffer_load_dwordx4 v8, s[20:23], s37 offen lds
    buffer_load_dwordx4 v9, s[20:23], s37 offen offset:1024 lds
    s_barrier
    ds_read_b128 v[32:35], v6 offset:28672
    ds_read_b128 v[36:39], v7 offset:29696
    ds_read_b128 v[40:43], v6 offset:0
    ds_read_b128 v[44:47], v7 offset:1024
    s_mov_b32 s37, 114688
    s_waitcnt lgkmcnt(8)
    s_add_u32 m0, s38, 4096
    s_nop 0
    buffer_load_dwordx4 v8, s[20:23], s37 offen lds
    buffer_load_dwordx4 v9, s[20:23], s37 offen offset:1024 lds
    s_mov_b32 s37, 118272
    s_waitcnt lgkmcnt(4)
    s_add_u32 m0, s38, 6144
    s_nop 0
    buffer_load_dwordx4 v8, s[20:23], s37 offen lds
    buffer_load_dwordx4 v9, s[20:23], s37 offen offset:1024 lds
    s_waitcnt lgkmcnt(2)
    v_mfma_f32_16x16x32_bf16 v[88:91], a[0:3], v[32:35], 0
    s_waitcnt vmcnt(10)
    ds_read_b64_tr_b16 a[32:33], v10 offset:8192
    ds_read_b64_tr_b16 a[36:37], v11 offset:8192
    v_mfma_f32_16x16x32_bf16 v[88:91], a[16:19], v[36:39], v[88:91]
    ds_read_b64_tr_b16 a[40:41], v12 offset:8192
    ds_read_b64_tr_b16 a[44:45], v13 offset:8192
    v_mfma_f32_16x16x32_bf16 v[92:95], a[4:7], v[32:35], 0
    v_mfma_f32_16x16x32_bf16 v[92:95], a[20:23], v[36:39], v[92:95]
    ds_read_b128 v[48:51], v6 offset:14336
    s_mov_b32 s37, 143360
    v_mfma_f32_16x16x32_bf16 v[96:99], a[8:11], v[32:35], 0
    ds_read_b128 v[52:55], v7 offset:15360
    s_waitcnt lgkmcnt(2)
    s_add_u32 m0, s38, 8192
    v_mfma_f32_16x16x32_bf16 v[96:99], a[24:27], v[36:39], v[96:99]
    buffer_load_dwordx4 v8, s[20:23], s37 offen lds
    v_mfma_f32_16x16x32_bf16 v[100:103], a[12:15], v[32:35], 0
    s_waitcnt vmcnt(9)
    ds_read_b64_tr_b16 a[34:35], v10 offset:10240
    ds_read_b64_tr_b16 a[38:39], v11 offset:10240
    v_mfma_f32_16x16x32_bf16 v[100:103], a[28:31], v[36:39], v[100:103]
    ds_read_b64_tr_b16 a[42:43], v12 offset:10240
    ds_read_b64_tr_b16 a[46:47], v13 offset:10240
    v_mfma_f32_16x16x32_bf16 v[56:59], a[0:3], v[40:43], 0
    buffer_load_dwordx4 v9, s[20:23], s37 offen offset:1024 lds
    v_mfma_f32_16x16x32_bf16 v[56:59], a[16:19], v[44:47], v[56:59]
    s_mov_b32 s37, 146944
    v_mfma_f32_16x16x32_bf16 v[60:63], a[4:7], v[40:43], 0
    s_waitcnt lgkmcnt(0)
    s_add_u32 m0, s38, 10240
    s_nop 0
    buffer_load_dwordx4 v8, s[20:23], s37 offen lds
    v_mfma_f32_16x16x32_bf16 v[60:63], a[20:23], v[44:47], v[60:63]
    ds_read_b128 v[32:35], v6 offset:30720
    v_mfma_f32_16x16x32_bf16 v[64:67], a[8:11], v[40:43], 0
    ds_read_b128 v[36:39], v7 offset:31744
    buffer_load_dwordx4 v9, s[20:23], s37 offen offset:1024 lds
    v_mfma_f32_16x16x32_bf16 v[64:67], a[24:27], v[44:47], v[64:67]
    s_waitcnt vmcnt(10)
    ds_read_b64_tr_b16 a[48:49], v10 offset:0
    ds_read_b64_tr_b16 a[52:53], v11 offset:0
    ds_read_b64_tr_b16 a[56:57], v12 offset:0
    v_mfma_f32_16x16x32_bf16 v[68:71], a[12:15], v[40:43], 0
    ds_read_b64_tr_b16 a[60:61], v13 offset:0
    v_mfma_f32_16x16x32_bf16 v[68:71], a[28:31], v[44:47], v[68:71]
    v_mfma_f32_16x16x32_bf16 v[72:75], a[0:3], v[48:51], 0
    s_mov_b32 s37, 172032
    s_waitcnt lgkmcnt(0)
    s_add_u32 m0, s38, 0
    v_mfma_f32_16x16x32_bf16 v[72:75], a[16:19], v[52:55], v[72:75]
    buffer_load_dwordx4 v8, s[20:23], s37 offen lds
    buffer_load_dwordx4 v9, s[20:23], s37 offen offset:1024 lds
    v_mfma_f32_16x16x32_bf16 v[76:79], a[4:7], v[48:51], 0
    s_waitcnt vmcnt(10)
    ds_read_b64_tr_b16 a[50:51], v10 offset:2048
    ds_read_b64_tr_b16 a[54:55], v11 offset:2048
    ds_read_b64_tr_b16 a[58:59], v12 offset:2048
    v_mfma_f32_16x16x32_bf16 v[76:79], a[20:23], v[52:55], v[76:79]
    ds_read_b128 v[40:43], v6 offset:2048
    ds_read_b64_tr_b16 a[62:63], v13 offset:2048
    v_mfma_f32_16x16x32_bf16 v[80:83], a[8:11], v[48:51], 0
    ds_read_b128 v[44:47], v7 offset:3072
    v_mfma_f32_16x16x32_bf16 v[80:83], a[24:27], v[52:55], v[80:83]
    s_mov_b32 s37, 175616
    v_mfma_f32_16x16x32_bf16 v[84:87], a[12:15], v[48:51], 0
    s_waitcnt lgkmcnt(1)
    s_add_u32 m0, s38, 2048
    v_mfma_f32_16x16x32_bf16 v[84:87], a[28:31], v[52:55], v[84:87]
    buffer_load_dwordx4 v8, s[20:23], s37 offen lds
    v_mfma_f32_16x16x32_bf16 v[88:91], a[32:35], v[32:35], v[88:91]
    s_waitcnt vmcnt(9)
    ds_read_b64_tr_b16 a[64:65], v10 offset:4096
    ds_read_b64_tr_b16 a[68:69], v11 offset:4096
    v_mfma_f32_16x16x32_bf16 v[88:91], a[48:51], v[36:39], v[88:91]
    ds_read_b64_tr_b16 a[72:73], v12 offset:4096
    ds_read_b64_tr_b16 a[76:77], v13 offset:4096
    v_mfma_f32_16x16x32_bf16 v[92:95], a[36:39], v[32:35], v[92:95]
    buffer_load_dwordx4 v9, s[20:23], s37 offen offset:1024 lds
    v_mfma_f32_16x16x32_bf16 v[92:95], a[52:55], v[36:39], v[92:95]
    ds_read_b128 v[48:51], v6 offset:16384
    s_mov_b32 s37, 200704
    v_mfma_f32_16x16x32_bf16 v[96:99], a[40:43], v[32:35], v[96:99]
    ds_read_b128 v[52:55], v7 offset:17408
    s_waitcnt lgkmcnt(2)
    s_add_u32 m0, s38, 4096
    v_mfma_f32_16x16x32_bf16 v[96:99], a[56:59], v[36:39], v[96:99]
    buffer_load_dwordx4 v8, s[20:23], s37 offen lds
    v_mfma_f32_16x16x32_bf16 v[100:103], a[44:47], v[32:35], v[100:103]
    s_waitcnt vmcnt(9)
    ds_read_b64_tr_b16 a[66:67], v10 offset:6144
    ds_read_b64_tr_b16 a[70:71], v11 offset:6144
    v_mfma_f32_16x16x32_bf16 v[100:103], a[60:63], v[36:39], v[100:103]
    ds_read_b64_tr_b16 a[74:75], v12 offset:6144
    ds_read_b64_tr_b16 a[78:79], v13 offset:6144
    v_mfma_f32_16x16x32_bf16 v[56:59], a[32:35], v[40:43], v[56:59]
    buffer_load_dwordx4 v9, s[20:23], s37 offen offset:1024 lds
    v_mfma_f32_16x16x32_bf16 v[56:59], a[48:51], v[44:47], v[56:59]
    s_mov_b32 s37, 204288
    v_mfma_f32_16x16x32_bf16 v[60:63], a[36:39], v[40:43], v[60:63]
    s_waitcnt lgkmcnt(0)
    s_add_u32 m0, s38, 6144
    s_nop 0
    buffer_load_dwordx4 v8, s[20:23], s37 offen lds
    v_mfma_f32_16x16x32_bf16 v[60:63], a[52:55], v[44:47], v[60:63]
    ds_read_b128 v[32:35], v6 offset:32768
    v_mfma_f32_16x16x32_bf16 v[64:67], a[40:43], v[40:43], v[64:67]
    ds_read_b128 v[36:39], v7 offset:33792
    buffer_load_dwordx4 v9, s[20:23], s37 offen offset:1024 lds
    v_mfma_f32_16x16x32_bf16 v[64:67], a[56:59], v[44:47], v[64:67]
    s_waitcnt vmcnt(10)
    ds_read_b64_tr_b16 a[80:81], v10 offset:8192
    ds_read_b64_tr_b16 a[84:85], v11 offset:8192
    ds_read_b64_tr_b16 a[88:89], v12 offset:8192
    v_mfma_f32_16x16x32_bf16 v[68:71], a[44:47], v[40:43], v[68:71]
    ds_read_b64_tr_b16 a[92:93], v13 offset:8192
    v_mfma_f32_16x16x32_bf16 v[68:71], a[60:63], v[44:47], v[68:71]
    v_mfma_f32_16x16x32_bf16 v[72:75], a[32:35], v[48:51], v[72:75]
    s_mov_b32 s37, 229376
    s_waitcnt lgkmcnt(0)
    s_add_u32 m0, s38, 8192
    v_mfma_f32_16x16x32_bf16 v[72:75], a[48:51], v[52:55], v[72:75]
    buffer_load_dwordx4 v8, s[20:23], s37 offen lds
    buffer_load_dwordx4 v9, s[20:23], s37 offen offset:1024 lds
    v_mfma_f32_16x16x32_bf16 v[76:79], a[36:39], v[48:51], v[76:79]
    s_waitcnt vmcnt(10)
    ds_read_b64_tr_b16 a[82:83], v10 offset:10240
    ds_read_b64_tr_b16 a[86:87], v11 offset:10240
    ds_read_b64_tr_b16 a[90:91], v12 offset:10240
    v_mfma_f32_16x16x32_bf16 v[76:79], a[52:55], v[52:55], v[76:79]
    ds_read_b128 v[40:43], v6 offset:4096
    ds_read_b64_tr_b16 a[94:95], v13 offset:10240
    v_mfma_f32_16x16x32_bf16 v[80:83], a[40:43], v[48:51], v[80:83]
    ds_read_b128 v[44:47], v7 offset:5120
    v_mfma_f32_16x16x32_bf16 v[80:83], a[56:59], v[52:55], v[80:83]
    s_mov_b32 s37, 232960
    v_mfma_f32_16x16x32_bf16 v[84:87], a[44:47], v[48:51], v[84:87]
    s_waitcnt lgkmcnt(1)
    s_add_u32 m0, s38, 10240
    v_mfma_f32_16x16x32_bf16 v[84:87], a[60:63], v[52:55], v[84:87]
    buffer_load_dwordx4 v8, s[20:23], s37 offen lds
    v_mfma_f32_16x16x32_bf16 v[88:91], a[64:67], v[32:35], v[88:91]
    s_waitcnt vmcnt(9)
    ds_read_b64_tr_b16 a[96:97], v10 offset:0
    ds_read_b64_tr_b16 a[100:101], v11 offset:0
    v_mfma_f32_16x16x32_bf16 v[88:91], a[80:83], v[36:39], v[88:91]
    ds_read_b64_tr_b16 a[104:105], v12 offset:0
    ds_read_b64_tr_b16 a[108:109], v13 offset:0
    v_mfma_f32_16x16x32_bf16 v[92:95], a[68:71], v[32:35], v[92:95]
    buffer_load_dwordx4 v9, s[20:23], s37 offen offset:1024 lds
    v_mfma_f32_16x16x32_bf16 v[92:95], a[84:87], v[36:39], v[92:95]
    ds_read_b128 v[48:51], v6 offset:18432
    s_mov_b32 s37, 258048
    v_mfma_f32_16x16x32_bf16 v[96:99], a[72:75], v[32:35], v[96:99]
    ds_read_b128 v[52:55], v7 offset:19456
    s_waitcnt lgkmcnt(2)
    s_add_u32 m0, s38, 0
    v_mfma_f32_16x16x32_bf16 v[96:99], a[88:91], v[36:39], v[96:99]
    buffer_load_dwordx4 v8, s[20:23], s37 offen lds
    v_mfma_f32_16x16x32_bf16 v[100:103], a[76:79], v[32:35], v[100:103]
    s_waitcnt vmcnt(9)
    ds_read_b64_tr_b16 a[98:99], v10 offset:2048
    ds_read_b64_tr_b16 a[102:103], v11 offset:2048
    v_mfma_f32_16x16x32_bf16 v[100:103], a[92:95], v[36:39], v[100:103]
    ds_read_b64_tr_b16 a[106:107], v12 offset:2048
    ds_read_b64_tr_b16 a[110:111], v13 offset:2048
    v_mfma_f32_16x16x32_bf16 v[56:59], a[64:67], v[40:43], v[56:59]
    buffer_load_dwordx4 v9, s[20:23], s37 offen offset:1024 lds
    v_mfma_f32_16x16x32_bf16 v[56:59], a[80:83], v[44:47], v[56:59]
    s_mov_b32 s37, 261632
    v_mfma_f32_16x16x32_bf16 v[60:63], a[68:71], v[40:43], v[60:63]
    s_waitcnt lgkmcnt(0)
    s_add_u32 m0, s38, 2048
    s_nop 0
    buffer_load_dwordx4 v8, s[20:23], s37 offen lds
    v_mfma_f32_16x16x32_bf16 v[60:63], a[84:87], v[44:47], v[60:63]
    ds_read_b128 v[32:35], v6 offset:34816
    v_mfma_f32_16x16x32_bf16 v[64:67], a[72:75], v[40:43], v[64:67]
    ds_read_b128 v[36:39], v7 offset:35840
    buffer_load_dwordx4 v9, s[20:23], s37 offen offset:1024 lds
    v_mfma_f32_16x16x32_bf16 v[64:67], a[88:91], v[44:47], v[64:67]
    s_waitcnt vmcnt(10)
    ds_read_b64_tr_b16 a[112:113], v10 offset:4096
    ds_read_b64_tr_b16 a[116:117], v11 offset:4096
    ds_read_b64_tr_b16 a[120:121], v12 offset:4096
    v_mfma_f32_16x16x32_bf16 v[68:71], a[76:79], v[40:43], v[68:71]
    ds_read_b64_tr_b16 a[124:125], v13 offset:4096
    v_mfma_f32_16x16x32_bf16 v[68:71], a[92:95], v[44:47], v[68:71]
    v_mfma_f32_16x16x32_bf16 v[72:75], a[64:67], v[48:51], v[72:75]
    s_mov_b32 s37, 286720
    s_waitcnt lgkmcnt(0)
    s_add_u32 m0, s38, 4096
    v_mfma_f32_16x16x32_bf16 v[72:75], a[80:83], v[52:55], v[72:75]
    buffer_load_dwordx4 v8, s[20:23], s37 offen lds
    buffer_load_dwordx4 v9, s[20:23], s37 offen offset:1024 lds
    v_mfma_f32_16x16x32_bf16 v[76:79], a[68:71], v[48:51], v[76:79]
    s_waitcnt vmcnt(10)
    ds_read_b64_tr_b16 a[114:115], v10 offset:6144
    ds_read_b64_tr_b16 a[118:119], v11 offset:6144
    ds_read_b64_tr_b16 a[122:123], v12 offset:6144
    v_mfma_f32_16x16x32_bf16 v[76:79], a[84:87], v[52:55], v[76:79]
    ds_read_b128 v[40:43], v6 offset:6144
    ds_read_b64_tr_b16 a[126:127], v13 offset:6144
    v_mfma_f32_16x16x32_bf16 v[80:83], a[72:75], v[48:51], v[80:83]
    ds_read_b128 v[44:47], v7 offset:7168
    v_mfma_f32_16x16x32_bf16 v[80:83], a[88:91], v[52:55], v[80:83]
    s_mov_b32 s37, 290304
    v_mfma_f32_16x16x32_bf16 v[84:87], a[76:79], v[48:51], v[84:87]
    s_waitcnt lgkmcnt(1)
    s_add_u32 m0, s38, 6144
    v_mfma_f32_16x16x32_bf16 v[84:87], a[92:95], v[52:55], v[84:87]
    buffer_load_dwordx4 v8, s[20:23], s37 offen lds
    v_mfma_f32_16x16x32_bf16 v[88:91], a[96:99], v[32:35], v[88:91]
    s_waitcnt vmcnt(9)
    ds_read_b64_tr_b16 a[128:129], v10 offset:8192
    ds_read_b64_tr_b16 a[132:133], v11 offset:8192
    v_mfma_f32_16x16x32_bf16 v[88:91], a[112:115], v[36:39], v[88:91]
    ds_read_b64_tr_b16 a[136:137], v12 offset:8192
    ds_read_b64_tr_b16 a[140:141], v13 offset:8192
    v_mfma_f32_16x16x32_bf16 v[92:95], a[100:103], v[32:35], v[92:95]
    buffer_load_dwordx4 v9, s[20:23], s37 offen offset:1024 lds
    v_mfma_f32_16x16x32_bf16 v[92:95], a[116:119], v[36:39], v[92:95]
    ds_read_b128 v[48:51], v6 offset:20480
    s_mov_b32 s37, 315392
    v_mfma_f32_16x16x32_bf16 v[96:99], a[104:107], v[32:35], v[96:99]
    ds_read_b128 v[52:55], v7 offset:21504
    s_waitcnt lgkmcnt(2)
    s_add_u32 m0, s38, 8192
    v_mfma_f32_16x16x32_bf16 v[96:99], a[120:123], v[36:39], v[96:99]
    buffer_load_dwordx4 v8, s[20:23], s37 offen lds
    v_mfma_f32_16x16x32_bf16 v[100:103], a[108:111], v[32:35], v[100:103]
    s_waitcnt vmcnt(9)
    ds_read_b64_tr_b16 a[130:131], v10 offset:10240
    ds_read_b64_tr_b16 a[134:135], v11 offset:10240
    v_mfma_f32_16x16x32_bf16 v[100:103], a[124:127], v[36:39], v[100:103]
    ds_read_b64_tr_b16 a[138:139], v12 offset:10240
    ds_read_b64_tr_b16 a[142:143], v13 offset:10240
    v_mfma_f32_16x16x32_bf16 v[56:59], a[96:99], v[40:43], v[56:59]
    buffer_load_dwordx4 v9, s[20:23], s37 offen offset:1024 lds
    v_mfma_f32_16x16x32_bf16 v[56:59], a[112:115], v[44:47], v[56:59]
    s_mov_b32 s37, 318976
    v_mfma_f32_16x16x32_bf16 v[60:63], a[100:103], v[40:43], v[60:63]
    s_waitcnt lgkmcnt(0)
    s_add_u32 m0, s38, 10240
    s_nop 0
    buffer_load_dwordx4 v8, s[20:23], s37 offen lds
    v_mfma_f32_16x16x32_bf16 v[60:63], a[116:119], v[44:47], v[60:63]
    ds_read_b128 v[32:35], v6 offset:36864
    v_mfma_f32_16x16x32_bf16 v[64:67], a[104:107], v[40:43], v[64:67]
    ds_read_b128 v[36:39], v7 offset:37888
    buffer_load_dwordx4 v9, s[20:23], s37 offen offset:1024 lds
    v_mfma_f32_16x16x32_bf16 v[64:67], a[120:123], v[44:47], v[64:67]
    s_waitcnt vmcnt(10)
    ds_read_b64_tr_b16 a[144:145], v10 offset:0
    ds_read_b64_tr_b16 a[148:149], v11 offset:0
    ds_read_b64_tr_b16 a[152:153], v12 offset:0
    v_mfma_f32_16x16x32_bf16 v[68:71], a[108:111], v[40:43], v[68:71]
    ds_read_b64_tr_b16 a[156:157], v13 offset:0
    v_mfma_f32_16x16x32_bf16 v[68:71], a[124:127], v[44:47], v[68:71]
    v_mfma_f32_16x16x32_bf16 v[72:75], a[96:99], v[48:51], v[72:75]
    s_mov_b32 s37, 344064
    s_waitcnt lgkmcnt(0)
    s_add_u32 m0, s38, 0
    v_mfma_f32_16x16x32_bf16 v[72:75], a[112:115], v[52:55], v[72:75]
    buffer_load_dwordx4 v8, s[20:23], s37 offen lds
    buffer_load_dwordx4 v9, s[20:23], s37 offen offset:1024 lds
    v_mfma_f32_16x16x32_bf16 v[76:79], a[100:103], v[48:51], v[76:79]
    s_waitcnt vmcnt(10)
    ds_read_b64_tr_b16 a[146:147], v10 offset:2048
    ds_read_b64_tr_b16 a[150:151], v11 offset:2048
    ds_read_b64_tr_b16 a[154:155], v12 offset:2048
    v_mfma_f32_16x16x32_bf16 v[76:79], a[116:119], v[52:55], v[76:79]
    ds_read_b128 v[40:43], v6 offset:8192
    ds_read_b64_tr_b16 a[158:159], v13 offset:2048
    v_mfma_f32_16x16x32_bf16 v[80:83], a[104:107], v[48:51], v[80:83]
    ds_read_b128 v[44:47], v7 offset:9216
    v_mfma_f32_16x16x32_bf16 v[80:83], a[120:123], v[52:55], v[80:83]
    s_mov_b32 s37, 347648
    v_mfma_f32_16x16x32_bf16 v[84:87], a[108:111], v[48:51], v[84:87]
    s_waitcnt lgkmcnt(1)
    s_add_u32 m0, s38, 2048
    v_mfma_f32_16x16x32_bf16 v[84:87], a[124:127], v[52:55], v[84:87]
    buffer_load_dwordx4 v8, s[20:23], s37 offen lds
    v_mfma_f32_16x16x32_bf16 v[88:91], a[128:131], v[32:35], v[88:91]
    s_waitcnt vmcnt(9)
    ds_read_b64_tr_b16 a[160:161], v10 offset:4096
    ds_read_b64_tr_b16 a[164:165], v11 offset:4096
    v_mfma_f32_16x16x32_bf16 v[88:91], a[144:147], v[36:39], v[88:91]
    ds_read_b64_tr_b16 a[168:169], v12 offset:4096
    ds_read_b64_tr_b16 a[172:173], v13 offset:4096
    v_mfma_f32_16x16x32_bf16 v[92:95], a[132:135], v[32:35], v[92:95]
    buffer_load_dwordx4 v9, s[20:23], s37 offen offset:1024 lds
    v_mfma_f32_16x16x32_bf16 v[92:95], a[148:151], v[36:39], v[92:95]
    ds_read_b128 v[48:51], v6 offset:22528
    s_mov_b32 s37, 372736
    v_mfma_f32_16x16x32_bf16 v[96:99], a[136:139], v[32:35], v[96:99]
    ds_read_b128 v[52:55], v7 offset:23552
    s_waitcnt lgkmcnt(2)
    s_add_u32 m0, s38, 4096
    v_mfma_f32_16x16x32_bf16 v[96:99], a[152:155], v[36:39], v[96:99]
    buffer_load_dwordx4 v8, s[20:23], s37 offen lds
    v_mfma_f32_16x16x32_bf16 v[100:103], a[140:143], v[32:35], v[100:103]
    s_waitcnt vmcnt(9)
    ds_read_b64_tr_b16 a[162:163], v10 offset:6144
    ds_read_b64_tr_b16 a[166:167], v11 offset:6144
    v_mfma_f32_16x16x32_bf16 v[100:103], a[156:159], v[36:39], v[100:103]
    ds_read_b64_tr_b16 a[170:171], v12 offset:6144
    ds_read_b64_tr_b16 a[174:175], v13 offset:6144
    v_mfma_f32_16x16x32_bf16 v[56:59], a[128:131], v[40:43], v[56:59]
    buffer_load_dwordx4 v9, s[20:23], s37 offen offset:1024 lds
    v_mfma_f32_16x16x32_bf16 v[56:59], a[144:147], v[44:47], v[56:59]
    s_mov_b32 s37, 376320
    v_mfma_f32_16x16x32_bf16 v[60:63], a[132:135], v[40:43], v[60:63]
    s_waitcnt lgkmcnt(0)
    s_add_u32 m0, s38, 6144
    s_nop 0
    buffer_load_dwordx4 v8, s[20:23], s37 offen lds
    v_mfma_f32_16x16x32_bf16 v[60:63], a[148:151], v[44:47], v[60:63]
    ds_read_b128 v[32:35], v6 offset:38912
    v_mfma_f32_16x16x32_bf16 v[64:67], a[136:139], v[40:43], v[64:67]
    ds_read_b128 v[36:39], v7 offset:39936
    buffer_load_dwordx4 v9, s[20:23], s37 offen offset:1024 lds
    v_mfma_f32_16x16x32_bf16 v[64:67], a[152:155], v[44:47], v[64:67]
    s_waitcnt vmcnt(10)
    ds_read_b64_tr_b16 a[176:177], v10 offset:8192
    ds_read_b64_tr_b16 a[180:181], v11 offset:8192
    ds_read_b64_tr_b16 a[184:185], v12 offset:8192
    v_mfma_f32_16x16x32_bf16 v[68:71], a[140:143], v[40:43], v[68:71]
    ds_read_b64_tr_b16 a[188:189], v13 offset:8192
    v_mfma_f32_16x16x32_bf16 v[68:71], a[156:159], v[44:47], v[68:71]
    v_mfma_f32_16x16x32_bf16 v[72:75], a[128:131], v[48:51], v[72:75]
    v_mfma_f32_16x16x32_bf16 v[72:75], a[144:147], v[52:55], v[72:75]
    buffer_load_dwordx4 v[120:123], v0, s[16:19], s53 offen offset:0 nt
    buffer_load_dwordx4 v[124:127], v0, s[16:19], s53 offen offset:256 nt
    v_mfma_f32_16x16x32_bf16 v[76:79], a[132:135], v[48:51], v[76:79]
    s_waitcnt vmcnt(10)
    ds_read_b64_tr_b16 a[178:179], v10 offset:10240
    ds_read_b64_tr_b16 a[182:183], v11 offset:10240
    ds_read_b64_tr_b16 a[186:187], v12 offset:10240
    v_mfma_f32_16x16x32_bf16 v[76:79], a[148:151], v[52:55], v[76:79]
    ds_read_b128 v[40:43], v6 offset:10240
    ds_read_b64_tr_b16 a[190:191], v13 offset:10240
    v_mfma_f32_16x16x32_bf16 v[80:83], a[136:139], v[48:51], v[80:83]
    ds_read_b128 v[44:47], v7 offset:11264
    v_mfma_f32_16x16x32_bf16 v[80:83], a[152:155], v[52:55], v[80:83]
    s_waitcnt lgkmcnt(10)
    v_mfma_f32_16x16x32_bf16 v[84:87], a[140:143], v[48:51], v[84:87]
    v_mfma_f32_16x16x32_bf16 v[84:87], a[156:159], v[52:55], v[84:87]
    buffer_load_dwordx4 v[128:131], v0, s[16:19], s53 offen offset:512 nt
    s_waitcnt lgkmcnt(1)
    v_mfma_f32_16x16x32_bf16 v[88:91], a[160:163], v[32:35], v[88:91]
    s_waitcnt vmcnt(9)
    ds_read_b64_tr_b16 a[192:193], v10 offset:0
    ds_read_b64_tr_b16 a[196:197], v11 offset:0
    v_mfma_f32_16x16x32_bf16 v[88:91], a[176:179], v[36:39], v[88:91]
    ds_read_b64_tr_b16 a[200:201], v12 offset:0
    ds_read_b64_tr_b16 a[204:205], v13 offset:0
    v_mfma_f32_16x16x32_bf16 v[92:95], a[164:167], v[32:35], v[92:95]
    buffer_load_dwordx2 v[132:133], v1, s[16:19], s53 offen nt
    v_mfma_f32_16x16x32_bf16 v[92:95], a[180:183], v[36:39], v[92:95]
    ds_read_b128 v[48:51], v6 offset:24576
    v_mfma_f32_16x16x32_bf16 v[96:99], a[168:171], v[32:35], v[96:99]
    ds_read_b128 v[52:55], v7 offset:25600
    v_mfma_f32_16x16x32_bf16 v[96:99], a[184:187], v[36:39], v[96:99]
    s_waitcnt lgkmcnt(6)
    buffer_load_dwordx4 v[134:137], v0, s[16:19], s54 offen offset:0 nt
    v_mfma_f32_16x16x32_bf16 v[100:103], a[172:175], v[32:35], v[100:103]
    s_waitcnt vmcnt(9)
    ds_read_b64_tr_b16 a[194:195], v10 offset:2048
    ds_read_b64_tr_b16 a[198:199], v11 offset:2048
    v_mfma_f32_16x16x32_bf16 v[100:103], a[188:191], v[36:39], v[100:103]
    ds_read_b64_tr_b16 a[202:203], v12 offset:2048
    ds_read_b64_tr_b16 a[206:207], v13 offset:2048
    v_mfma_f32_16x16x32_bf16 v[56:59], a[160:163], v[40:43], v[56:59]
    buffer_load_dwordx4 v[138:141], v0, s[16:19], s54 offen offset:256 nt
    v_mfma_f32_16x16x32_bf16 v[56:59], a[176:179], v[44:47], v[56:59]
    v_mfma_f32_16x16x32_bf16 v[60:63], a[164:167], v[40:43], v[60:63]
    buffer_load_dwordx4 v[142:145], v0, s[16:19], s54 offen offset:512 nt
    v_mfma_f32_16x16x32_bf16 v[60:63], a[180:183], v[44:47], v[60:63]
    ds_read_b128 v[32:35], v6 offset:40960
    v_mfma_f32_16x16x32_bf16 v[64:67], a[168:171], v[40:43], v[64:67]
    ds_read_b128 v[36:39], v7 offset:41984
    buffer_load_dwordx2 v[146:147], v1, s[16:19], s54 offen nt
    v_mfma_f32_16x16x32_bf16 v[64:67], a[184:187], v[44:47], v[64:67]
    s_waitcnt lgkmcnt(6)
    s_waitcnt vmcnt(10)
    ds_read_b64_tr_b16 a[208:209], v10 offset:4096
    ds_read_b64_tr_b16 a[212:213], v11 offset:4096
    ds_read_b64_tr_b16 a[216:217], v12 offset:4096
    v_mfma_f32_16x16x32_bf16 v[68:71], a[172:175], v[40:43], v[68:71]
    ds_read_b64_tr_b16 a[220:221], v13 offset:4096
    v_mfma_f32_16x16x32_bf16 v[68:71], a[188:191], v[44:47], v[68:71]
    v_mfma_f32_16x16x32_bf16 v[72:75], a[160:163], v[48:51], v[72:75]
    v_mfma_f32_16x16x32_bf16 v[72:75], a[176:179], v[52:55], v[72:75]
    buffer_load_dwordx4 v[148:151], v0, s[16:19], s55 offen offset:0 nt
    buffer_load_dwordx4 v[152:155], v0, s[16:19], s55 offen offset:256 nt
    v_mfma_f32_16x16x32_bf16 v[76:79], a[164:167], v[48:51], v[76:79]
    s_waitcnt vmcnt(10)
    ds_read_b64_tr_b16 a[210:211], v10 offset:6144
    ds_read_b64_tr_b16 a[214:215], v11 offset:6144
    ds_read_b64_tr_b16 a[218:219], v12 offset:6144
    v_mfma_f32_16x16x32_bf16 v[76:79], a[180:183], v[52:55], v[76:79]
    ds_read_b128 v[40:43], v6 offset:12288
    ds_read_b64_tr_b16 a[222:223], v13 offset:6144
    v_mfma_f32_16x16x32_bf16 v[80:83], a[168:171], v[48:51], v[80:83]
    ds_read_b128 v[44:47], v7 offset:13312
    v_mfma_f32_16x16x32_bf16 v[80:83], a[184:187], v[52:55], v[80:83]
    s_waitcnt lgkmcnt(10)
    v_mfma_f32_16x16x32_bf16 v[84:87], a[172:175], v[48:51], v[84:87]
    v_mfma_f32_16x16x32_bf16 v[84:87], a[188:191], v[52:55], v[84:87]
    s_waitcnt lgkmcnt(1)
    v_mfma_f32_16x16x32_bf16 v[88:91], a[192:195], v[32:35], v[88:91]
    v_mfma_f32_16x16x32_bf16 v[88:91], a[208:211], v[36:39], v[88:91]
    v_mfma_f32_16x16x32_bf16 v[92:95], a[196:199], v[32:35], v[92:95]
    v_mfma_f32_16x16x32_bf16 v[92:95], a[212:215], v[36:39], v[92:95]
    ds_read_b128 v[48:51], v6 offset:26624
    v_mfma_f32_16x16x32_bf16 v[96:99], a[200:203], v[32:35], v[96:99]
    ds_read_b128 v[52:55], v7 offset:27648
    v_mfma_f32_16x16x32_bf16 v[96:99], a[216:219], v[36:39], v[96:99]
    s_waitcnt lgkmcnt(2)
    v_mfma_f32_16x16x32_bf16 v[100:103], a[204:207], v[32:35], v[100:103]
    v_mfma_f32_16x16x32_bf16 v[100:103], a[220:223], v[36:39], v[100:103]
    v_mfma_f32_16x16x32_bf16 v[56:59], a[192:195], v[40:43], v[56:59]
    v_mfma_f32_16x16x32_bf16 v[56:59], a[208:211], v[44:47], v[56:59]
    v_mfma_f32_16x16x32_bf16 v[60:63], a[196:199], v[40:43], v[60:63]
    v_mfma_f32_16x16x32_bf16 v[60:63], a[212:215], v[44:47], v[60:63]
    v_mfma_f32_16x16x32_bf16 v[64:67], a[200:203], v[40:43], v[64:67]
    v_mfma_f32_16x16x32_bf16 v[64:67], a[216:219], v[44:47], v[64:67]
    s_waitcnt lgkmcnt(0)
    v_cvt_pk_bf16_f32 v88, v88, v89
    v_cvt_pk_bf16_f32 v89, v90, v91
    v_mfma_f32_16x16x32_bf16 v[68:71], a[204:207], v[40:43], v[68:71]
    ds_write_b64 v28, v[88:89]
    v_mfma_f32_16x16x32_bf16 v[68:71], a[220:223], v[44:47], v[68:71]
    v_cvt_pk_bf16_f32 v92, v92, v93
    v_cvt_pk_bf16_f32 v93, v94, v95
    v_mfma_f32_16x16x32_bf16 v[72:75], a[192:195], v[48:51], v[72:75]
    ds_write_b64 v29, v[92:93]
    v_mfma_f32_16x16x32_bf16 v[72:75], a[208:211], v[52:55], v[72:75]
    v_cvt_pk_bf16_f32 v96, v96, v97
    v_cvt_pk_bf16_f32 v97, v98, v99
    v_mfma_f32_16x16x32_bf16 v[76:79], a[196:199], v[48:51], v[76:79]
    ds_write_b64 v30, v[96:97]
    v_mfma_f32_16x16x32_bf16 v[76:79], a[212:215], v[52:55], v[76:79]
    v_cvt_pk_bf16_f32 v100, v100, v101
    v_cvt_pk_bf16_f32 v101, v102, v103
    v_mfma_f32_16x16x32_bf16 v[80:83], a[200:203], v[48:51], v[80:83]
    ds_write_b64 v31, v[100:101]
    v_mfma_f32_16x16x32_bf16 v[80:83], a[216:219], v[52:55], v[80:83]
    ds_read_b128 v[88:91], v18
    v_mfma_f32_16x16x32_bf16 v[84:87], a[204:207], v[48:51], v[84:87]
    ds_read2_b64 v[92:95], v18 offset0:129 offset1:128
    v_mfma_f32_16x16x32_bf16 v[84:87], a[220:223], v[52:55], v[84:87]
    s_nop 0
    v_cvt_pk_bf16_f32 v56, v56, v57
    v_cvt_pk_bf16_f32 v57, v58, v59
    ds_write_b64 v28, v[56:57]
    v_cvt_pk_bf16_f32 v60, v60, v61
    v_cvt_pk_bf16_f32 v61, v62, v63
    ds_write_b64 v29, v[60:61]
    v_cvt_pk_bf16_f32 v64, v64, v65
    v_cvt_pk_bf16_f32 v65, v66, v67
    ds_write_b64 v30, v[64:65]
    v_cvt_pk_bf16_f32 v68, v68, v69
    v_cvt_pk_bf16_f32 v69, v70, v71
    ds_write_b64 v31, v[68:69]
    ds_read_b128 v[96:99], v18
    ds_read2_b64 v[100:103], v18 offset0:129 offset1:128
    buffer_load_dwordx4 v[156:159], v0, s[16:19], s55 offen offset:512 nt
    buffer_load_dwordx2 v[160:161], v1, s[16:19], s55 offen nt
    v_cvt_pk_bf16_f32 v72, v72, v73
    v_cvt_pk_bf16_f32 v73, v74, v75
    ds_write_b64 v28, v[72:73]
    v_cvt_pk_bf16_f32 v76, v76, v77
    v_cvt_pk_bf16_f32 v77, v78, v79
    ds_write_b64 v29, v[76:77]
    v_cvt_pk_bf16_f32 v80, v80, v81
    v_cvt_pk_bf16_f32 v81, v82, v83
    ds_write_b64 v30, v[80:81]
    v_cvt_pk_bf16_f32 v84, v84, v85
    v_cvt_pk_bf16_f32 v85, v86, v87
    ds_write_b64 v31, v[84:85]
    ds_read_b128 v[72:75], v18
    ds_read2_b64 v[76:79], v18 offset0:129 offset1:128
    s_waitcnt vmcnt(8)
    s_nop 0
    v_dot2_f32_bf16 v17, v120, s43, 0
    v_dot2_f32_bf16 v17, v121, s43, v17
    v_dot2_f32_bf16 v17, v122, s43, v17
    v_dot2_f32_bf16 v17, v123, s43, v17
    v_dot2_f32_bf16 v17, v124, s43, v17
    v_dot2_f32_bf16 v17, v125, s43, v17
    v_dot2_f32_bf16 v17, v126, s43, v17
    v_dot2_f32_bf16 v17, v127, s43, v17
    v_dot2_f32_bf16 v17, v128, s43, v17
    v_dot2_f32_bf16 v17, v129, s43, v17
    v_dot2_f32_bf16 v17, v130, s43, v17
    v_dot2_f32_bf16 v17, v131, s43, v17
    v_dot2_f32_bf16 v17, v132, s43, v17
    v_dot2_f32_bf16 v17, v133, s43, v17
    s_nop 2
    v_add_f32_dpp v17, v17, v17 row_ror:8 row_mask:0xf bank_mask:0xf
    s_nop 1
    v_add_f32_dpp v17, v17, v17 row_ror:4 row_mask:0xf bank_mask:0xf
    buffer_load_dwordx4 v[106:109], v0, s[16:19], s56 offen offset:0 nt
    s_nop 0
    v_add_f32_dpp v17, v17, v17 row_ror:2 row_mask:0xf bank_mask:0xf
    s_nop 1
    v_add_f32_dpp v17, v17, v17 row_ror:1 row_mask:0xf bank_mask:0xf
    v_mul_f32_e64 v17, s44, v17
    v_dot2_f32_bf16 v172, v120, s41, v17 neg_lo:[0,0,1]
    v_dot2_f32_bf16 v173, v120, s42, v17 neg_lo:[0,0,1]
    v_dot2_f32_bf16 v174, v121, s41, v17 neg_lo:[0,0,1]
    v_dot2_f32_bf16 v175, v121, s42, v17 neg_lo:[0,0,1]
    v_dot2_f32_bf16 v176, v122, s41, v17 neg_lo:[0,0,1]
    v_dot2_f32_bf16 v177, v122, s42, v17 neg_lo:[0,0,1]
    v_dot2_f32_bf16 v178, v123, s41, v17 neg_lo:[0,0,1]
    v_dot2_f32_bf16 v179, v123, s42, v17 neg_lo:[0,0,1]
    v_dot2_f32_bf16 v180, v124, s41, v17 neg_lo:[0,0,1]
    v_dot2_f32_bf16 v181, v124, s42, v17 neg_lo:[0,0,1]
    buffer_load_dwordx4 v[110:113], v0, s[16:19], s56 offen offset:256 nt
    v_dot2_f32_bf16 v182, v125, s41, v17 neg_lo:[0,0,1]
    v_dot2_f32_bf16 v183, v125, s42, v17 neg_lo:[0,0,1]
    v_dot2_f32_bf16 v184, v126, s41, v17 neg_lo:[0,0,1]
    v_dot2_f32_bf16 v185, v126, s42, v17 neg_lo:[0,0,1]
    v_dot2_f32_bf16 v186, v127, s41, v17 neg_lo:[0,0,1]
    v_dot2_f32_bf16 v187, v127, s42, v17 neg_lo:[0,0,1]
    v_dot2_f32_bf16 v188, v128, s41, v17 neg_lo:[0,0,1]
    v_dot2_f32_bf16 v189, v128, s42, v17 neg_lo:[0,0,1]
    v_dot2_f32_bf16 v190, v129, s41, v17 neg_lo:[0,0,1]
    v_dot2_f32_bf16 v191, v129, s42, v17 neg_lo:[0,0,1]
    v_dot2_f32_bf16 v192, v130, s41, v17 neg_lo:[0,0,1]
    v_dot2_f32_bf16 v193, v130, s42, v17 neg_lo:[0,0,1]
    v_dot2_f32_bf16 v194, v131, s41, v17 neg_lo:[0,0,1]
    buffer_load_dwordx4 v[114:117], v0, s[16:19], s56 offen offset:512 nt
    v_dot2_f32_bf16 v195, v131, s42, v17 neg_lo:[0,0,1]
    v_dot2_f32_bf16 v196, v132, s41, v17 neg_lo:[0,0,1]
    v_dot2_f32_bf16 v197, v132, s42, v17 neg_lo:[0,0,1]
    v_dot2_f32_bf16 v198, v133, s41, v17 neg_lo:[0,0,1]
    v_dot2_f32_bf16 v199, v133, s42, v17 neg_lo:[0,0,1]
    v_pk_mul_f32 v[120:121], v[172:173], v[172:173]
    v_pk_fma_f32 v[120:121], v[174:175], v[174:175], v[120:121]
    v_pk_fma_f32 v[120:121], v[176:177], v[176:177], v[120:121]
    v_pk_fma_f32 v[120:121], v[178:179], v[178:179], v[120:121]
    v_pk_fma_f32 v[120:121], v[180:181], v[180:181], v[120:121]
    v_pk_fma_f32 v[120:121], v[182:183], v[182:183], v[120:121]
    v_pk_fma_f32 v[120:121], v[184:185], v[184:185], v[120:121]
    v_pk_fma_f32 v[120:121], v[186:187], v[186:187], v[120:121]
    v_pk_fma_f32 v[120:121], v[188:189], v[188:189], v[120:121]
    buffer_load_dwordx2 v[118:119], v1, s[16:19], s56 offen nt
    v_pk_fma_f32 v[120:121], v[190:191], v[190:191], v[120:121]
    v_pk_fma_f32 v[120:121], v[192:193], v[192:193], v[120:121]
    v_pk_fma_f32 v[120:121], v[194:195], v[194:195], v[120:121]
    v_pk_fma_f32 v[120:121], v[196:197], v[196:197], v[120:121]
    v_pk_fma_f32 v[120:121], v[198:199], v[198:199], v[120:121]
    v_add_f32_e64 v120, v120, v121
    v_pk_mul_f32 v[172:173], v[172:173], v[228:229]
    v_pk_mul_f32 v[174:175], v[174:175], v[230:231]
    v_add_f32_dpp v120, v120, v120 row_ror:8 row_mask:0xf bank_mask:0xf
    v_pk_mul_f32 v[176:177], v[176:177], v[232:233]
    v_pk_mul_f32 v[178:179], v[178:179], v[234:235]
    v_add_f32_dpp v120, v120, v120 row_ror:4 row_mask:0xf bank_mask:0xf
    v_pk_mul_f32 v[180:181], v[180:181], v[236:237]
    buffer_load_dwordx4 v[56:59], v0, s[16:19], s57 offen offset:0 nt
    v_pk_mul_f32 v[182:183], v[182:183], v[238:239]
    v_add_f32_dpp v120, v120, v120 row_ror:2 row_mask:0xf bank_mask:0xf
    v_pk_mul_f32 v[184:185], v[184:185], v[240:241]
    v_pk_mul_f32 v[186:187], v[186:187], v[242:243]
    v_add_f32_dpp v120, v120, v120 row_ror:1 row_mask:0xf bank_mask:0xf
    v_fma_f32 v120, v120, s44, v16
    v_rsq_f32_e64 v122, v120
    v_pk_mul_f32 v[188:189], v[188:189], v[244:245]
    v_pk_mul_f32 v[190:191], v[190:191], v[246:247]
    v_pk_mul_f32 v[192:193], v[192:193], v[248:249]
    v_pk_mul_f32 v[194:195], v[194:195], v[250:251]
    v_pk_mul_f32 v[196:197], v[196:197], v[252:253]
    v_pk_mul_f32 v[198:199], v[198:199], v[254:255]
    v_pk_fma_f32 v[172:173], v[172:173], v[122:123], v[200:201] op_sel_hi:[1,0,1]
    buffer_load_dwordx4 v[60:63], v0, s[16:19], s57 offen offset:256 nt
    v_pk_fma_f32 v[174:175], v[174:175], v[122:123], v[202:203] op_sel_hi:[1,0,1]
    v_pk_fma_f32 v[176:177], v[176:177], v[122:123], v[204:205] op_sel_hi:[1,0,1]
    v_pk_fma_f32 v[178:179], v[178:179], v[122:123], v[206:207] op_sel_hi:[1,0,1]
    v_cvt_pk_bf16_f32 v172, v172, v173
    v_cvt_pk_bf16_f32 v173, v174, v175
    v_cvt_pk_bf16_f32 v174, v176, v177
    v_cvt_pk_bf16_f32 v175, v178, v179
    ds_write_b128 v14, v[172:175] offset:43008
    v_pk_fma_f32 v[180:181], v[180:181], v[122:123], v[208:209] op_sel_hi:[1,0,1]
    v_pk_fma_f32 v[182:183], v[182:183], v[122:123], v[210:211] op_sel_hi:[1,0,1]
    v_pk_fma_f32 v[184:185], v[184:185], v[122:123], v[212:213] op_sel_hi:[1,0,1]
    v_pk_fma_f32 v[186:187], v[186:187], v[122:123], v[214:215] op_sel_hi:[1,0,1]
    v_cvt_pk_bf16_f32 v180, v180, v181
    buffer_load_dwordx4 v[64:67], v0, s[16:19], s57 offen offset:512 nt
    v_cvt_pk_bf16_f32 v181, v182, v183
    v_cvt_pk_bf16_f32 v182, v184, v185
    v_cvt_pk_bf16_f32 v183, v186, v187
    ds_write_b128 v14, v[180:183] offset:47104
    v_pk_fma_f32 v[188:189], v[188:189], v[122:123], v[216:217] op_sel_hi:[1,0,1]
    v_pk_fma_f32 v[190:191], v[190:191], v[122:123], v[218:219] op_sel_hi:[1,0,1]
    v_pk_fma_f32 v[192:193], v[192:193], v[122:123], v[220:221] op_sel_hi:[1,0,1]
    v_pk_fma_f32 v[194:195], v[194:195], v[122:123], v[222:223] op_sel_hi:[1,0,1]
    v_cvt_pk_bf16_f32 v188, v188, v189
    v_cvt_pk_bf16_f32 v189, v190, v191
    s_waitcnt vmcnt(11)
    s_nop 0
    v_dot2_f32_bf16 v17, v134, s43, 0
    v_dot2_f32_bf16 v17, v135, s43, v17
    v_dot2_f32_bf16 v17, v136, s43, v17
    v_dot2_f32_bf16 v17, v137, s43, v17
    buffer_load_dwordx2 v[68:69], v1, s[16:19], s57 offen nt
    v_dot2_f32_bf16 v17, v138, s43, v17
    v_dot2_f32_bf16 v17, v139, s43, v17
    v_dot2_f32_bf16 v17, v140, s43, v17
    v_dot2_f32_bf16 v17, v141, s43, v17
    v_dot2_f32_bf16 v17, v142, s43, v17
    v_dot2_f32_bf16 v17, v143, s43, v17
    v_dot2_f32_bf16 v17, v144, s43, v17
    v_dot2_f32_bf16 v17, v145, s43, v17
    v_dot2_f32_bf16 v17, v146, s43, v17
    v_dot2_f32_bf16 v17, v147, s43, v17
    v_cvt_pk_bf16_f32 v190, v192, v193
    v_cvt_pk_bf16_f32 v191, v194, v195
    ds_write_b128 v14, v[188:191] offset:51200
    v_add_f32_dpp v17, v17, v17 row_ror:8 row_mask:0xf bank_mask:0xf
    v_pk_fma_f32 v[196:197], v[196:197], v[122:123], v[224:225] op_sel_hi:[1,0,1]
    v_pk_fma_f32 v[198:199], v[198:199], v[122:123], v[226:227] op_sel_hi:[1,0,1]
    v_add_f32_dpp v17, v17, v17 row_ror:4 row_mask:0xf bank_mask:0xf
    v_cvt_pk_bf16_f32 v196, v196, v197
    v_cvt_pk_bf16_f32 v197, v198, v199
    v_add_f32_dpp v17, v17, v17 row_ror:2 row_mask:0xf bank_mask:0xf
    ds_write_b64 v15, v[196:197] offset:43008
    v_add_u32 v14, 57344, v14
    v_add_f32_dpp v17, v17, v17 row_ror:1 row_mask:0xf bank_mask:0xf
    v_add_u32 v15, 57344, v15
    v_mul_f32_e64 v17, s44, v17
    v_dot2_f32_bf16 v172, v134, s41, v17 neg_lo:[0,0,1]
    v_dot2_f32_bf16 v173, v134, s42, v17 neg_lo:[0,0,1]
    v_dot2_f32_bf16 v174, v135, s41, v17 neg_lo:[0,0,1]
    v_dot2_f32_bf16 v175, v135, s42, v17 neg_lo:[0,0,1]
    v_dot2_f32_bf16 v176, v136, s41, v17 neg_lo:[0,0,1]
    v_dot2_f32_bf16 v177, v136, s42, v17 neg_lo:[0,0,1]
    v_dot2_f32_bf16 v178, v137, s41, v17 neg_lo:[0,0,1]
    v_dot2_f32_bf16 v179, v137, s42, v17 neg_lo:[0,0,1]
    v_dot2_f32_bf16 v180, v138, s41, v17 neg_lo:[0,0,1]
    v_dot2_f32_bf16 v181, v138, s42, v17 neg_lo:[0,0,1]
    v_dot2_f32_bf16 v182, v139, s41, v17 neg_lo:[0,0,1]
    v_dot2_f32_bf16 v183, v139, s42, v17 neg_lo:[0,0,1]
    v_dot2_f32_bf16 v184, v140, s41, v17 neg_lo:[0,0,1]
    v_dot2_f32_bf16 v185, v140, s42, v17 neg_lo:[0,0,1]
    v_dot2_f32_bf16 v186, v141, s41, v17 neg_lo:[0,0,1]
    v_dot2_f32_bf16 v187, v141, s42, v17 neg_lo:[0,0,1]
    v_dot2_f32_bf16 v188, v142, s41, v17 neg_lo:[0,0,1]
    v_dot2_f32_bf16 v189, v142, s42, v17 neg_lo:[0,0,1]
    v_dot2_f32_bf16 v190, v143, s41, v17 neg_lo:[0,0,1]
    v_dot2_f32_bf16 v191, v143, s42, v17 neg_lo:[0,0,1]
    v_dot2_f32_bf16 v192, v144, s41, v17 neg_lo:[0,0,1]
    v_dot2_f32_bf16 v193, v144, s42, v17 neg_lo:[0,0,1]
    v_dot2_f32_bf16 v194, v145, s41, v17 neg_lo:[0,0,1]
    v_dot2_f32_bf16 v195, v145, s42, v17 neg_lo:[0,0,1]
    v_dot2_f32_bf16 v196, v146, s41, v17 neg_lo:[0,0,1]
    v_dot2_f32_bf16 v197, v146, s42, v17 neg_lo:[0,0,1]
    v_dot2_f32_bf16 v198, v147, s41, v17 neg_lo:[0,0,1]
    v_dot2_f32_bf16 v199, v147, s42, v17 neg_lo:[0,0,1]
    v_pk_mul_f32 v[134:135], v[172:173], v[172:173]
    v_pk_fma_f32 v[134:135], v[174:175], v[174:175], v[134:135]
    v_pk_fma_f32 v[134:135], v[176:177], v[176:177], v[134:135]
    v_pk_fma_f32 v[134:135], v[178:179], v[178:179], v[134:135]
    v_pk_fma_f32 v[134:135], v[180:181], v[180:181], v[134:135]
    v_pk_fma_f32 v[134:135], v[182:183], v[182:183], v[134:135]
    v_pk_fma_f32 v[134:135], v[184:185], v[184:185], v[134:135]
    v_pk_fma_f32 v[134:135], v[186:187], v[186:187], v[134:135]
    v_pk_fma_f32 v[134:135], v[188:189], v[188:189], v[134:135]
    v_pk_fma_f32 v[134:135], v[190:191], v[190:191], v[134:135]
    v_pk_fma_f32 v[134:135], v[192:193], v[192:193], v[134:135]
    v_pk_fma_f32 v[134:135], v[194:195], v[194:195], v[134:135]
    v_pk_fma_f32 v[134:135], v[196:197], v[196:197], v[134:135]
    v_pk_fma_f32 v[134:135], v[198:199], v[198:199], v[134:135]
    v_add_f32_e64 v134, v134, v135
    v_pk_mul_f32 v[172:173], v[172:173], v[228:229]
    v_pk_mul_f32 v[174:175], v[174:175], v[230:231]
    v_add_f32_dpp v134, v134, v134 row_ror:8 row_mask:0xf bank_mask:0xf
    v_pk_mul_f32 v[176:177], v[176:177], v[232:233]
    v_pk_mul_f32 v[178:179], v[178:179], v[234:235]
    v_add_f32_dpp v134, v134, v134 row_ror:4 row_mask:0xf bank_mask:0xf
    v_pk_mul_f32 v[180:181], v[180:181], v[236:237]
    v_pk_mul_f32 v[182:183], v[182:183], v[238:239]
    v_add_f32_dpp v134, v134, v134 row_ror:2 row_mask:0xf bank_mask:0xf
    v_pk_mul_f32 v[184:185], v[184:185], v[240:241]
    v_pk_mul_f32 v[186:187], v[186:187], v[242:243]
    v_add_f32_dpp v134, v134, v134 row_ror:1 row_mask:0xf bank_mask:0xf
    v_fma_f32 v134, v134, s44, v16
    v_rsq_f32_e64 v136, v134
    v_pk_mul_f32 v[188:189], v[188:189], v[244:245]
    v_pk_mul_f32 v[190:191], v[190:191], v[246:247]
    v_pk_mul_f32 v[192:193], v[192:193], v[248:249]
    s_lshr_b32 s39, s2, 4
    s_lshl_b32 s39, s39, 2
    s_add_u32 s39, s39, s3
    s_mul_i32 s39, s39, 6272
    v_lshrrev_b32 v166, 7, v25
    v_min_u32_e64 v166, 20, v166
    v_mul_u32_u24 v167, 86, v166
    v_lshrrev_b32 v167, 8, v167
    v_lshlrev_b32 v167, 9, v167
    v_lshl_add_u32 v166, v166, 7, v167
    buffer_load_dword v167, v166, s[20:23], s39 offen offset:2560
    v_pk_mul_f32 v[194:195], v[194:195], v[250:251]
    v_pk_mul_f32 v[196:197], v[196:197], v[252:253]
    v_pk_mul_f32 v[198:199], v[198:199], v[254:255]
    v_pk_fma_f32 v[172:173], v[172:173], v[136:137], v[200:201] op_sel_hi:[1,0,1]
    v_pk_fma_f32 v[174:175], v[174:175], v[136:137], v[202:203] op_sel_hi:[1,0,1]
    v_pk_fma_f32 v[176:177], v[176:177], v[136:137], v[204:205] op_sel_hi:[1,0,1]
    v_pk_fma_f32 v[178:179], v[178:179], v[136:137], v[206:207] op_sel_hi:[1,0,1]
    v_cvt_pk_bf16_f32 v172, v172, v173
    v_cvt_pk_bf16_f32 v173, v174, v175
    v_cvt_pk_bf16_f32 v174, v176, v177
    v_cvt_pk_bf16_f32 v175, v178, v179
    ds_write_b128 v14, v[172:175] offset:0
    v_pk_fma_f32 v[180:181], v[180:181], v[136:137], v[208:209] op_sel_hi:[1,0,1]
    v_pk_fma_f32 v[182:183], v[182:183], v[136:137], v[210:211] op_sel_hi:[1,0,1]
    v_pk_fma_f32 v[184:185], v[184:185], v[136:137], v[212:213] op_sel_hi:[1,0,1]
    v_pk_fma_f32 v[186:187], v[186:187], v[136:137], v[214:215] op_sel_hi:[1,0,1]
    v_cvt_pk_bf16_f32 v180, v180, v181
    v_cvt_pk_bf16_f32 v181, v182, v183
    v_cvt_pk_bf16_f32 v182, v184, v185
    v_cvt_pk_bf16_f32 v183, v186, v187
    ds_write_b128 v14, v[180:183] offset:4096
    v_pk_fma_f32 v[188:189], v[188:189], v[136:137], v[216:217] op_sel_hi:[1,0,1]
    v_pk_fma_f32 v[190:191], v[190:191], v[136:137], v[218:219] op_sel_hi:[1,0,1]
    v_pk_fma_f32 v[192:193], v[192:193], v[136:137], v[220:221] op_sel_hi:[1,0,1]
    v_pk_fma_f32 v[194:195], v[194:195], v[136:137], v[222:223] op_sel_hi:[1,0,1]
    s_waitcnt vmcnt(9)
    s_nop 0
    v_dot2_f32_bf16 v17, v148, s43, 0
    v_dot2_f32_bf16 v17, v149, s43, v17
    v_dot2_f32_bf16 v17, v150, s43, v17
    v_dot2_f32_bf16 v17, v151, s43, v17
    v_dot2_f32_bf16 v17, v152, s43, v17
    v_dot2_f32_bf16 v17, v153, s43, v17
    v_dot2_f32_bf16 v17, v154, s43, v17
    v_dot2_f32_bf16 v17, v155, s43, v17
    v_dot2_f32_bf16 v17, v156, s43, v17
    v_dot2_f32_bf16 v17, v157, s43, v17
    v_dot2_f32_bf16 v17, v158, s43, v17
    v_dot2_f32_bf16 v17, v159, s43, v17
    v_dot2_f32_bf16 v17, v160, s43, v17
    v_dot2_f32_bf16 v17, v161, s43, v17
    v_cvt_pk_bf16_f32 v188, v188, v189
    v_cvt_pk_bf16_f32 v189, v190, v191
    v_cvt_pk_bf16_f32 v190, v192, v193
    v_add_f32_dpp v17, v17, v17 row_ror:8 row_mask:0xf bank_mask:0xf
    v_cvt_pk_bf16_f32 v191, v194, v195
    ds_write_b128 v14, v[188:191] offset:8192
    v_add_f32_dpp v17, v17, v17 row_ror:4 row_mask:0xf bank_mask:0xf
    v_pk_fma_f32 v[196:197], v[196:197], v[136:137], v[224:225] op_sel_hi:[1,0,1]
    v_pk_fma_f32 v[198:199], v[198:199], v[136:137], v[226:227] op_sel_hi:[1,0,1]
    v_add_f32_dpp v17, v17, v17 row_ror:2 row_mask:0xf bank_mask:0xf
    v_cvt_pk_bf16_f32 v196, v196, v197
    v_cvt_pk_bf16_f32 v197, v198, v199
    v_add_f32_dpp v17, v17, v17 row_ror:1 row_mask:0xf bank_mask:0xf
    ds_write_b64 v15, v[196:197] offset:0
    v_mul_f32_e64 v17, s44, v17
    v_dot2_f32_bf16 v172, v148, s41, v17 neg_lo:[0,0,1]
    v_dot2_f32_bf16 v173, v148, s42, v17 neg_lo:[0,0,1]
    v_dot2_f32_bf16 v174, v149, s41, v17 neg_lo:[0,0,1]
    v_dot2_f32_bf16 v175, v149, s42, v17 neg_lo:[0,0,1]
    v_dot2_f32_bf16 v176, v150, s41, v17 neg_lo:[0,0,1]
    v_dot2_f32_bf16 v177, v150, s42, v17 neg_lo:[0,0,1]
    v_dot2_f32_bf16 v178, v151, s41, v17 neg_lo:[0,0,1]
    v_dot2_f32_bf16 v179, v151, s42, v17 neg_lo:[0,0,1]
    v_dot2_f32_bf16 v180, v152, s41, v17 neg_lo:[0,0,1]
    v_dot2_f32_bf16 v181, v152, s42, v17 neg_lo:[0,0,1]
    v_dot2_f32_bf16 v182, v153, s41, v17 neg_lo:[0,0,1]
    v_dot2_f32_bf16 v183, v153, s42, v17 neg_lo:[0,0,1]
    v_dot2_f32_bf16 v184, v154, s41, v17 neg_lo:[0,0,1]
    v_dot2_f32_bf16 v185, v154, s42, v17 neg_lo:[0,0,1]
    v_dot2_f32_bf16 v186, v155, s41, v17 neg_lo:[0,0,1]
    v_dot2_f32_bf16 v187, v155, s42, v17 neg_lo:[0,0,1]
    v_dot2_f32_bf16 v188, v156, s41, v17 neg_lo:[0,0,1]
    v_dot2_f32_bf16 v189, v156, s42, v17 neg_lo:[0,0,1]
    v_dot2_f32_bf16 v190, v157, s41, v17 neg_lo:[0,0,1]
    v_dot2_f32_bf16 v191, v157, s42, v17 neg_lo:[0,0,1]
    v_dot2_f32_bf16 v192, v158, s41, v17 neg_lo:[0,0,1]
    v_dot2_f32_bf16 v193, v158, s42, v17 neg_lo:[0,0,1]
    v_dot2_f32_bf16 v194, v159, s41, v17 neg_lo:[0,0,1]
    v_dot2_f32_bf16 v195, v159, s42, v17 neg_lo:[0,0,1]
    v_dot2_f32_bf16 v196, v160, s41, v17 neg_lo:[0,0,1]
    v_dot2_f32_bf16 v197, v160, s42, v17 neg_lo:[0,0,1]
    v_dot2_f32_bf16 v198, v161, s41, v17 neg_lo:[0,0,1]
    v_dot2_f32_bf16 v199, v161, s42, v17 neg_lo:[0,0,1]
    v_pk_mul_f32 v[148:149], v[172:173], v[172:173]
    v_pk_fma_f32 v[148:149], v[174:175], v[174:175], v[148:149]
    v_pk_fma_f32 v[148:149], v[176:177], v[176:177], v[148:149]
    v_pk_fma_f32 v[148:149], v[178:179], v[178:179], v[148:149]
    v_pk_fma_f32 v[148:149], v[180:181], v[180:181], v[148:149]
    v_pk_fma_f32 v[148:149], v[182:183], v[182:183], v[148:149]
    v_pk_fma_f32 v[148:149], v[184:185], v[184:185], v[148:149]
    v_pk_fma_f32 v[148:149], v[186:187], v[186:187], v[148:149]
    v_pk_fma_f32 v[148:149], v[188:189], v[188:189], v[148:149]
    v_pk_fma_f32 v[148:149], v[190:191], v[190:191], v[148:149]
    v_pk_fma_f32 v[148:149], v[192:193], v[192:193], v[148:149]
    v_pk_fma_f32 v[148:149], v[194:195], v[194:195], v[148:149]
    s_add_u32 m0, s38, 5120
    s_nop 0
    buffer_load_dwordx4 v2, s[20:23], 0 offen offset:1024 lds
    v_pk_fma_f32 v[148:149], v[196:197], v[196:197], v[148:149]
    v_pk_fma_f32 v[148:149], v[198:199], v[198:199], v[148:149]
    v_add_f32 v148, v148, v149
    v_pk_mul_f32 v[172:173], v[172:173], v[228:229]
    v_pk_mul_f32 v[174:175], v[174:175], v[230:231]
    v_add_f32_dpp v148, v148, v148 row_ror:8 row_mask:0xf bank_mask:0xf
    v_pk_mul_f32 v[176:177], v[176:177], v[232:233]
    v_pk_mul_f32 v[178:179], v[178:179], v[234:235]
    v_add_f32_dpp v148, v148, v148 row_ror:4 row_mask:0xf bank_mask:0xf
    v_pk_mul_f32 v[180:181], v[180:181], v[236:237]
    v_pk_mul_f32 v[182:183], v[182:183], v[238:239]
    v_add_f32_dpp v148, v148, v148 row_ror:2 row_mask:0xf bank_mask:0xf
    v_pk_mul_f32 v[184:185], v[184:185], v[240:241]
    v_pk_mul_f32 v[186:187], v[186:187], v[242:243]
    v_add_f32_dpp v148, v148, v148 row_ror:1 row_mask:0xf bank_mask:0xf
    s_add_u32 m0, s38, 5120
    s_nop 0
    buffer_load_dwordx4 v3, s[20:23], 0 offen offset:2048 lds
    v_fma_f32 v148, v148, s44, v16
    v_rsq_f32 v150, v148
    v_pk_mul_f32 v[188:189], v[188:189], v[244:245]
    v_pk_mul_f32 v[190:191], v[190:191], v[246:247]
    v_pk_mul_f32 v[192:193], v[192:193], v[248:249]
    v_pk_mul_f32 v[194:195], v[194:195], v[250:251]
    v_pk_mul_f32 v[196:197], v[196:197], v[252:253]
    v_pk_mul_f32 v[198:199], v[198:199], v[254:255]
    v_pk_fma_f32 v[172:173], v[172:173], v[150:151], v[200:201] op_sel_hi:[1,0,1]
    v_pk_fma_f32 v[174:175], v[174:175], v[150:151], v[202:203] op_sel_hi:[1,0,1]
    v_pk_fma_f32 v[176:177], v[176:177], v[150:151], v[204:205] op_sel_hi:[1,0,1]
    v_pk_fma_f32 v[178:179], v[178:179], v[150:151], v[206:207] op_sel_hi:[1,0,1]
    v_cvt_pk_bf16_f32 v172, v172, v173
    v_cvt_pk_bf16_f32 v173, v174, v175
    v_cvt_pk_bf16_f32 v174, v176, v177
    s_add_u32 m0, s38, 8192
    s_nop 0
    s_nop 0
    buffer_load_dwordx4 v4, s[20:23], 0 offen offset:0 lds
    v_cvt_pk_bf16_f32 v175, v178, v179
    ds_write_b128 v14, v[172:175] offset:14336
    v_pk_fma_f32 v[180:181], v[180:181], v[150:151], v[208:209] op_sel_hi:[1,0,1]
    v_pk_fma_f32 v[182:183], v[182:183], v[150:151], v[210:211] op_sel_hi:[1,0,1]
    v_pk_fma_f32 v[184:185], v[184:185], v[150:151], v[212:213] op_sel_hi:[1,0,1]
    v_pk_fma_f32 v[186:187], v[186:187], v[150:151], v[214:215] op_sel_hi:[1,0,1]
    v_cvt_pk_bf16_f32 v180, v180, v181
    v_cvt_pk_bf16_f32 v181, v182, v183
    v_cvt_pk_bf16_f32 v182, v184, v185
    v_cvt_pk_bf16_f32 v183, v186, v187
    ds_write_b128 v14, v[180:183] offset:18432
    v_pk_fma_f32 v[188:189], v[188:189], v[150:151], v[216:217] op_sel_hi:[1,0,1]
    v_pk_fma_f32 v[190:191], v[190:191], v[150:151], v[218:219] op_sel_hi:[1,0,1]
    v_pk_fma_f32 v[192:193], v[192:193], v[150:151], v[220:221] op_sel_hi:[1,0,1]
    v_pk_fma_f32 v[194:195], v[194:195], v[150:151], v[222:223] op_sel_hi:[1,0,1]
    s_add_u32 m0, s38, 8192
    s_nop 0
    buffer_load_dwordx4 v2, s[20:23], s28 offen offset:1024 lds
    s_waitcnt vmcnt(9)
    v_dot2_f32_bf16 v17, v106, s43, 0
    v_dot2_f32_bf16 v17, v107, s43, v17
    v_dot2_f32_bf16 v17, v108, s43, v17
    v_dot2_f32_bf16 v17, v109, s43, v17
    v_dot2_f32_bf16 v17, v110, s43, v17
    v_dot2_f32_bf16 v17, v111, s43, v17
    v_dot2_f32_bf16 v17, v112, s43, v17
    v_dot2_f32_bf16 v17, v113, s43, v17
    v_dot2_f32_bf16 v17, v114, s43, v17
    v_dot2_f32_bf16 v17, v115, s43, v17
    v_dot2_f32_bf16 v17, v116, s43, v17
    v_dot2_f32_bf16 v17, v117, s43, v17
    v_dot2_f32_bf16 v17, v118, s43, v17
    v_dot2_f32_bf16 v17, v119, s43, v17
    v_cvt_pk_bf16_f32 v188, v188, v189
    v_cvt_pk_bf16_f32 v189, v190, v191
    v_cvt_pk_bf16_f32 v190, v192, v193
    v_add_f32_dpp v17, v17, v17 row_ror:8 row_mask:0xf bank_mask:0xf
    v_cvt_pk_bf16_f32 v191, v194, v195
    ds_write_b128 v14, v[188:191] offset:22528
    v_add_f32_dpp v17, v17, v17 row_ror:4 row_mask:0xf bank_mask:0xf
    v_pk_fma_f32 v[196:197], v[196:197], v[150:151], v[224:225] op_sel_hi:[1,0,1]
    v_pk_fma_f32 v[198:199], v[198:199], v[150:151], v[226:227] op_sel_hi:[1,0,1]
    v_add_f32_dpp v17, v17, v17 row_ror:2 row_mask:0xf bank_mask:0xf
    v_cvt_pk_bf16_f32 v196, v196, v197
    v_cvt_pk_bf16_f32 v197, v198, v199
    v_add_f32_dpp v17, v17, v17 row_ror:1 row_mask:0xf bank_mask:0xf
    ds_write_b64 v15, v[196:197] offset:14336
    v_mul_f32_e64 v17, s44, v17
    v_dot2_f32_bf16 v172, v106, s41, v17 neg_lo:[0,0,1]
    v_dot2_f32_bf16 v173, v106, s42, v17 neg_lo:[0,0,1]
    s_add_u32 m0, s38, 4294965248
    s_nop 0
    s_nop 0
    buffer_load_dwordx4 v3, s[20:23], s28 offen offset:2048 lds
    v_dot2_f32_bf16 v174, v107, s41, v17 neg_lo:[0,0,1]
    v_dot2_f32_bf16 v175, v107, s42, v17 neg_lo:[0,0,1]
    v_dot2_f32_bf16 v176, v108, s41, v17 neg_lo:[0,0,1]
    v_dot2_f32_bf16 v177, v108, s42, v17 neg_lo:[0,0,1]
    v_dot2_f32_bf16 v178, v109, s41, v17 neg_lo:[0,0,1]
    v_dot2_f32_bf16 v179, v109, s42, v17 neg_lo:[0,0,1]
    v_dot2_f32_bf16 v180, v110, s41, v17 neg_lo:[0,0,1]
    v_dot2_f32_bf16 v181, v110, s42, v17 neg_lo:[0,0,1]
    v_dot2_f32_bf16 v182, v111, s41, v17 neg_lo:[0,0,1]
    v_dot2_f32_bf16 v183, v111, s42, v17 neg_lo:[0,0,1]
    v_dot2_f32_bf16 v184, v112, s41, v17 neg_lo:[0,0,1]
    v_dot2_f32_bf16 v185, v112, s42, v17 neg_lo:[0,0,1]
    v_dot2_f32_bf16 v186, v113, s41, v17 neg_lo:[0,0,1]
    v_dot2_f32_bf16 v187, v113, s42, v17 neg_lo:[0,0,1]
    v_dot2_f32_bf16 v188, v114, s41, v17 neg_lo:[0,0,1]
    v_dot2_f32_bf16 v189, v114, s42, v17 neg_lo:[0,0,1]
    v_dot2_f32_bf16 v190, v115, s41, v17 neg_lo:[0,0,1]
    v_dot2_f32_bf16 v191, v115, s42, v17 neg_lo:[0,0,1]
    v_dot2_f32_bf16 v192, v116, s41, v17 neg_lo:[0,0,1]
    v_dot2_f32_bf16 v193, v116, s42, v17 neg_lo:[0,0,1]
    s_add_u32 m0, s38, 1024
    s_nop 0
    s_nop 0
    buffer_load_dwordx4 v4, s[20:23], s28 offen offset:0 lds
    v_dot2_f32_bf16 v194, v117, s41, v17 neg_lo:[0,0,1]
    v_dot2_f32_bf16 v195, v117, s42, v17 neg_lo:[0,0,1]
    v_dot2_f32_bf16 v196, v118, s41, v17 neg_lo:[0,0,1]
    v_dot2_f32_bf16 v197, v118, s42, v17 neg_lo:[0,0,1]
    v_dot2_f32_bf16 v198, v119, s41, v17 neg_lo:[0,0,1]
    v_dot2_f32_bf16 v199, v119, s42, v17 neg_lo:[0,0,1]
    v_pk_mul_f32 v[106:107], v[172:173], v[172:173]
    v_pk_fma_f32 v[106:107], v[174:175], v[174:175], v[106:107]
    v_pk_fma_f32 v[106:107], v[176:177], v[176:177], v[106:107]
    v_pk_fma_f32 v[106:107], v[178:179], v[178:179], v[106:107]
    v_pk_fma_f32 v[106:107], v[180:181], v[180:181], v[106:107]
    v_pk_fma_f32 v[106:107], v[182:183], v[182:183], v[106:107]
    v_pk_fma_f32 v[106:107], v[184:185], v[184:185], v[106:107]
    v_pk_fma_f32 v[106:107], v[186:187], v[186:187], v[106:107]
    v_pk_fma_f32 v[106:107], v[188:189], v[188:189], v[106:107]
    v_pk_fma_f32 v[106:107], v[190:191], v[190:191], v[106:107]
    v_pk_fma_f32 v[106:107], v[192:193], v[192:193], v[106:107]
    v_pk_fma_f32 v[106:107], v[194:195], v[194:195], v[106:107]
    v_pk_fma_f32 v[106:107], v[196:197], v[196:197], v[106:107]
    v_pk_fma_f32 v[106:107], v[198:199], v[198:199], v[106:107]
    v_add_f32_e64 v106, v106, v107
    s_add_u32 m0, s38, 1024
    s_nop 0
    s_nop 0
    buffer_load_dwordx4 v2, s[20:23], s29 offen offset:1024 lds
    v_pk_mul_f32 v[172:173], v[172:173], v[228:229]
    v_pk_mul_f32 v[174:175], v[174:175], v[230:231]
    v_add_f32_dpp v106, v106, v106 row_ror:8 row_mask:0xf bank_mask:0xf
    v_pk_mul_f32 v[176:177], v[176:177], v[232:233]
    v_pk_mul_f32 v[178:179], v[178:179], v[234:235]
    v_add_f32_dpp v106, v106, v106 row_ror:4 row_mask:0xf bank_mask:0xf
    v_pk_mul_f32 v[180:181], v[180:181], v[236:237]
    v_pk_mul_f32 v[182:183], v[182:183], v[238:239]
    v_add_f32_dpp v106, v106, v106 row_ror:2 row_mask:0xf bank_mask:0xf
    v_pk_mul_f32 v[184:185], v[184:185], v[240:241]
    v_pk_mul_f32 v[186:187], v[186:187], v[242:243]
    v_add_f32_dpp v106, v106, v106 row_ror:1 row_mask:0xf bank_mask:0xf
    v_fma_f32 v106, v106, s44, v16
    v_rsq_f32_e64 v108, v106
    v_pk_mul_f32 v[188:189], v[188:189], v[244:245]
    v_pk_mul_f32 v[190:191], v[190:191], v[246:247]
    v_pk_mul_f32 v[192:193], v[192:193], v[248:249]
    v_pk_mul_f32 v[194:195], v[194:195], v[250:251]
    v_pk_mul_f32 v[196:197], v[196:197], v[252:253]
    v_pk_mul_f32 v[198:199], v[198:199], v[254:255]
    v_pk_fma_f32 v[172:173], v[172:173], v[108:109], v[200:201] op_sel_hi:[1,0,1]
    s_add_u32 m0, s38, 1024
    s_nop 0
    s_nop 0
    buffer_load_dwordx4 v3, s[20:23], s29 offen offset:2048 lds
    v_pk_fma_f32 v[174:175], v[174:175], v[108:109], v[202:203] op_sel_hi:[1,0,1]
    v_pk_fma_f32 v[176:177], v[176:177], v[108:109], v[204:205] op_sel_hi:[1,0,1]
    v_pk_fma_f32 v[178:179], v[178:179], v[108:109], v[206:207] op_sel_hi:[1,0,1]
    v_cvt_pk_bf16_f32 v172, v172, v173
    v_cvt_pk_bf16_f32 v173, v174, v175
    v_cvt_pk_bf16_f32 v174, v176, v177
    v_cvt_pk_bf16_f32 v175, v178, v179
    ds_write_b128 v14, v[172:175] offset:28672
    v_pk_fma_f32 v[180:181], v[180:181], v[108:109], v[208:209] op_sel_hi:[1,0,1]
    v_pk_fma_f32 v[182:183], v[182:183], v[108:109], v[210:211] op_sel_hi:[1,0,1]
    v_pk_fma_f32 v[184:185], v[184:185], v[108:109], v[212:213] op_sel_hi:[1,0,1]
    v_pk_fma_f32 v[186:187], v[186:187], v[108:109], v[214:215] op_sel_hi:[1,0,1]
    v_cvt_pk_bf16_f32 v180, v180, v181
    v_cvt_pk_bf16_f32 v181, v182, v183
    v_cvt_pk_bf16_f32 v182, v184, v185
    v_cvt_pk_bf16_f32 v183, v186, v187
    ds_write_b128 v14, v[180:183] offset:32768
    v_pk_fma_f32 v[188:189], v[188:189], v[108:109], v[216:217] op_sel_hi:[1,0,1]
    v_pk_fma_f32 v[190:191], v[190:191], v[108:109], v[218:219] op_sel_hi:[1,0,1]
    v_pk_fma_f32 v[192:193], v[192:193], v[108:109], v[220:221] op_sel_hi:[1,0,1]
    v_pk_fma_f32 v[194:195], v[194:195], v[108:109], v[222:223] op_sel_hi:[1,0,1]
    s_add_u32 m0, s38, 4096
    s_nop 0
    buffer_load_dwordx4 v4, s[20:23], s29 offen offset:0 lds
    s_waitcnt vmcnt(10)
    v_dot2_f32_bf16 v17, v56, s43, 0
    v_dot2_f32_bf16 v17, v57, s43, v17
    v_dot2_f32_bf16 v17, v58, s43, v17
    v_dot2_f32_bf16 v17, v59, s43, v17
    v_dot2_f32_bf16 v17, v60, s43, v17
    v_dot2_f32_bf16 v17, v61, s43, v17
    v_dot2_f32_bf16 v17, v62, s43, v17
    v_dot2_f32_bf16 v17, v63, s43, v17
    v_dot2_f32_bf16 v17, v64, s43, v17
    v_dot2_f32_bf16 v17, v65, s43, v17
    v_dot2_f32_bf16 v17, v66, s43, v17
    v_dot2_f32_bf16 v17, v67, s43, v17
    v_dot2_f32_bf16 v17, v68, s43, v17
    v_dot2_f32_bf16 v17, v69, s43, v17
    v_cvt_pk_bf16_f32 v188, v188, v189
    v_cvt_pk_bf16_f32 v189, v190, v191
    v_cvt_pk_bf16_f32 v190, v192, v193
    v_add_f32_dpp v17, v17, v17 row_ror:8 row_mask:0xf bank_mask:0xf
    v_cvt_pk_bf16_f32 v191, v194, v195
    ds_write_b128 v14, v[188:191] offset:36864
    v_add_f32_dpp v17, v17, v17 row_ror:4 row_mask:0xf bank_mask:0xf
    v_pk_fma_f32 v[196:197], v[196:197], v[108:109], v[224:225] op_sel_hi:[1,0,1]
    v_pk_fma_f32 v[198:199], v[198:199], v[108:109], v[226:227] op_sel_hi:[1,0,1]
    v_add_f32_dpp v17, v17, v17 row_ror:2 row_mask:0xf bank_mask:0xf
    v_cvt_pk_bf16_f32 v196, v196, v197
    v_cvt_pk_bf16_f32 v197, v198, v199
    v_add_f32_dpp v17, v17, v17 row_ror:1 row_mask:0xf bank_mask:0xf
    ds_write_b64 v15, v[196:197] offset:28672
    v_mul_f32_e64 v17, s44, v17
    v_dot2_f32_bf16 v172, v56, s41, v17 neg_lo:[0,0,1]
    v_dot2_f32_bf16 v173, v56, s42, v17 neg_lo:[0,0,1]
    s_waitcnt lgkmcnt(15)
    s_nop 0
    buffer_store_dwordx4 v[88:91], v19, s[24:27], s52 offen nt sc1
    v_dot2_f32_bf16 v174, v57, s41, v17 neg_lo:[0,0,1]
    v_dot2_f32_bf16 v175, v57, s42, v17 neg_lo:[0,0,1]
    v_dot2_f32_bf16 v176, v58, s41, v17 neg_lo:[0,0,1]
    v_dot2_f32_bf16 v177, v58, s42, v17 neg_lo:[0,0,1]
    v_dot2_f32_bf16 v178, v59, s41, v17 neg_lo:[0,0,1]
    v_dot2_f32_bf16 v179, v59, s42, v17 neg_lo:[0,0,1]
    v_dot2_f32_bf16 v180, v60, s41, v17 neg_lo:[0,0,1]
    v_dot2_f32_bf16 v181, v60, s42, v17 neg_lo:[0,0,1]
    v_dot2_f32_bf16 v182, v61, s41, v17 neg_lo:[0,0,1]
    v_dot2_f32_bf16 v183, v61, s42, v17 neg_lo:[0,0,1]
    v_dot2_f32_bf16 v184, v62, s41, v17 neg_lo:[0,0,1]
    v_dot2_f32_bf16 v185, v62, s42, v17 neg_lo:[0,0,1]
    v_dot2_f32_bf16 v186, v63, s41, v17 neg_lo:[0,0,1]
    v_dot2_f32_bf16 v187, v63, s42, v17 neg_lo:[0,0,1]
    v_dot2_f32_bf16 v188, v64, s41, v17 neg_lo:[0,0,1]
    v_dot2_f32_bf16 v189, v64, s42, v17 neg_lo:[0,0,1]
    v_dot2_f32_bf16 v190, v65, s41, v17 neg_lo:[0,0,1]
    buffer_store_dwordx4 v[92:95], v20, s[24:27], s52 offen nt sc1
    v_dot2_f32_bf16 v191, v65, s42, v17 neg_lo:[0,0,1]
    v_dot2_f32_bf16 v192, v66, s41, v17 neg_lo:[0,0,1]
    v_dot2_f32_bf16 v193, v66, s42, v17 neg_lo:[0,0,1]
    v_dot2_f32_bf16 v194, v67, s41, v17 neg_lo:[0,0,1]
    v_dot2_f32_bf16 v195, v67, s42, v17 neg_lo:[0,0,1]
    v_dot2_f32_bf16 v196, v68, s41, v17 neg_lo:[0,0,1]
    v_dot2_f32_bf16 v197, v68, s42, v17 neg_lo:[0,0,1]
    v_dot2_f32_bf16 v198, v69, s41, v17 neg_lo:[0,0,1]
    v_dot2_f32_bf16 v199, v69, s42, v17 neg_lo:[0,0,1]
    v_pk_mul_f32 v[56:57], v[172:173], v[172:173]
    v_pk_fma_f32 v[56:57], v[174:175], v[174:175], v[56:57]
    v_pk_fma_f32 v[56:57], v[176:177], v[176:177], v[56:57]
    v_pk_fma_f32 v[56:57], v[178:179], v[178:179], v[56:57]
    v_pk_fma_f32 v[56:57], v[180:181], v[180:181], v[56:57]
    v_pk_fma_f32 v[56:57], v[182:183], v[182:183], v[56:57]
    v_pk_fma_f32 v[56:57], v[184:185], v[184:185], v[56:57]
    v_pk_fma_f32 v[56:57], v[186:187], v[186:187], v[56:57]
    v_pk_fma_f32 v[56:57], v[188:189], v[188:189], v[56:57]
    buffer_store_dwordx4 v[96:99], v19, s[24:27], s50 offen nt sc1
    v_pk_fma_f32 v[56:57], v[190:191], v[190:191], v[56:57]
    v_pk_fma_f32 v[56:57], v[192:193], v[192:193], v[56:57]
    v_pk_fma_f32 v[56:57], v[194:195], v[194:195], v[56:57]
    v_pk_fma_f32 v[56:57], v[196:197], v[196:197], v[56:57]
    v_pk_fma_f32 v[56:57], v[198:199], v[198:199], v[56:57]
    v_add_f32_e64 v56, v56, v57
    v_pk_mul_f32 v[172:173], v[172:173], v[228:229]
    v_pk_mul_f32 v[174:175], v[174:175], v[230:231]
    v_add_f32_dpp v56, v56, v56 row_ror:8 row_mask:0xf bank_mask:0xf
    v_pk_mul_f32 v[176:177], v[176:177], v[232:233]
    v_pk_mul_f32 v[178:179], v[178:179], v[234:235]
    v_add_f32_dpp v56, v56, v56 row_ror:4 row_mask:0xf bank_mask:0xf
    v_pk_mul_f32 v[180:181], v[180:181], v[236:237]
    v_pk_mul_f32 v[182:183], v[182:183], v[238:239]
    v_add_f32_dpp v56, v56, v56 row_ror:2 row_mask:0xf bank_mask:0xf
    v_pk_mul_f32 v[184:185], v[184:185], v[240:241]
    v_pk_mul_f32 v[186:187], v[186:187], v[242:243]
    buffer_store_dwordx4 v[100:103], v20, s[24:27], s50 offen nt sc1
    v_add_f32_dpp v56, v56, v56 row_ror:1 row_mask:0xf bank_mask:0xf
    v_fma_f32 v56, v56, s44, v16
    v_rsq_f32_e64 v58, v56
    v_pk_mul_f32 v[188:189], v[188:189], v[244:245]
    v_pk_mul_f32 v[190:191], v[190:191], v[246:247]
    v_pk_mul_f32 v[192:193], v[192:193], v[248:249]
    v_pk_mul_f32 v[194:195], v[194:195], v[250:251]
    v_pk_mul_f32 v[196:197], v[196:197], v[252:253]
    v_pk_mul_f32 v[198:199], v[198:199], v[254:255]
    v_pk_fma_f32 v[172:173], v[172:173], v[58:59], v[200:201] op_sel_hi:[1,0,1]
    v_pk_fma_f32 v[174:175], v[174:175], v[58:59], v[202:203] op_sel_hi:[1,0,1]
    v_pk_fma_f32 v[176:177], v[176:177], v[58:59], v[204:205] op_sel_hi:[1,0,1]
    v_pk_fma_f32 v[178:179], v[178:179], v[58:59], v[206:207] op_sel_hi:[1,0,1]
    v_cvt_pk_bf16_f32 v172, v172, v173
    v_cvt_pk_bf16_f32 v173, v174, v175
    v_cvt_pk_bf16_f32 v174, v176, v177
    v_cvt_pk_bf16_f32 v175, v178, v179
    ds_write_b128 v14, v[172:175] offset:43008
    buffer_store_dwordx4 v[72:75], v19, s[24:27], s51 offen nt sc1
    v_pk_fma_f32 v[180:181], v[180:181], v[58:59], v[208:209] op_sel_hi:[1,0,1]
    v_pk_fma_f32 v[182:183], v[182:183], v[58:59], v[210:211] op_sel_hi:[1,0,1]
    v_pk_fma_f32 v[184:185], v[184:185], v[58:59], v[212:213] op_sel_hi:[1,0,1]
    v_pk_fma_f32 v[186:187], v[186:187], v[58:59], v[214:215] op_sel_hi:[1,0,1]
    v_cvt_pk_bf16_f32 v180, v180, v181
    v_cvt_pk_bf16_f32 v181, v182, v183
    v_cvt_pk_bf16_f32 v182, v184, v185
    v_cvt_pk_bf16_f32 v183, v186, v187
    ds_write_b128 v14, v[180:183] offset:47104
    v_pk_fma_f32 v[188:189], v[188:189], v[58:59], v[216:217] op_sel_hi:[1,0,1]
    v_pk_fma_f32 v[190:191], v[190:191], v[58:59], v[218:219] op_sel_hi:[1,0,1]
    v_pk_fma_f32 v[192:193], v[192:193], v[58:59], v[220:221] op_sel_hi:[1,0,1]
    v_pk_fma_f32 v[194:195], v[194:195], v[58:59], v[222:223] op_sel_hi:[1,0,1]
    v_cvt_pk_bf16_f32 v188, v188, v189
    v_cvt_pk_bf16_f32 v189, v190, v191
    v_cvt_pk_bf16_f32 v190, v192, v193
    v_cvt_pk_bf16_f32 v191, v194, v195
    ds_write_b128 v14, v[188:191] offset:51200
    buffer_store_dwordx4 v[76:79], v20, s[24:27], s51 offen nt sc1
    v_pk_fma_f32 v[196:197], v[196:197], v[58:59], v[224:225] op_sel_hi:[1,0,1]
    v_pk_fma_f32 v[198:199], v[198:199], v[58:59], v[226:227] op_sel_hi:[1,0,1]
    v_cvt_pk_bf16_f32 v196, v196, v197
    v_cvt_pk_bf16_f32 v197, v198, v199
    ds_write_b64 v15, v[196:197] offset:43008
    s_waitcnt lgkmcnt(0)
    s_barrier
    ds_read_b128 v[32:35], v6 offset:43008
    ds_read_b128 v[36:39], v7 offset:44032
    ds_read_b128 v[40:43], v6 offset:45056
    ds_read_b128 v[44:47], v7 offset:46080
    s_waitcnt lgkmcnt(2)
    v_mfma_f32_16x16x32_bf16 v[56:59], a[0:3], v[32:35], 0
    s_waitcnt vmcnt(14)
    ds_read_b64_tr_b16 a[224:225], v26 offset:6144
    v_mfma_f32_16x16x32_bf16 v[56:59], a[16:19], v[36:39], v[56:59]
    ds_read_b64_tr_b16 a[228:229], v27 offset:6144
    s_add_u32 m0, s38, 4096
    v_mfma_f32_16x16x32_bf16 v[60:63], a[4:7], v[32:35], 0
    buffer_load_dwordx4 v2, s[20:23], s30 offen offset:1024 lds
    v_mfma_f32_16x16x32_bf16 v[60:63], a[20:23], v[36:39], v[60:63]
    ds_read_b128 v[48:51], v6 offset:47104
    v_mfma_f32_16x16x32_bf16 v[64:67], a[8:11], v[32:35], 0
    ds_read_b128 v[52:55], v7 offset:48128
    v_mfma_f32_16x16x32_bf16 v[64:67], a[24:27], v[36:39], v[64:67]
    s_waitcnt lgkmcnt(4)
    s_waitcnt vmcnt(14)
    ds_read_b64_tr_b16 a[226:227], v26 offset:7168
    v_mfma_f32_16x16x32_bf16 v[68:71], a[12:15], v[32:35], 0
    ds_read_b64_tr_b16 a[230:231], v27 offset:7168
    s_waitcnt lgkmcnt(4)
    s_add_u32 m0, s38, 4096
    v_mfma_f32_16x16x32_bf16 v[68:71], a[28:31], v[36:39], v[68:71]
    buffer_load_dwordx4 v3, s[20:23], s30 offen offset:2048 lds
    v_mfma_f32_16x16x32_bf16 v[56:59], a[32:35], v[40:43], v[56:59]
    v_mfma_f32_16x16x32_bf16 v[56:59], a[48:51], v[44:47], v[56:59]
    s_waitcnt vmcnt(14)
    ds_read_b64_tr_b16 a[232:233], v5 offset:8192
    v_mfma_f32_16x16x32_bf16 v[60:63], a[36:39], v[40:43], v[60:63]
    ds_read_b64_tr_b16 a[234:235], v5 offset:8704
    v_mfma_f32_16x16x32_bf16 v[60:63], a[52:55], v[44:47], v[60:63]
    ds_read_b128 v[32:35], v6 offset:49152
    v_mfma_f32_16x16x32_bf16 v[64:67], a[40:43], v[40:43], v[64:67]
    ds_read_b128 v[36:39], v7 offset:50176
    s_waitcnt lgkmcnt(4)
    s_add_u32 m0, s38, 7168
    v_mfma_f32_16x16x32_bf16 v[64:67], a[56:59], v[44:47], v[64:67]
    buffer_load_dwordx4 v4, s[20:23], s30 offen offset:0 lds
    v_mfma_f32_16x16x32_bf16 v[68:71], a[44:47], v[40:43], v[68:71]
    v_mfma_f32_16x16x32_bf16 v[68:71], a[60:63], v[44:47], v[68:71]
    v_mfma_f32_16x16x32_bf16 v[56:59], a[64:67], v[48:51], v[56:59]
    s_waitcnt vmcnt(14)
    ds_read_b64_tr_b16 a[236:237], v26 offset:9216
    v_mfma_f32_16x16x32_bf16 v[56:59], a[80:83], v[52:55], v[56:59]
    ds_read_b64_tr_b16 a[240:241], v27 offset:9216
    s_waitcnt lgkmcnt(4)
    s_add_u32 m0, s38, 7168
    v_mfma_f32_16x16x32_bf16 v[60:63], a[68:71], v[48:51], v[60:63]
    buffer_load_dwordx4 v2, s[20:23], s31 offen offset:1024 lds
    v_mfma_f32_16x16x32_bf16 v[60:63], a[84:87], v[52:55], v[60:63]
    ds_read_b128 v[40:43], v6 offset:51200
    v_mfma_f32_16x16x32_bf16 v[64:67], a[72:75], v[48:51], v[64:67]
    ds_read_b128 v[44:47], v7 offset:52224
    v_mfma_f32_16x16x32_bf16 v[64:67], a[88:91], v[52:55], v[64:67]
    s_waitcnt lgkmcnt(4)
    s_waitcnt vmcnt(14)
    ds_read_b64_tr_b16 a[238:239], v26 offset:0
    v_mfma_f32_16x16x32_bf16 v[68:71], a[76:79], v[48:51], v[68:71]
    ds_read_b64_tr_b16 a[242:243], v27 offset:0
    s_waitcnt lgkmcnt(4)
    s_add_u32 m0, s38, 7168
    v_mfma_f32_16x16x32_bf16 v[68:71], a[92:95], v[52:55], v[68:71]
    buffer_load_dwordx4 v3, s[20:23], s31 offen offset:2048 lds
    v_mfma_f32_16x16x32_bf16 v[56:59], a[96:99], v[32:35], v[56:59]
    v_mfma_f32_16x16x32_bf16 v[56:59], a[112:115], v[36:39], v[56:59]
    s_waitcnt vmcnt(14)
    ds_read_b64_tr_b16 a[244:245], v5 offset:1024
    v_mfma_f32_16x16x32_bf16 v[60:63], a[100:103], v[32:35], v[60:63]
    ds_read_b64_tr_b16 a[246:247], v5 offset:1536
    v_mfma_f32_16x16x32_bf16 v[60:63], a[116:119], v[36:39], v[60:63]
    ds_read_b128 v[48:51], v6 offset:53248
    v_mfma_f32_16x16x32_bf16 v[64:67], a[104:107], v[32:35], v[64:67]
    ds_read_b128 v[52:55], v7 offset:54272
    s_waitcnt lgkmcnt(4)
    s_add_u32 m0, s38, 0
    v_mfma_f32_16x16x32_bf16 v[64:67], a[120:123], v[36:39], v[64:67]
    buffer_load_dwordx4 v4, s[20:23], s31 offen offset:0 lds
    v_mfma_f32_16x16x32_bf16 v[68:71], a[108:111], v[32:35], v[68:71]
    v_mfma_f32_16x16x32_bf16 v[68:71], a[124:127], v[36:39], v[68:71]
    v_mfma_f32_16x16x32_bf16 v[56:59], a[128:131], v[40:43], v[56:59]
    s_waitcnt vmcnt(14)
    ds_read_b64_tr_b16 a[248:249], v26 offset:2048
    v_mfma_f32_16x16x32_bf16 v[56:59], a[144:147], v[44:47], v[56:59]
    ds_read_b64_tr_b16 a[252:253], v27 offset:2048
    s_waitcnt lgkmcnt(4)
    s_add_u32 m0, s38, 0
    v_mfma_f32_16x16x32_bf16 v[60:63], a[132:135], v[40:43], v[60:63]
    buffer_load_dwordx4 v2, s[20:23], s32 offen offset:1024 lds
    v_mfma_f32_16x16x32_bf16 v[60:63], a[148:151], v[44:47], v[60:63]
    ds_read_b128 v[32:35], v6 offset:55296
    v_mfma_f32_16x16x32_bf16 v[64:67], a[136:139], v[40:43], v[64:67]
    ds_read_b128 v[36:39], v7 offset:56320
    v_mfma_f32_16x16x32_bf16 v[64:67], a[152:155], v[44:47], v[64:67]
    s_waitcnt lgkmcnt(4)
    s_waitcnt vmcnt(14)
    ds_read_b64_tr_b16 a[250:251], v26 offset:3072
    v_mfma_f32_16x16x32_bf16 v[68:71], a[140:143], v[40:43], v[68:71]
    ds_read_b64_tr_b16 a[254:255], v27 offset:3072
    s_waitcnt lgkmcnt(4)
    s_add_u32 m0, s38, 0
    v_mfma_f32_16x16x32_bf16 v[68:71], a[156:159], v[44:47], v[68:71]
    buffer_load_dwordx4 v3, s[20:23], s32 offen offset:2048 lds
    v_mfma_f32_16x16x32_bf16 v[56:59], a[160:163], v[48:51], v[56:59]
    v_mfma_f32_16x16x32_bf16 v[56:59], a[176:179], v[52:55], v[56:59]
    s_waitcnt vmcnt(14)
    ds_read_b64_tr_b16 v[120:121], v5 offset:4096
    v_mfma_f32_16x16x32_bf16 v[60:63], a[164:167], v[48:51], v[60:63]
    ds_read_b64_tr_b16 v[122:123], v5 offset:4608
    v_add_u32 v6, 57344, v6
    v_mfma_f32_16x16x32_bf16 v[60:63], a[180:183], v[52:55], v[60:63]
    ds_read_b128 v[40:43], v6 offset:0
    v_add_u32 v7, 57344, v7
    v_mfma_f32_16x16x32_bf16 v[64:67], a[168:171], v[48:51], v[64:67]
    ds_read_b128 v[44:47], v7 offset:1024
    s_waitcnt lgkmcnt(4)
    s_add_u32 m0, s38, 3072
    v_mfma_f32_16x16x32_bf16 v[64:67], a[184:187], v[52:55], v[64:67]
    buffer_load_dwordx4 v4, s[20:23], s32 offen offset:0 lds
    v_mfma_f32_16x16x32_bf16 v[68:71], a[172:175], v[48:51], v[68:71]
    v_mfma_f32_16x16x32_bf16 v[68:71], a[188:191], v[52:55], v[68:71]
    v_mfma_f32_16x16x32_bf16 v[56:59], a[192:195], v[32:35], v[56:59]
    s_waitcnt vmcnt(8)
    ds_read_b64_tr_b16 v[124:125], v26 offset:5120
    v_mfma_f32_16x16x32_bf16 v[56:59], a[208:211], v[36:39], v[56:59]
    ds_read_b64_tr_b16 v[128:129], v27 offset:5120
    s_waitcnt lgkmcnt(4)
    s_add_u32 m0, s38, 3072
    v_mfma_f32_16x16x32_bf16 v[60:63], a[196:199], v[32:35], v[60:63]
    buffer_load_dwordx4 v2, s[20:23], s33 offen offset:1024 lds
    v_mfma_f32_16x16x32_bf16 v[60:63], a[212:215], v[36:39], v[60:63]
    ds_read_b128 v[48:51], v6 offset:2048
    v_mfma_f32_16x16x32_bf16 v[64:67], a[200:203], v[32:35], v[64:67]
    ds_read_b128 v[52:55], v7 offset:3072
    v_mfma_f32_16x16x32_bf16 v[64:67], a[216:219], v[36:39], v[64:67]
    s_waitcnt lgkmcnt(4)
    s_waitcnt vmcnt(8)
    ds_read_b64_tr_b16 v[126:127], v26 offset:6144
    v_mfma_f32_16x16x32_bf16 v[68:71], a[204:207], v[32:35], v[68:71]
    ds_read_b64_tr_b16 v[130:131], v27 offset:6144
    s_waitcnt lgkmcnt(4)
    s_add_u32 m0, s38, 3072
    v_mfma_f32_16x16x32_bf16 v[68:71], a[220:223], v[36:39], v[68:71]
    buffer_load_dwordx4 v3, s[20:23], s33 offen offset:2048 lds
    v_mfma_f32_16x16x32_bf16 v[104:107], a[0:3], v[40:43], 0
    v_mfma_f32_16x16x32_bf16 v[104:107], a[16:19], v[44:47], v[104:107]
    s_waitcnt vmcnt(8)
    ds_read_b64_tr_b16 v[132:133], v5 offset:7168
    v_mfma_f32_16x16x32_bf16 v[108:111], a[4:7], v[40:43], 0
    ds_read_b64_tr_b16 v[134:135], v5 offset:7680
    v_mfma_f32_16x16x32_bf16 v[108:111], a[20:23], v[44:47], v[108:111]
    ds_read_b128 v[32:35], v6 offset:4096
    v_mfma_f32_16x16x32_bf16 v[112:115], a[8:11], v[40:43], 0
    ds_read_b128 v[36:39], v7 offset:5120
    s_waitcnt lgkmcnt(4)
    s_add_u32 m0, s38, 6144
    v_mfma_f32_16x16x32_bf16 v[112:115], a[24:27], v[44:47], v[112:115]
    buffer_load_dwordx4 v4, s[20:23], s33 offen offset:0 lds
    v_mfma_f32_16x16x32_bf16 v[116:119], a[12:15], v[40:43], 0
    v_mfma_f32_16x16x32_bf16 v[116:119], a[28:31], v[44:47], v[116:119]
    v_mfma_f32_16x16x32_bf16 v[104:107], a[32:35], v[48:51], v[104:107]
    s_waitcnt vmcnt(8)
    ds_read_b64_tr_b16 v[136:137], v26 offset:8192
    v_mfma_f32_16x16x32_bf16 v[104:107], a[48:51], v[52:55], v[104:107]
    ds_read_b64_tr_b16 v[140:141], v27 offset:8192
    s_waitcnt lgkmcnt(4)
    s_add_u32 m0, s38, 6144
    v_mfma_f32_16x16x32_bf16 v[108:111], a[36:39], v[48:51], v[108:111]
    buffer_load_dwordx4 v2, s[20:23], s34 offen offset:1024 lds
    v_mfma_f32_16x16x32_bf16 v[108:111], a[52:55], v[52:55], v[108:111]
    ds_read_b128 v[40:43], v6 offset:6144
    v_mfma_f32_16x16x32_bf16 v[112:115], a[40:43], v[48:51], v[112:115]
    ds_read_b128 v[44:47], v7 offset:7168
    v_mfma_f32_16x16x32_bf16 v[112:115], a[56:59], v[52:55], v[112:115]
    s_waitcnt lgkmcnt(4)
    s_waitcnt vmcnt(8)
    ds_read_b64_tr_b16 v[138:139], v26 offset:9216
    v_mfma_f32_16x16x32_bf16 v[116:119], a[44:47], v[48:51], v[116:119]
    ds_read_b64_tr_b16 v[142:143], v27 offset:9216
    s_waitcnt lgkmcnt(4)
    s_add_u32 m0, s38, 6144
    v_mfma_f32_16x16x32_bf16 v[116:119], a[60:63], v[52:55], v[116:119]
    buffer_load_dwordx4 v3, s[20:23], s34 offen offset:2048 lds
    v_mfma_f32_16x16x32_bf16 v[104:107], a[64:67], v[32:35], v[104:107]
    v_mfma_f32_16x16x32_bf16 v[104:107], a[80:83], v[36:39], v[104:107]
    s_waitcnt vmcnt(8)
    ds_read_b64_tr_b16 v[144:145], v5 offset:0
    v_mfma_f32_16x16x32_bf16 v[108:111], a[68:71], v[32:35], v[108:111]
    ds_read_b64_tr_b16 v[146:147], v5 offset:512
    v_mfma_f32_16x16x32_bf16 v[108:111], a[84:87], v[36:39], v[108:111]
    ds_read_b128 v[48:51], v6 offset:8192
    v_mfma_f32_16x16x32_bf16 v[112:115], a[72:75], v[32:35], v[112:115]
    ds_read_b128 v[52:55], v7 offset:9216
    s_waitcnt lgkmcnt(4)
    s_add_u32 m0, s38, 9216
    v_mfma_f32_16x16x32_bf16 v[112:115], a[88:91], v[36:39], v[112:115]
    buffer_load_dwordx4 v4, s[20:23], s34 offen offset:0 lds
    v_mfma_f32_16x16x32_bf16 v[116:119], a[76:79], v[32:35], v[116:119]
    v_mfma_f32_16x16x32_bf16 v[116:119], a[92:95], v[36:39], v[116:119]
    v_mfma_f32_16x16x32_bf16 v[104:107], a[96:99], v[40:43], v[104:107]
    s_waitcnt vmcnt(8)
    ds_read_b64_tr_b16 v[148:149], v26 offset:1024
    v_mfma_f32_16x16x32_bf16 v[104:107], a[112:115], v[44:47], v[104:107]
    ds_read_b64_tr_b16 v[152:153], v27 offset:1024
    s_waitcnt lgkmcnt(4)
    s_add_u32 m0, s38, 4294966272
    v_mfma_f32_16x16x32_bf16 v[108:111], a[100:103], v[40:43], v[108:111]
    buffer_load_dwordx4 v2, s[20:23], s35 offen offset:1024 lds
    v_mfma_f32_16x16x32_bf16 v[108:111], a[116:119], v[44:47], v[108:111]
    ds_read_b128 v[32:35], v6 offset:10240
    v_mfma_f32_16x16x32_bf16 v[112:115], a[104:107], v[40:43], v[112:115]
    ds_read_b128 v[36:39], v7 offset:11264
    v_mfma_f32_16x16x32_bf16 v[112:115], a[120:123], v[44:47], v[112:115]
    s_waitcnt lgkmcnt(4)
    s_waitcnt vmcnt(8)
    ds_read_b64_tr_b16 v[150:151], v26 offset:2048
    v_mfma_f32_16x16x32_bf16 v[116:119], a[108:111], v[40:43], v[116:119]
    ds_read_b64_tr_b16 v[154:155], v27 offset:2048
    s_waitcnt lgkmcnt(4)
    s_add_u32 m0, s38, 4294966272
    v_mfma_f32_16x16x32_bf16 v[116:119], a[124:127], v[44:47], v[116:119]
    buffer_load_dwordx4 v3, s[20:23], s35 offen offset:2048 lds
    v_mfma_f32_16x16x32_bf16 v[104:107], a[128:131], v[48:51], v[104:107]
    v_mfma_f32_16x16x32_bf16 v[104:107], a[144:147], v[52:55], v[104:107]
    s_waitcnt vmcnt(8)
    ds_read_b64_tr_b16 v[156:157], v5 offset:3072
    v_mfma_f32_16x16x32_bf16 v[108:111], a[132:135], v[48:51], v[108:111]
    ds_read_b64_tr_b16 v[158:159], v5 offset:3584
    v_mfma_f32_16x16x32_bf16 v[108:111], a[148:151], v[52:55], v[108:111]
    ds_read_b128 v[40:43], v6 offset:12288
    v_mfma_f32_16x16x32_bf16 v[112:115], a[136:139], v[48:51], v[112:115]
    ds_read_b128 v[44:47], v7 offset:13312
    s_waitcnt lgkmcnt(4)
    s_add_u32 m0, s38, 2048
    v_mfma_f32_16x16x32_bf16 v[112:115], a[152:155], v[52:55], v[112:115]
    buffer_load_dwordx4 v4, s[20:23], s35 offen offset:0 lds
    v_mfma_f32_16x16x32_bf16 v[116:119], a[140:143], v[48:51], v[116:119]
    v_mfma_f32_16x16x32_bf16 v[116:119], a[156:159], v[52:55], v[116:119]
    v_mfma_f32_16x16x32_bf16 v[104:107], a[160:163], v[32:35], v[104:107]
    s_waitcnt vmcnt(8)
    ds_read_b64_tr_b16 v[160:161], v26 offset:4096
    v_mfma_f32_16x16x32_bf16 v[104:107], a[176:179], v[36:39], v[104:107]
    ds_read_b64_tr_b16 v[164:165], v27 offset:4096
    s_waitcnt lgkmcnt(4)
    s_add_u32 m0, s38, 2048
    v_mfma_f32_16x16x32_bf16 v[108:111], a[164:167], v[32:35], v[108:111]
    buffer_load_dwordx4 v2, s[20:23], s92 offen offset:1024 lds
    v_mfma_f32_16x16x32_bf16 v[108:111], a[180:183], v[36:39], v[108:111]
    ds_read_b128 v[48:51], v6 offset:14336
    v_mfma_f32_16x16x32_bf16 v[112:115], a[168:171], v[32:35], v[112:115]
    ds_read_b128 v[52:55], v7 offset:15360
    v_mfma_f32_16x16x32_bf16 v[112:115], a[184:187], v[36:39], v[112:115]
    s_waitcnt lgkmcnt(4)
    s_waitcnt vmcnt(8)
    ds_read_b64_tr_b16 v[162:163], v26 offset:5120
    v_mfma_f32_16x16x32_bf16 v[116:119], a[172:175], v[32:35], v[116:119]
    ds_read_b64_tr_b16 v[166:167], v27 offset:5120
    s_waitcnt lgkmcnt(4)
    s_add_u32 m0, s38, 2048
    v_mfma_f32_16x16x32_bf16 v[116:119], a[188:191], v[36:39], v[116:119]
    buffer_load_dwordx4 v3, s[20:23], s92 offen offset:2048 lds
    v_mfma_f32_16x16x32_bf16 v[104:107], a[192:195], v[40:43], v[104:107]
    v_mfma_f32_16x16x32_bf16 v[104:107], a[208:211], v[44:47], v[104:107]
    s_waitcnt vmcnt(8)
    ds_read_b64_tr_b16 v[168:169], v5 offset:6144
    v_mfma_f32_16x16x32_bf16 v[108:111], a[196:199], v[40:43], v[108:111]
    ds_read_b64_tr_b16 v[170:171], v5 offset:6656
    v_mfma_f32_16x16x32_bf16 v[108:111], a[212:215], v[44:47], v[108:111]
    ds_read_b128 v[32:35], v6 offset:16384
    v_mfma_f32_16x16x32_bf16 v[112:115], a[200:203], v[40:43], v[112:115]
    ds_read_b128 v[36:39], v7 offset:17408
    s_waitcnt lgkmcnt(4)
    s_add_u32 m0, s38, 5120
    v_mfma_f32_16x16x32_bf16 v[112:115], a[216:219], v[44:47], v[112:115]
    buffer_load_dwordx4 v4, s[20:23], s92 offen offset:0 lds
    v_mfma_f32_16x16x32_bf16 v[116:119], a[204:207], v[40:43], v[116:119]
    v_mfma_f32_16x16x32_bf16 v[116:119], a[220:223], v[44:47], v[116:119]
    v_mfma_f32_16x16x32_bf16 v[72:75], a[0:3], v[48:51], 0
    s_waitcnt vmcnt(8)
    ds_read_b64_tr_b16 v[172:173], v26 offset:7168
    v_mfma_f32_16x16x32_bf16 v[72:75], a[16:19], v[52:55], v[72:75]
    ds_read_b64_tr_b16 v[176:177], v27 offset:7168
    s_waitcnt lgkmcnt(4)
    s_add_u32 m0, s38, 5120
    v_mfma_f32_16x16x32_bf16 v[76:79], a[4:7], v[48:51], 0
    buffer_load_dwordx4 v2, s[20:23], s93 offen offset:1024 lds
    v_mfma_f32_16x16x32_bf16 v[76:79], a[20:23], v[52:55], v[76:79]
    ds_read_b128 v[40:43], v6 offset:18432
    v_mfma_f32_16x16x32_bf16 v[80:83], a[8:11], v[48:51], 0
    ds_read_b128 v[44:47], v7 offset:19456
    v_mfma_f32_16x16x32_bf16 v[80:83], a[24:27], v[52:55], v[80:83]
    s_waitcnt lgkmcnt(4)
    s_waitcnt vmcnt(8)
    ds_read_b64_tr_b16 v[174:175], v26 offset:8192
    v_mfma_f32_16x16x32_bf16 v[84:87], a[12:15], v[48:51], 0
    ds_read_b64_tr_b16 v[178:179], v27 offset:8192
    s_waitcnt lgkmcnt(4)
    s_add_u32 m0, s38, 5120
    v_mfma_f32_16x16x32_bf16 v[84:87], a[28:31], v[52:55], v[84:87]
    buffer_load_dwordx4 v3, s[20:23], s93 offen offset:2048 lds
    v_mfma_f32_16x16x32_bf16 v[72:75], a[32:35], v[32:35], v[72:75]
    v_mfma_f32_16x16x32_bf16 v[72:75], a[48:51], v[36:39], v[72:75]
    s_waitcnt vmcnt(8)
    ds_read_b64_tr_b16 v[180:181], v5 offset:9216
    v_mfma_f32_16x16x32_bf16 v[76:79], a[36:39], v[32:35], v[76:79]
    ds_read_b64_tr_b16 v[182:183], v5 offset:9728
    v_mfma_f32_16x16x32_bf16 v[76:79], a[52:55], v[36:39], v[76:79]
    ds_read_b128 v[48:51], v6 offset:20480
    v_mfma_f32_16x16x32_bf16 v[80:83], a[40:43], v[32:35], v[80:83]
    ds_read_b128 v[52:55], v7 offset:21504
    s_waitcnt lgkmcnt(4)
    s_add_u32 m0, s38, 8192
    v_mfma_f32_16x16x32_bf16 v[80:83], a[56:59], v[36:39], v[80:83]
    buffer_load_dwordx4 v4, s[20:23], s93 offen offset:0 lds
    v_mfma_f32_16x16x32_bf16 v[84:87], a[44:47], v[32:35], v[84:87]
    v_mfma_f32_16x16x32_bf16 v[84:87], a[60:63], v[36:39], v[84:87]
    v_mfma_f32_16x16x32_bf16 v[72:75], a[64:67], v[40:43], v[72:75]
    s_waitcnt vmcnt(8)
    ds_read_b64_tr_b16 v[184:185], v26 offset:0
    v_mfma_f32_16x16x32_bf16 v[72:75], a[80:83], v[44:47], v[72:75]
    ds_read_b64_tr_b16 v[188:189], v27 offset:0
    s_waitcnt lgkmcnt(4)
    s_add_u32 m0, s38, 8192
    v_mfma_f32_16x16x32_bf16 v[76:79], a[68:71], v[40:43], v[76:79]
    buffer_load_dwordx4 v2, s[20:23], s94 offen offset:1024 lds
    v_mfma_f32_16x16x32_bf16 v[76:79], a[84:87], v[44:47], v[76:79]
    ds_read_b128 v[32:35], v6 offset:22528
    v_mfma_f32_16x16x32_bf16 v[80:83], a[72:75], v[40:43], v[80:83]
    ds_read_b128 v[36:39], v7 offset:23552
    v_mfma_f32_16x16x32_bf16 v[80:83], a[88:91], v[44:47], v[80:83]
    s_waitcnt lgkmcnt(4)
    s_waitcnt vmcnt(8)
    ds_read_b64_tr_b16 v[186:187], v26 offset:1024
    v_mfma_f32_16x16x32_bf16 v[84:87], a[76:79], v[40:43], v[84:87]
    ds_read_b64_tr_b16 v[190:191], v27 offset:1024
    s_waitcnt lgkmcnt(4)
    s_add_u32 m0, s38, 4294965248
    v_mfma_f32_16x16x32_bf16 v[84:87], a[92:95], v[44:47], v[84:87]
    buffer_load_dwordx4 v3, s[20:23], s94 offen offset:2048 lds
    v_mfma_f32_16x16x32_bf16 v[72:75], a[96:99], v[48:51], v[72:75]
    v_mfma_f32_16x16x32_bf16 v[72:75], a[112:115], v[52:55], v[72:75]
    s_waitcnt vmcnt(8)
    ds_read_b64_tr_b16 v[192:193], v5 offset:2048
    v_mfma_f32_16x16x32_bf16 v[76:79], a[100:103], v[48:51], v[76:79]
    ds_read_b64_tr_b16 v[194:195], v5 offset:2560
    v_mfma_f32_16x16x32_bf16 v[76:79], a[116:119], v[52:55], v[76:79]
    ds_read_b128 v[40:43], v6 offset:24576
    v_mfma_f32_16x16x32_bf16 v[80:83], a[104:107], v[48:51], v[80:83]
    ds_read_b128 v[44:47], v7 offset:25600
    s_waitcnt lgkmcnt(4)
    s_add_u32 m0, s38, 1024
    v_mfma_f32_16x16x32_bf16 v[80:83], a[120:123], v[52:55], v[80:83]
    buffer_load_dwordx4 v4, s[20:23], s94 offen offset:0 lds
    v_mfma_f32_16x16x32_bf16 v[84:87], a[108:111], v[48:51], v[84:87]
    v_mfma_f32_16x16x32_bf16 v[84:87], a[124:127], v[52:55], v[84:87]
    v_mfma_f32_16x16x32_bf16 v[72:75], a[128:131], v[32:35], v[72:75]
    s_waitcnt vmcnt(8)
    ds_read_b64_tr_b16 v[196:197], v26 offset:3072
    v_mfma_f32_16x16x32_bf16 v[72:75], a[144:147], v[36:39], v[72:75]
    ds_read_b64_tr_b16 v[200:201], v27 offset:3072
    s_waitcnt lgkmcnt(4)
    s_add_u32 m0, s38, 1024
    v_mfma_f32_16x16x32_bf16 v[76:79], a[132:135], v[32:35], v[76:79]
    buffer_load_dwordx4 v2, s[20:23], s98 offen offset:1024 lds
    v_mfma_f32_16x16x32_bf16 v[76:79], a[148:151], v[36:39], v[76:79]
    ds_read_b128 v[48:51], v6 offset:26624
    v_mfma_f32_16x16x32_bf16 v[80:83], a[136:139], v[32:35], v[80:83]
    ds_read_b128 v[52:55], v7 offset:27648
    v_mfma_f32_16x16x32_bf16 v[80:83], a[152:155], v[36:39], v[80:83]
    s_waitcnt lgkmcnt(4)
    s_waitcnt vmcnt(8)
    ds_read_b64_tr_b16 v[198:199], v26 offset:4096
    v_mfma_f32_16x16x32_bf16 v[84:87], a[140:143], v[32:35], v[84:87]
    ds_read_b64_tr_b16 v[202:203], v27 offset:4096
    s_waitcnt lgkmcnt(4)
    s_add_u32 m0, s38, 1024
    v_mfma_f32_16x16x32_bf16 v[84:87], a[156:159], v[36:39], v[84:87]
    buffer_load_dwordx4 v3, s[20:23], s98 offen offset:2048 lds
    v_mfma_f32_16x16x32_bf16 v[72:75], a[160:163], v[40:43], v[72:75]
    v_mfma_f32_16x16x32_bf16 v[72:75], a[176:179], v[44:47], v[72:75]
    s_waitcnt vmcnt(8)
    ds_read_b64_tr_b16 v[204:205], v5 offset:5120
    v_mfma_f32_16x16x32_bf16 v[76:79], a[164:167], v[40:43], v[76:79]
    ds_read_b64_tr_b16 v[206:207], v5 offset:5632
    v_mfma_f32_16x16x32_bf16 v[76:79], a[180:183], v[44:47], v[76:79]
    ds_read_b128 v[32:35], v6 offset:28672
    v_mfma_f32_16x16x32_bf16 v[80:83], a[168:171], v[40:43], v[80:83]
    ds_read_b128 v[36:39], v7 offset:29696
    s_waitcnt lgkmcnt(4)
    s_add_u32 m0, s38, 4096
    v_mfma_f32_16x16x32_bf16 v[80:83], a[184:187], v[44:47], v[80:83]
    buffer_load_dwordx4 v4, s[20:23], s98 offen offset:0 lds
    v_mfma_f32_16x16x32_bf16 v[84:87], a[172:175], v[40:43], v[84:87]
    v_mfma_f32_16x16x32_bf16 v[84:87], a[188:191], v[44:47], v[84:87]
    v_mfma_f32_16x16x32_bf16 v[72:75], a[192:195], v[48:51], v[72:75]
    s_waitcnt vmcnt(8)
    ds_read_b64_tr_b16 v[208:209], v26 offset:6144
    v_mfma_f32_16x16x32_bf16 v[72:75], a[208:211], v[52:55], v[72:75]
    ds_read_b64_tr_b16 v[212:213], v27 offset:6144
    s_waitcnt lgkmcnt(4)
    s_add_u32 m0, s38, 4096
    v_mfma_f32_16x16x32_bf16 v[76:79], a[196:199], v[48:51], v[76:79]
    buffer_load_dwordx4 v2, s[20:23], s99 offen offset:1024 lds
    v_mfma_f32_16x16x32_bf16 v[76:79], a[212:215], v[52:55], v[76:79]
    ds_read_b128 v[40:43], v6 offset:30720
    v_mfma_f32_16x16x32_bf16 v[80:83], a[200:203], v[48:51], v[80:83]
    ds_read_b128 v[44:47], v7 offset:31744
    v_mfma_f32_16x16x32_bf16 v[80:83], a[216:219], v[52:55], v[80:83]
    s_waitcnt lgkmcnt(4)
    s_waitcnt vmcnt(8)
    ds_read_b64_tr_b16 v[210:211], v26 offset:7168
    v_mfma_f32_16x16x32_bf16 v[84:87], a[204:207], v[48:51], v[84:87]
    ds_read_b64_tr_b16 v[214:215], v27 offset:7168
    s_waitcnt lgkmcnt(4)
    s_add_u32 m0, s38, 4096
    v_mfma_f32_16x16x32_bf16 v[84:87], a[220:223], v[52:55], v[84:87]
    buffer_load_dwordx4 v3, s[20:23], s99 offen offset:2048 lds
    v_mfma_f32_16x16x32_bf16 v[88:91], a[0:3], v[32:35], 0
    v_mfma_f32_16x16x32_bf16 v[88:91], a[16:19], v[36:39], v[88:91]
    s_waitcnt vmcnt(8)
    ds_read_b64_tr_b16 v[216:217], v5 offset:8192
    v_mfma_f32_16x16x32_bf16 v[92:95], a[4:7], v[32:35], 0
    ds_read_b64_tr_b16 v[218:219], v5 offset:8704
    v_mfma_f32_16x16x32_bf16 v[92:95], a[20:23], v[36:39], v[92:95]
    ds_read_b128 v[48:51], v6 offset:32768
    v_mfma_f32_16x16x32_bf16 v[96:99], a[8:11], v[32:35], 0
    ds_read_b128 v[52:55], v7 offset:33792
    s_waitcnt lgkmcnt(4)
    s_add_u32 m0, s38, 7168
    v_mfma_f32_16x16x32_bf16 v[96:99], a[24:27], v[36:39], v[96:99]
    buffer_load_dwordx4 v4, s[20:23], s99 offen offset:0 lds
    v_mfma_f32_16x16x32_bf16 v[100:103], a[12:15], v[32:35], 0
    v_mfma_f32_16x16x32_bf16 v[100:103], a[28:31], v[36:39], v[100:103]
    v_mfma_f32_16x16x32_bf16 v[88:91], a[32:35], v[40:43], v[88:91]
    s_waitcnt vmcnt(8)
    ds_read_b64_tr_b16 v[220:221], v26 offset:9216
    v_mfma_f32_16x16x32_bf16 v[88:91], a[48:51], v[44:47], v[88:91]
    ds_read_b64_tr_b16 v[224:225], v27 offset:9216
    v_mfma_f32_16x16x32_bf16 v[92:95], a[36:39], v[40:43], v[92:95]
    v_mfma_f32_16x16x32_bf16 v[92:95], a[52:55], v[44:47], v[92:95]
    ds_read_b128 v[32:35], v6 offset:34816
    v_mfma_f32_16x16x32_bf16 v[96:99], a[40:43], v[40:43], v[96:99]
    ds_read_b128 v[36:39], v7 offset:35840
    v_mfma_f32_16x16x32_bf16 v[96:99], a[56:59], v[44:47], v[96:99]
    s_waitcnt lgkmcnt(4)
    s_waitcnt vmcnt(7)
    ds_read_b64_tr_b16 v[222:223], v26 offset:0
    v_mfma_f32_16x16x32_bf16 v[100:103], a[44:47], v[40:43], v[100:103]
    ds_read_b64_tr_b16 v[226:227], v27 offset:0
    v_mfma_f32_16x16x32_bf16 v[100:103], a[60:63], v[44:47], v[100:103]
    v_mfma_f32_16x16x32_bf16 v[88:91], a[64:67], v[48:51], v[88:91]
    v_mfma_f32_16x16x32_bf16 v[88:91], a[80:83], v[52:55], v[88:91]
    s_waitcnt vmcnt(6)
    ds_read_b64_tr_b16 v[228:229], v5 offset:1024
    v_mfma_f32_16x16x32_bf16 v[92:95], a[68:71], v[48:51], v[92:95]
    ds_read_b64_tr_b16 v[230:231], v5 offset:1536
    v_mfma_f32_16x16x32_bf16 v[92:95], a[84:87], v[52:55], v[92:95]
    ds_read_b128 v[40:43], v6 offset:36864
    v_mfma_f32_16x16x32_bf16 v[96:99], a[72:75], v[48:51], v[96:99]
    ds_read_b128 v[44:47], v7 offset:37888
    v_mfma_f32_16x16x32_bf16 v[96:99], a[88:91], v[52:55], v[96:99]
    s_waitcnt lgkmcnt(6)
    v_mfma_f32_16x16x32_bf16 v[100:103], a[76:79], v[48:51], v[100:103]
    v_cvt_pk_bf16_f32 v56, v56, v57
    v_cvt_pk_bf16_f32 v57, v58, v59
    v_mfma_f32_16x16x32_bf16 v[100:103], a[92:95], v[52:55], v[100:103]
    ds_write_b64 v28, v[56:57]
    v_mfma_f32_16x16x32_bf16 v[88:91], a[96:99], v[32:35], v[88:91]
    s_waitcnt vmcnt(5)
    ds_read_b64_tr_b16 v[232:233], v26 offset:2048
    v_mfma_f32_16x16x32_bf16 v[88:91], a[112:115], v[36:39], v[88:91]
    ds_read_b64_tr_b16 v[236:237], v27 offset:2048
    v_cvt_pk_bf16_f32 v60, v60, v61
    v_mfma_f32_16x16x32_bf16 v[92:95], a[100:103], v[32:35], v[92:95]
    v_cvt_pk_bf16_f32 v61, v62, v63
    v_mfma_f32_16x16x32_bf16 v[92:95], a[116:119], v[36:39], v[92:95]
    ds_read_b128 v[48:51], v6 offset:38912
    v_mfma_f32_16x16x32_bf16 v[96:99], a[104:107], v[32:35], v[96:99]
    ds_read_b128 v[52:55], v7 offset:39936
    v_mfma_f32_16x16x32_bf16 v[96:99], a[120:123], v[36:39], v[96:99]
    s_waitcnt lgkmcnt(5)
    s_waitcnt vmcnt(4)
    ds_read_b64_tr_b16 v[234:235], v26 offset:3072
    v_mfma_f32_16x16x32_bf16 v[100:103], a[108:111], v[32:35], v[100:103]
    ds_read_b64_tr_b16 v[238:239], v27 offset:3072
    v_mfma_f32_16x16x32_bf16 v[100:103], a[124:127], v[36:39], v[100:103]
    ds_write_b64 v29, v[60:61]
    v_mfma_f32_16x16x32_bf16 v[88:91], a[128:131], v[40:43], v[88:91]
    v_cvt_pk_bf16_f32 v64, v64, v65
    v_cvt_pk_bf16_f32 v65, v66, v67
    v_mfma_f32_16x16x32_bf16 v[88:91], a[144:147], v[44:47], v[88:91]
    s_waitcnt vmcnt(3)
    ds_read_b64_tr_b16 v[240:241], v5 offset:4096
    v_mfma_f32_16x16x32_bf16 v[92:95], a[132:135], v[40:43], v[92:95]
    ds_read_b64_tr_b16 v[242:243], v5 offset:4608
    v_mfma_f32_16x16x32_bf16 v[92:95], a[148:151], v[44:47], v[92:95]
    ds_read_b128 v[32:35], v6 offset:40960
    v_mfma_f32_16x16x32_bf16 v[96:99], a[136:139], v[40:43], v[96:99]
    ds_read_b128 v[36:39], v7 offset:41984
    v_mfma_f32_16x16x32_bf16 v[96:99], a[152:155], v[44:47], v[96:99]
    s_waitcnt lgkmcnt(7)
    v_mfma_f32_16x16x32_bf16 v[100:103], a[140:143], v[40:43], v[100:103]
    ds_write_b64 v30, v[64:65]
    v_mfma_f32_16x16x32_bf16 v[100:103], a[156:159], v[44:47], v[100:103]
    v_cvt_pk_bf16_f32 v68, v68, v69
    v_cvt_pk_bf16_f32 v69, v70, v71
    v_mfma_f32_16x16x32_bf16 v[88:91], a[160:163], v[48:51], v[88:91]
    s_waitcnt vmcnt(2)
    ds_read_b64_tr_b16 v[244:245], v26 offset:5120
    v_mfma_f32_16x16x32_bf16 v[88:91], a[176:179], v[52:55], v[88:91]
    ds_read_b64_tr_b16 v[248:249], v27 offset:5120
    v_mfma_f32_16x16x32_bf16 v[92:95], a[164:167], v[48:51], v[92:95]
    ds_write_b64 v31, v[68:69]
    v_mfma_f32_16x16x32_bf16 v[92:95], a[180:183], v[52:55], v[92:95]
    ds_read_b128 v[40:43], v6 offset:43008
    v_mfma_f32_16x16x32_bf16 v[96:99], a[168:171], v[48:51], v[96:99]
    ds_read_b128 v[44:47], v7 offset:44032
    v_mfma_f32_16x16x32_bf16 v[96:99], a[184:187], v[52:55], v[96:99]
    s_waitcnt lgkmcnt(6)
    s_waitcnt vmcnt(1)
    ds_read_b64_tr_b16 v[246:247], v26 offset:6144
    v_mfma_f32_16x16x32_bf16 v[100:103], a[172:175], v[48:51], v[100:103]
    ds_read_b64_tr_b16 v[250:251], v27 offset:6144
    v_mfma_f32_16x16x32_bf16 v[100:103], a[188:191], v[52:55], v[100:103]
    ds_read_b128 v[8:11], v18
    v_mfma_f32_16x16x32_bf16 v[88:91], a[192:195], v[32:35], v[88:91]
    ds_read2_b64 v[12:15], v18 offset0:129 offset1:128
    v_mfma_f32_16x16x32_bf16 v[88:91], a[208:211], v[36:39], v[88:91]
    s_waitcnt vmcnt(0)
    ds_read_b64_tr_b16 v[252:253], v5 offset:7168
    v_mfma_f32_16x16x32_bf16 v[92:95], a[196:199], v[32:35], v[92:95]
    ds_read_b64_tr_b16 v[254:255], v5 offset:7680
    v_mfma_f32_16x16x32_bf16 v[92:95], a[212:215], v[36:39], v[92:95]
    ds_read_b128 v[48:51], v6 offset:45056
    v_mfma_f32_16x16x32_bf16 v[96:99], a[200:203], v[32:35], v[96:99]
    ds_read_b128 v[52:55], v7 offset:46080
    v_mfma_f32_16x16x32_bf16 v[96:99], a[216:219], v[36:39], v[96:99]
    s_waitcnt lgkmcnt(8)
    v_mfma_f32_16x16x32_bf16 v[100:103], a[204:207], v[32:35], v[100:103]
    v_mfma_f32_16x16x32_bf16 v[100:103], a[220:223], v[36:39], v[100:103]
    v_mfma_f32_16x16x32_bf16 v[56:59], a[0:3], v[40:43], 0
    s_waitcnt lgkmcnt(5)
    buffer_store_dwordx4 v[8:11], v19, s[24:27], s53 offen nt sc1
    v_mfma_f32_16x16x32_bf16 v[56:59], a[16:19], v[44:47], v[56:59]
    v_mfma_f32_16x16x32_bf16 v[60:63], a[4:7], v[40:43], 0
    v_mfma_f32_16x16x32_bf16 v[60:63], a[20:23], v[44:47], v[60:63]
    ds_read_b128 v[32:35], v6 offset:47104
    v_mfma_f32_16x16x32_bf16 v[64:67], a[8:11], v[40:43], 0
    ds_read_b128 v[36:39], v7 offset:48128
    v_mfma_f32_16x16x32_bf16 v[64:67], a[24:27], v[44:47], v[64:67]
    s_waitcnt lgkmcnt(2)
    v_mfma_f32_16x16x32_bf16 v[68:71], a[12:15], v[40:43], 0
    buffer_store_dwordx4 v[12:15], v20, s[24:27], s53 offen nt sc1
    v_mfma_f32_16x16x32_bf16 v[68:71], a[28:31], v[44:47], v[68:71]
    v_mfma_f32_16x16x32_bf16 v[56:59], a[32:35], v[48:51], v[56:59]
    v_cvt_pk_bf16_f32 v104, v104, v105
    v_cvt_pk_bf16_f32 v105, v106, v107
    v_mfma_f32_16x16x32_bf16 v[56:59], a[48:51], v[52:55], v[56:59]
    ds_write_b64 v28, v[104:105]
    v_mfma_f32_16x16x32_bf16 v[60:63], a[36:39], v[48:51], v[60:63]
    v_cvt_pk_bf16_f32 v108, v108, v109
    v_cvt_pk_bf16_f32 v109, v110, v111
    v_mfma_f32_16x16x32_bf16 v[60:63], a[52:55], v[52:55], v[60:63]
    ds_read_b128 v[40:43], v6 offset:49152
    v_mfma_f32_16x16x32_bf16 v[64:67], a[40:43], v[48:51], v[64:67]
    ds_read_b128 v[44:47], v7 offset:50176
    v_mfma_f32_16x16x32_bf16 v[64:67], a[56:59], v[52:55], v[64:67]
    s_waitcnt lgkmcnt(3)
    v_mfma_f32_16x16x32_bf16 v[68:71], a[44:47], v[48:51], v[68:71]
    ds_write_b64 v29, v[108:109]
    v_mfma_f32_16x16x32_bf16 v[68:71], a[60:63], v[52:55], v[68:71]
    v_cvt_pk_bf16_f32 v112, v112, v113
    v_cvt_pk_bf16_f32 v113, v114, v115
    v_mfma_f32_16x16x32_bf16 v[56:59], a[64:67], v[32:35], v[56:59]
    ds_write_b64 v30, v[112:113]
    v_mfma_f32_16x16x32_bf16 v[56:59], a[80:83], v[36:39], v[56:59]
    v_cvt_pk_bf16_f32 v116, v116, v117
    v_cvt_pk_bf16_f32 v117, v118, v119
    v_mfma_f32_16x16x32_bf16 v[60:63], a[68:71], v[32:35], v[60:63]
    ds_write_b64 v31, v[116:117]
    v_mfma_f32_16x16x32_bf16 v[60:63], a[84:87], v[36:39], v[60:63]
    ds_read_b128 v[48:51], v6 offset:51200
    v_mfma_f32_16x16x32_bf16 v[64:67], a[72:75], v[32:35], v[64:67]
    ds_read_b128 v[52:55], v7 offset:52224
    v_mfma_f32_16x16x32_bf16 v[64:67], a[88:91], v[36:39], v[64:67]
    s_waitcnt lgkmcnt(5)
    ds_read_b128 v[104:107], v18
    v_mfma_f32_16x16x32_bf16 v[68:71], a[76:79], v[32:35], v[68:71]
    ds_read2_b64 v[108:111], v18 offset0:129 offset1:128
    v_mfma_f32_16x16x32_bf16 v[68:71], a[92:95], v[36:39], v[68:71]
    v_mfma_f32_16x16x32_bf16 v[56:59], a[96:99], v[40:43], v[56:59]
    v_mfma_f32_16x16x32_bf16 v[56:59], a[112:115], v[44:47], v[56:59]
    v_mfma_f32_16x16x32_bf16 v[60:63], a[100:103], v[40:43], v[60:63]
    v_mfma_f32_16x16x32_bf16 v[60:63], a[116:119], v[44:47], v[60:63]
    ds_read_b128 v[32:35], v6 offset:53248
    v_mfma_f32_16x16x32_bf16 v[64:67], a[104:107], v[40:43], v[64:67]
    ds_read_b128 v[36:39], v7 offset:54272
    v_mfma_f32_16x16x32_bf16 v[64:67], a[120:123], v[44:47], v[64:67]
    s_waitcnt lgkmcnt(4)
    v_mfma_f32_16x16x32_bf16 v[68:71], a[108:111], v[40:43], v[68:71]
    s_waitcnt lgkmcnt(3)
    buffer_store_dwordx4 v[104:107], v19, s[24:27], s54 offen nt sc1
    v_mfma_f32_16x16x32_bf16 v[68:71], a[124:127], v[44:47], v[68:71]
    v_mfma_f32_16x16x32_bf16 v[56:59], a[128:131], v[48:51], v[56:59]
    v_mfma_f32_16x16x32_bf16 v[56:59], a[144:147], v[52:55], v[56:59]
    v_mfma_f32_16x16x32_bf16 v[60:63], a[132:135], v[48:51], v[60:63]
    v_mfma_f32_16x16x32_bf16 v[60:63], a[148:151], v[52:55], v[60:63]
    ds_read_b128 v[40:43], v6 offset:55296
    v_mfma_f32_16x16x32_bf16 v[64:67], a[136:139], v[48:51], v[64:67]
    ds_read_b128 v[44:47], v7 offset:56320
    v_mfma_f32_16x16x32_bf16 v[64:67], a[152:155], v[52:55], v[64:67]
    s_waitcnt lgkmcnt(2)
    v_mfma_f32_16x16x32_bf16 v[68:71], a[140:143], v[48:51], v[68:71]
    buffer_store_dwordx4 v[108:111], v20, s[24:27], s54 offen nt sc1
    v_mfma_f32_16x16x32_bf16 v[68:71], a[156:159], v[52:55], v[68:71]
    v_mfma_f32_16x16x32_bf16 v[56:59], a[160:163], v[32:35], v[56:59]
    v_mfma_f32_16x16x32_bf16 v[56:59], a[176:179], v[36:39], v[56:59]
    v_mfma_f32_16x16x32_bf16 v[60:63], a[164:167], v[32:35], v[60:63]
    v_subrev_u32 v6, 57344, v6
    v_mfma_f32_16x16x32_bf16 v[60:63], a[180:183], v[36:39], v[60:63]
    ds_read_b128 v[48:51], v6 offset:0
    v_subrev_u32 v7, 57344, v7
    v_mfma_f32_16x16x32_bf16 v[64:67], a[168:171], v[32:35], v[64:67]
    ds_read_b128 v[52:55], v7 offset:1024
    v_mfma_f32_16x16x32_bf16 v[64:67], a[184:187], v[36:39], v[64:67]
    s_waitcnt lgkmcnt(2)
    v_mfma_f32_16x16x32_bf16 v[68:71], a[172:175], v[32:35], v[68:71]
    v_mfma_f32_16x16x32_bf16 v[68:71], a[188:191], v[36:39], v[68:71]
    v_mfma_f32_16x16x32_bf16 v[56:59], a[192:195], v[40:43], v[56:59]
    v_cvt_pk_bf16_f32 v72, v72, v73
    v_cvt_pk_bf16_f32 v73, v74, v75
    v_mfma_f32_16x16x32_bf16 v[56:59], a[208:211], v[44:47], v[56:59]
    ds_write_b64 v28, v[72:73]
    v_mfma_f32_16x16x32_bf16 v[60:63], a[196:199], v[40:43], v[60:63]
    v_cvt_pk_bf16_f32 v76, v76, v77
    v_cvt_pk_bf16_f32 v77, v78, v79
    v_mfma_f32_16x16x32_bf16 v[60:63], a[212:215], v[44:47], v[60:63]
    ds_read_b128 v[32:35], v6 offset:2048
    v_mfma_f32_16x16x32_bf16 v[64:67], a[200:203], v[40:43], v[64:67]
    ds_read_b128 v[36:39], v7 offset:3072
    v_mfma_f32_16x16x32_bf16 v[64:67], a[216:219], v[44:47], v[64:67]
    s_waitcnt lgkmcnt(3)
    v_mfma_f32_16x16x32_bf16 v[68:71], a[204:207], v[40:43], v[68:71]
    ds_write_b64 v29, v[76:77]
    v_mfma_f32_16x16x32_bf16 v[68:71], a[220:223], v[44:47], v[68:71]
    v_cvt_pk_bf16_f32 v80, v80, v81
    v_cvt_pk_bf16_f32 v81, v82, v83
    v_mfma_f32_16x16x32_bf16 v[104:107], a[224:227], v[48:51], 0
    ds_write_b64 v30, v[80:81]
    v_mfma_f32_16x16x32_bf16 v[104:107], a[236:239], v[52:55], v[104:107]
    ds_read_b128 v[40:43], v6 offset:4096
    v_cvt_pk_bf16_f32 v84, v84, v85
    v_mfma_f32_16x16x32_bf16 v[108:111], a[228:231], v[48:51], 0
    ds_read_b128 v[44:47], v7 offset:5120
    v_cvt_pk_bf16_f32 v85, v86, v87
    v_mfma_f32_16x16x32_bf16 v[108:111], a[240:243], v[52:55], v[108:111]
    ds_write_b64 v31, v[84:85]
    v_mfma_f32_16x16x32_bf16 v[112:115], a[232:235], v[48:51], 0
    ds_read_b128 v[72:75], v18
    v_mfma_f32_16x16x32_bf16 v[112:115], a[244:247], v[52:55], v[112:115]
    s_waitcnt lgkmcnt(6)
    ds_read2_b64 v[76:79], v18 offset0:129 offset1:128
    v_mfma_f32_16x16x32_bf16 v[104:107], a[248:251], v[32:35], v[104:107]
    v_mfma_f32_16x16x32_bf16 v[104:107], v[124:127], v[36:39], v[104:107]
    ds_read_b128 v[48:51], v6 offset:6144
    v_mfma_f32_16x16x32_bf16 v[108:111], a[252:255], v[32:35], v[108:111]
    ds_read_b128 v[52:55], v7 offset:7168
    v_mfma_f32_16x16x32_bf16 v[108:111], v[128:131], v[36:39], v[108:111]
    v_mfma_f32_16x16x32_bf16 v[112:115], v[120:123], v[32:35], v[112:115]
    v_mfma_f32_16x16x32_bf16 v[112:115], v[132:135], v[36:39], v[112:115]
    s_waitcnt lgkmcnt(5)
    v_mfma_f32_16x16x32_bf16 v[104:107], v[136:139], v[40:43], v[104:107]
    v_mfma_f32_16x16x32_bf16 v[104:107], v[148:151], v[44:47], v[104:107]
    ds_read_b128 v[32:35], v6 offset:8192
    v_mfma_f32_16x16x32_bf16 v[108:111], v[140:143], v[40:43], v[108:111]
    ds_read_b128 v[36:39], v7 offset:9216
    v_mfma_f32_16x16x32_bf16 v[108:111], v[152:155], v[44:47], v[108:111]
    s_waitcnt lgkmcnt(5)
    buffer_store_dwordx4 v[72:75], v19, s[24:27], s55 offen nt sc1
    v_mfma_f32_16x16x32_bf16 v[112:115], v[144:147], v[40:43], v[112:115]
    v_mfma_f32_16x16x32_bf16 v[112:115], v[156:159], v[44:47], v[112:115]
    s_waitcnt lgkmcnt(2)
    v_mfma_f32_16x16x32_bf16 v[104:107], v[160:163], v[48:51], v[104:107]
    v_mfma_f32_16x16x32_bf16 v[104:107], v[172:175], v[52:55], v[104:107]
    ds_read_b128 v[40:43], v6 offset:10240
    v_mfma_f32_16x16x32_bf16 v[108:111], v[164:167], v[48:51], v[108:111]
    ds_read_b128 v[44:47], v7 offset:11264
    v_mfma_f32_16x16x32_bf16 v[108:111], v[176:179], v[52:55], v[108:111]
    buffer_store_dwordx4 v[76:79], v20, s[24:27], s55 offen nt sc1
    v_mfma_f32_16x16x32_bf16 v[112:115], v[168:171], v[48:51], v[112:115]
    v_mfma_f32_16x16x32_bf16 v[112:115], v[180:183], v[52:55], v[112:115]
    s_waitcnt lgkmcnt(2)
    v_mfma_f32_16x16x32_bf16 v[104:107], v[184:187], v[32:35], v[104:107]
    v_mfma_f32_16x16x32_bf16 v[104:107], v[196:199], v[36:39], v[104:107]
    ds_read_b128 v[48:51], v6 offset:12288
    v_mfma_f32_16x16x32_bf16 v[108:111], v[188:191], v[32:35], v[108:111]
    ds_read_b128 v[52:55], v7 offset:13312
    v_mfma_f32_16x16x32_bf16 v[108:111], v[200:203], v[36:39], v[108:111]
    v_mfma_f32_16x16x32_bf16 v[112:115], v[192:195], v[32:35], v[112:115]
    v_mfma_f32_16x16x32_bf16 v[112:115], v[204:207], v[36:39], v[112:115]
    s_waitcnt lgkmcnt(2)
    v_mfma_f32_16x16x32_bf16 v[104:107], v[208:211], v[40:43], v[104:107]
    v_mfma_f32_16x16x32_bf16 v[104:107], v[220:223], v[44:47], v[104:107]
    ds_read_b128 v[32:35], v6 offset:14336
    v_mfma_f32_16x16x32_bf16 v[108:111], v[212:215], v[40:43], v[108:111]
    ds_read_b128 v[36:39], v7 offset:15360
    v_mfma_f32_16x16x32_bf16 v[108:111], v[224:227], v[44:47], v[108:111]
    v_mfma_f32_16x16x32_bf16 v[112:115], v[216:219], v[40:43], v[112:115]
    v_mfma_f32_16x16x32_bf16 v[112:115], v[228:231], v[44:47], v[112:115]
    s_waitcnt lgkmcnt(2)
    v_mfma_f32_16x16x32_bf16 v[104:107], v[232:235], v[48:51], v[104:107]
    v_mfma_f32_16x16x32_bf16 v[104:107], v[244:247], v[52:55], v[104:107]
    ds_read_b128 v[40:43], v6 offset:16384
    v_mfma_f32_16x16x32_bf16 v[108:111], v[236:239], v[48:51], v[108:111]
    ds_read_b128 v[44:47], v7 offset:17408
    v_mfma_f32_16x16x32_bf16 v[108:111], v[248:251], v[52:55], v[108:111]
    v_mfma_f32_16x16x32_bf16 v[112:115], v[240:243], v[48:51], v[112:115]
    v_cvt_pk_bf16_f32 v88, v88, v89
    v_cvt_pk_bf16_f32 v89, v90, v91
    v_mfma_f32_16x16x32_bf16 v[112:115], v[252:255], v[52:55], v[112:115]
    s_waitcnt lgkmcnt(2)
    v_mfma_f32_16x16x32_bf16 v[72:75], a[224:227], v[32:35], 0
    ds_write_b64 v28, v[88:89]
    v_mfma_f32_16x16x32_bf16 v[72:75], a[236:239], v[36:39], v[72:75]
    ds_read_b128 v[48:51], v6 offset:18432
    v_cvt_pk_bf16_f32 v92, v92, v93
    v_mfma_f32_16x16x32_bf16 v[76:79], a[228:231], v[32:35], 0
    ds_read_b128 v[52:55], v7 offset:19456
    v_cvt_pk_bf16_f32 v93, v94, v95
    v_mfma_f32_16x16x32_bf16 v[76:79], a[240:243], v[36:39], v[76:79]
    ds_write_b64 v29, v[92:93]
    v_mfma_f32_16x16x32_bf16 v[80:83], a[232:235], v[32:35], 0
    v_cvt_pk_bf16_f32 v96, v96, v97
    v_cvt_pk_bf16_f32 v97, v98, v99
    v_mfma_f32_16x16x32_bf16 v[80:83], a[244:247], v[36:39], v[80:83]
    s_waitcnt lgkmcnt(4)
    s_barrier
    v_mfma_f32_16x16x32_bf16 v[72:75], a[248:251], v[40:43], v[72:75]
    ds_write_b64 v30, v[96:97]
    v_mfma_f32_16x16x32_bf16 v[72:75], v[124:127], v[44:47], v[72:75]
    ds_read_b128 v[32:35], v6 offset:20480
    v_cvt_pk_bf16_f32 v100, v100, v101
    v_mfma_f32_16x16x32_bf16 v[76:79], a[252:255], v[40:43], v[76:79]
    ds_read_b128 v[36:39], v7 offset:21504
    v_cvt_pk_bf16_f32 v101, v102, v103
    v_mfma_f32_16x16x32_bf16 v[76:79], v[128:131], v[44:47], v[76:79]
    ds_write_b64 v31, v[100:101]
    v_mfma_f32_16x16x32_bf16 v[80:83], v[120:123], v[40:43], v[80:83]
    ds_read_b128 v[88:91], v18
    v_cvt_pk_bf16_f32 v104, v104, v105
    v_mfma_f32_16x16x32_bf16 v[80:83], v[132:135], v[44:47], v[80:83]
    s_waitcnt lgkmcnt(6)
    ds_read2_b64 v[92:95], v18 offset0:129 offset1:128
    v_mfma_f32_16x16x32_bf16 v[72:75], v[136:139], v[48:51], v[72:75]
    v_cvt_pk_bf16_f32 v105, v106, v107
    v_mfma_f32_16x16x32_bf16 v[72:75], v[148:151], v[52:55], v[72:75]
    ds_read_b128 v[40:43], v6 offset:22528
    v_mfma_f32_16x16x32_bf16 v[76:79], v[140:143], v[48:51], v[76:79]
    ds_read_b128 v[44:47], v7 offset:23552
    v_mfma_f32_16x16x32_bf16 v[76:79], v[152:155], v[52:55], v[76:79]
    ds_write_b64 v21, v[104:105] offset:0
    v_mfma_f32_16x16x32_bf16 v[80:83], v[144:147], v[48:51], v[80:83]
    v_cvt_pk_bf16_f32 v108, v108, v109
    v_cvt_pk_bf16_f32 v109, v110, v111
    v_mfma_f32_16x16x32_bf16 v[80:83], v[156:159], v[52:55], v[80:83]
    s_waitcnt lgkmcnt(6)
    ds_write_b64 v21, v[108:109] offset:32
    v_mfma_f32_16x16x32_bf16 v[72:75], v[160:163], v[32:35], v[72:75]
    v_cvt_pk_bf16_f32 v112, v112, v113
    v_cvt_pk_bf16_f32 v113, v114, v115
    v_mfma_f32_16x16x32_bf16 v[72:75], v[172:175], v[36:39], v[72:75]
    ds_read_b128 v[48:51], v6 offset:24576
    v_mfma_f32_16x16x32_bf16 v[76:79], v[164:167], v[32:35], v[76:79]
    ds_read_b128 v[52:55], v7 offset:25600
    v_mfma_f32_16x16x32_bf16 v[76:79], v[176:179], v[36:39], v[76:79]
    s_waitcnt lgkmcnt(7)
    buffer_store_dwordx4 v[88:91], v19, s[24:27], s56 offen nt sc1
    v_mfma_f32_16x16x32_bf16 v[80:83], v[168:171], v[32:35], v[80:83]
    ds_write_b64 v22, v[112:113] offset:0
    v_mfma_f32_16x16x32_bf16 v[80:83], v[180:183], v[36:39], v[80:83]
    s_waitcnt lgkmcnt(5)
    v_mfma_f32_16x16x32_bf16 v[72:75], v[184:187], v[40:43], v[72:75]
    v_mfma_f32_16x16x32_bf16 v[72:75], v[196:199], v[44:47], v[72:75]
    ds_read_b128 v[32:35], v6 offset:26624
    v_mfma_f32_16x16x32_bf16 v[76:79], v[188:191], v[40:43], v[76:79]
    ds_read_b128 v[36:39], v7 offset:27648
    v_mfma_f32_16x16x32_bf16 v[76:79], v[200:203], v[44:47], v[76:79]
    buffer_store_dwordx4 v[92:95], v20, s[24:27], s56 offen nt sc1
    v_mfma_f32_16x16x32_bf16 v[80:83], v[192:195], v[40:43], v[80:83]
    v_mfma_f32_16x16x32_bf16 v[80:83], v[204:207], v[44:47], v[80:83]
    s_waitcnt lgkmcnt(3)
    v_mfma_f32_16x16x32_bf16 v[72:75], v[208:211], v[48:51], v[72:75]
    v_mfma_f32_16x16x32_bf16 v[72:75], v[220:223], v[52:55], v[72:75]
    ds_read_b128 v[40:43], v6 offset:28672
    v_mfma_f32_16x16x32_bf16 v[76:79], v[212:215], v[48:51], v[76:79]
    ds_read_b128 v[44:47], v7 offset:29696
    v_mfma_f32_16x16x32_bf16 v[76:79], v[224:227], v[52:55], v[76:79]
    v_mfma_f32_16x16x32_bf16 v[80:83], v[216:219], v[48:51], v[80:83]
    v_mfma_f32_16x16x32_bf16 v[80:83], v[228:231], v[52:55], v[80:83]
    s_waitcnt lgkmcnt(2)
    v_mfma_f32_16x16x32_bf16 v[72:75], v[232:235], v[32:35], v[72:75]
    v_mfma_f32_16x16x32_bf16 v[72:75], v[244:247], v[36:39], v[72:75]
    ds_read_b128 v[48:51], v6 offset:30720
    v_mfma_f32_16x16x32_bf16 v[76:79], v[236:239], v[32:35], v[76:79]
    ds_read_b128 v[52:55], v7 offset:31744
    v_mfma_f32_16x16x32_bf16 v[76:79], v[248:251], v[36:39], v[76:79]
    v_mfma_f32_16x16x32_bf16 v[80:83], v[240:243], v[32:35], v[80:83]
    v_mfma_f32_16x16x32_bf16 v[80:83], v[252:255], v[36:39], v[80:83]
    s_waitcnt lgkmcnt(2)
    v_mfma_f32_16x16x32_bf16 v[88:91], a[224:227], v[40:43], 0
    v_mfma_f32_16x16x32_bf16 v[88:91], a[236:239], v[44:47], v[88:91]
    ds_read_b128 v[32:35], v6 offset:32768
    v_cvt_pk_bf16_f32 v56, v56, v57
    v_mfma_f32_16x16x32_bf16 v[92:95], a[228:231], v[40:43], 0
    ds_read_b128 v[36:39], v7 offset:33792
    v_cvt_pk_bf16_f32 v57, v58, v59
    v_mfma_f32_16x16x32_bf16 v[92:95], a[240:243], v[44:47], v[92:95]
    ds_write_b64 v28, v[56:57]
    v_mfma_f32_16x16x32_bf16 v[96:99], a[232:235], v[40:43], 0
    v_cvt_pk_bf16_f32 v60, v60, v61
    v_cvt_pk_bf16_f32 v61, v62, v63
    v_mfma_f32_16x16x32_bf16 v[96:99], a[244:247], v[44:47], v[96:99]
    s_waitcnt lgkmcnt(3)
    v_cvt_pk_bf16_f32 v72, v72, v73
    v_cvt_pk_bf16_f32 v73, v74, v75
    v_mfma_f32_16x16x32_bf16 v[88:91], a[248:251], v[48:51], v[88:91]
    ds_write_b64 v29, v[60:61]
    v_mfma_f32_16x16x32_bf16 v[88:91], v[124:127], v[52:55], v[88:91]
    ds_read_b128 v[40:43], v6 offset:34816
    v_cvt_pk_bf16_f32 v64, v64, v65
    v_mfma_f32_16x16x32_bf16 v[92:95], a[252:255], v[48:51], v[92:95]
    ds_read_b128 v[44:47], v7 offset:35840
    v_cvt_pk_bf16_f32 v65, v66, v67
    v_mfma_f32_16x16x32_bf16 v[92:95], v[128:131], v[52:55], v[92:95]
    ds_write_b64 v30, v[64:65]
    v_mfma_f32_16x16x32_bf16 v[96:99], v[120:123], v[48:51], v[96:99]
    v_cvt_pk_bf16_f32 v68, v68, v69
    v_cvt_pk_bf16_f32 v69, v70, v71
    v_mfma_f32_16x16x32_bf16 v[96:99], v[132:135], v[52:55], v[96:99]
    s_waitcnt lgkmcnt(5)
    ds_write_b64 v21, v[72:73] offset:12288
    v_mfma_f32_16x16x32_bf16 v[88:91], v[136:139], v[32:35], v[88:91]
    ds_write_b64 v31, v[68:69]
    v_mfma_f32_16x16x32_bf16 v[88:91], v[148:151], v[36:39], v[88:91]
    ds_read_b128 v[48:51], v6 offset:36864
    v_cvt_pk_bf16_f32 v76, v76, v77
    v_mfma_f32_16x16x32_bf16 v[92:95], v[140:143], v[32:35], v[92:95]
    ds_read_b128 v[52:55], v7 offset:37888
    v_cvt_pk_bf16_f32 v77, v78, v79
    v_mfma_f32_16x16x32_bf16 v[92:95], v[152:155], v[36:39], v[92:95]
    ds_read_b128 v[56:59], v18
    v_mfma_f32_16x16x32_bf16 v[96:99], v[144:147], v[32:35], v[96:99]
    ds_read2_b64 v[60:63], v18 offset0:129 offset1:128
    v_mfma_f32_16x16x32_bf16 v[96:99], v[156:159], v[36:39], v[96:99]
    s_waitcnt lgkmcnt(7)
    ds_write_b64 v21, v[76:77] offset:12320
    v_mfma_f32_16x16x32_bf16 v[88:91], v[160:163], v[40:43], v[88:91]
    v_cvt_pk_bf16_f32 v80, v80, v81
    v_cvt_pk_bf16_f32 v81, v82, v83
    v_mfma_f32_16x16x32_bf16 v[88:91], v[172:175], v[44:47], v[88:91]
    ds_read_b128 v[32:35], v6 offset:38912
    v_mfma_f32_16x16x32_bf16 v[92:95], v[164:167], v[40:43], v[92:95]
    ds_read_b128 v[36:39], v7 offset:39936
    v_mfma_f32_16x16x32_bf16 v[92:95], v[176:179], v[44:47], v[92:95]
    ds_write_b64 v22, v[80:81] offset:12288
    v_mfma_f32_16x16x32_bf16 v[96:99], v[168:171], v[40:43], v[96:99]
    v_mfma_f32_16x16x32_bf16 v[96:99], v[180:183], v[44:47], v[96:99]
    s_waitcnt lgkmcnt(6)
    v_mfma_f32_16x16x32_bf16 v[88:91], v[184:187], v[48:51], v[88:91]
    s_waitcnt lgkmcnt(5)
    buffer_store_dwordx4 v[56:59], v19, s[24:27], s57 offen nt sc1
    v_mfma_f32_16x16x32_bf16 v[88:91], v[196:199], v[52:55], v[88:91]
    ds_read_b128 v[40:43], v6 offset:40960
    v_mfma_f32_16x16x32_bf16 v[92:95], v[188:191], v[48:51], v[92:95]
    ds_read_b128 v[44:47], v7 offset:41984
    v_mfma_f32_16x16x32_bf16 v[92:95], v[200:203], v[52:55], v[92:95]
    s_waitcnt lgkmcnt(2)
    s_barrier
    v_mfma_f32_16x16x32_bf16 v[96:99], v[192:195], v[48:51], v[96:99]
    ds_read_b128 v[104:107], v23 offset:0
    v_mfma_f32_16x16x32_bf16 v[96:99], v[204:207], v[52:55], v[96:99]
    ds_read_b64 v[108:109], v24 offset:0
    v_mfma_f32_16x16x32_bf16 v[88:91], v[208:211], v[32:35], v[88:91]
    buffer_store_dwordx4 v[60:63], v20, s[24:27], s57 offen nt sc1
    v_mfma_f32_16x16x32_bf16 v[88:91], v[220:223], v[36:39], v[88:91]
    ds_read_b128 v[48:51], v6 offset:43008
    v_mfma_f32_16x16x32_bf16 v[92:95], v[212:215], v[32:35], v[92:95]
    ds_read_b128 v[52:55], v7 offset:44032
    v_mfma_f32_16x16x32_bf16 v[92:95], v[224:227], v[36:39], v[92:95]
    ds_read_b128 v[112:115], v23 offset:12288
    v_mfma_f32_16x16x32_bf16 v[96:99], v[216:219], v[32:35], v[96:99]
    ds_read_b64 v[116:117], v24 offset:12288
    v_mfma_f32_16x16x32_bf16 v[96:99], v[228:231], v[36:39], v[96:99]
    s_waitcnt lgkmcnt(6)
    v_mfma_f32_16x16x32_bf16 v[88:91], v[232:235], v[40:43], v[88:91]
    v_mfma_f32_16x16x32_bf16 v[88:91], v[244:247], v[44:47], v[88:91]
    ds_read_b128 v[32:35], v6 offset:45056
    v_mfma_f32_16x16x32_bf16 v[92:95], v[236:239], v[40:43], v[92:95]
    ds_read_b128 v[36:39], v7 offset:46080
    v_mfma_f32_16x16x32_bf16 v[92:95], v[248:251], v[44:47], v[92:95]
    v_mfma_f32_16x16x32_bf16 v[96:99], v[240:243], v[40:43], v[96:99]
    v_mfma_f32_16x16x32_bf16 v[96:99], v[252:255], v[44:47], v[96:99]
    s_waitcnt lgkmcnt(4)
    v_mfma_f32_16x16x32_bf16 v[56:59], a[224:227], v[48:51], 0
    buffer_store_dwordx4 v[104:107], v0, s[24:27], s50 offen offset:512 nt sc1
    v_mfma_f32_16x16x32_bf16 v[56:59], a[236:239], v[52:55], v[56:59]
    ds_read_b128 v[40:43], v6 offset:47104
    v_mfma_f32_16x16x32_bf16 v[60:63], a[228:231], v[48:51], 0
    ds_read_b128 v[44:47], v7 offset:48128
    v_mfma_f32_16x16x32_bf16 v[60:63], a[240:243], v[52:55], v[60:63]
    v_mfma_f32_16x16x32_bf16 v[64:67], a[232:235], v[48:51], 0
    v_cvt_pk_bf16_f32 v88, v88, v89
    v_cvt_pk_bf16_f32 v89, v90, v91
    v_mfma_f32_16x16x32_bf16 v[64:67], a[244:247], v[52:55], v[64:67]
    s_waitcnt lgkmcnt(2)
    ds_write_b64 v21, v[88:89] offset:24576
    v_mfma_f32_16x16x32_bf16 v[56:59], a[248:251], v[32:35], v[56:59]
    v_cvt_pk_bf16_f32 v92, v92, v93
    v_cvt_pk_bf16_f32 v93, v94, v95
    v_mfma_f32_16x16x32_bf16 v[56:59], v[124:127], v[36:39], v[56:59]
    ds_read_b128 v[48:51], v6 offset:49152
    v_mfma_f32_16x16x32_bf16 v[60:63], a[252:255], v[32:35], v[60:63]
    ds_read_b128 v[52:55], v7 offset:50176
    v_mfma_f32_16x16x32_bf16 v[60:63], v[128:131], v[36:39], v[60:63]
    buffer_store_dwordx2 v[108:109], v1, s[24:27], s50 offen nt sc1
    v_mfma_f32_16x16x32_bf16 v[64:67], v[120:123], v[32:35], v[64:67]
    ds_write_b64 v21, v[92:93] offset:24608
    v_mfma_f32_16x16x32_bf16 v[64:67], v[132:135], v[36:39], v[64:67]
    s_waitcnt lgkmcnt(4)
    v_cvt_pk_bf16_f32 v96, v96, v97
    v_cvt_pk_bf16_f32 v97, v98, v99
    v_mfma_f32_16x16x32_bf16 v[56:59], v[136:139], v[40:43], v[56:59]
    ds_write_b64 v22, v[96:97] offset:24576
    v_mfma_f32_16x16x32_bf16 v[56:59], v[148:151], v[44:47], v[56:59]
    ds_read_b128 v[32:35], v6 offset:51200
    v_mfma_f32_16x16x32_bf16 v[60:63], v[140:143], v[40:43], v[60:63]
    ds_read_b128 v[36:39], v7 offset:52224
    v_mfma_f32_16x16x32_bf16 v[60:63], v[152:155], v[44:47], v[60:63]
    v_mfma_f32_16x16x32_bf16 v[64:67], v[144:147], v[40:43], v[64:67]
    v_mfma_f32_16x16x32_bf16 v[64:67], v[156:159], v[44:47], v[64:67]
    s_waitcnt lgkmcnt(4)
    v_mfma_f32_16x16x32_bf16 v[56:59], v[160:163], v[48:51], v[56:59]
    buffer_store_dwordx4 v[112:115], v0, s[24:27], s51 offen offset:512 nt sc1
    v_mfma_f32_16x16x32_bf16 v[56:59], v[172:175], v[52:55], v[56:59]
    ds_read_b128 v[40:43], v6 offset:53248
    v_mfma_f32_16x16x32_bf16 v[60:63], v[164:167], v[48:51], v[60:63]
    ds_read_b128 v[44:47], v7 offset:54272
    v_mfma_f32_16x16x32_bf16 v[60:63], v[176:179], v[52:55], v[60:63]
    v_mfma_f32_16x16x32_bf16 v[64:67], v[168:171], v[48:51], v[64:67]
    v_mfma_f32_16x16x32_bf16 v[64:67], v[180:183], v[52:55], v[64:67]
    s_waitcnt lgkmcnt(2)
    v_mfma_f32_16x16x32_bf16 v[56:59], v[184:187], v[32:35], v[56:59]
    v_mfma_f32_16x16x32_bf16 v[56:59], v[196:199], v[36:39], v[56:59]
    ds_read_b128 v[48:51], v6 offset:55296
    v_mfma_f32_16x16x32_bf16 v[60:63], v[188:191], v[32:35], v[60:63]
    ds_read_b128 v[52:55], v7 offset:56320
    v_mfma_f32_16x16x32_bf16 v[60:63], v[200:203], v[36:39], v[60:63]
    buffer_store_dwordx2 v[116:117], v1, s[24:27], s51 offen nt sc1
    v_mfma_f32_16x16x32_bf16 v[64:67], v[192:195], v[32:35], v[64:67]
    v_mfma_f32_16x16x32_bf16 v[64:67], v[204:207], v[36:39], v[64:67]
    s_waitcnt lgkmcnt(2)
    v_mfma_f32_16x16x32_bf16 v[56:59], v[208:211], v[40:43], v[56:59]
    v_add_u32 v6, 57344, v6
    v_mfma_f32_16x16x32_bf16 v[56:59], v[220:223], v[44:47], v[56:59]
    ds_read_b128 v[32:35], v6 offset:0
    v_add_u32 v7, 57344, v7
    v_mfma_f32_16x16x32_bf16 v[60:63], v[212:215], v[40:43], v[60:63]
    ds_read_b128 v[36:39], v7 offset:1024
    v_mfma_f32_16x16x32_bf16 v[60:63], v[224:227], v[44:47], v[60:63]
    v_mfma_f32_16x16x32_bf16 v[64:67], v[216:219], v[40:43], v[64:67]
    v_mfma_f32_16x16x32_bf16 v[64:67], v[228:231], v[44:47], v[64:67]
    s_waitcnt lgkmcnt(2)
    v_mfma_f32_16x16x32_bf16 v[56:59], v[232:235], v[48:51], v[56:59]
    v_mfma_f32_16x16x32_bf16 v[56:59], v[244:247], v[52:55], v[56:59]
    ds_read_b128 v[40:43], v6 offset:2048
    v_mfma_f32_16x16x32_bf16 v[60:63], v[236:239], v[48:51], v[60:63]
    ds_read_b128 v[44:47], v7 offset:3072
    v_mfma_f32_16x16x32_bf16 v[60:63], v[248:251], v[52:55], v[60:63]
    v_mfma_f32_16x16x32_bf16 v[64:67], v[240:243], v[48:51], v[64:67]
    v_mfma_f32_16x16x32_bf16 v[64:67], v[252:255], v[52:55], v[64:67]
    s_waitcnt lgkmcnt(2)
    v_mfma_f32_16x16x32_bf16 v[72:75], a[224:227], v[32:35], 0
    v_mfma_f32_16x16x32_bf16 v[72:75], a[236:239], v[36:39], v[72:75]
    ds_read_b128 v[48:51], v6 offset:4096
    v_mfma_f32_16x16x32_bf16 v[76:79], a[228:231], v[32:35], 0
    ds_read_b128 v[52:55], v7 offset:5120
    v_mfma_f32_16x16x32_bf16 v[76:79], a[240:243], v[36:39], v[76:79]
    v_mfma_f32_16x16x32_bf16 v[80:83], a[232:235], v[32:35], 0
    v_cvt_pk_bf16_f32 v56, v56, v57
    v_cvt_pk_bf16_f32 v57, v58, v59
    v_mfma_f32_16x16x32_bf16 v[80:83], a[244:247], v[36:39], v[80:83]
    s_waitcnt lgkmcnt(2)
    ds_write_b64 v21, v[56:57] offset:36864
    v_mfma_f32_16x16x32_bf16 v[72:75], a[248:251], v[40:43], v[72:75]
    v_cvt_pk_bf16_f32 v60, v60, v61
    v_cvt_pk_bf16_f32 v61, v62, v63
    v_mfma_f32_16x16x32_bf16 v[72:75], v[124:127], v[44:47], v[72:75]
    ds_read_b128 v[32:35], v6 offset:6144
    v_mfma_f32_16x16x32_bf16 v[76:79], a[252:255], v[40:43], v[76:79]
    ds_read_b128 v[36:39], v7 offset:7168
    v_mfma_f32_16x16x32_bf16 v[76:79], v[128:131], v[44:47], v[76:79]
    ds_write_b64 v21, v[60:61] offset:36896
    v_mfma_f32_16x16x32_bf16 v[80:83], v[120:123], v[40:43], v[80:83]
    v_cvt_pk_bf16_f32 v64, v64, v65
    v_cvt_pk_bf16_f32 v65, v66, v67
    v_mfma_f32_16x16x32_bf16 v[80:83], v[132:135], v[44:47], v[80:83]
    s_waitcnt lgkmcnt(4)
    ds_write_b64 v22, v[64:65] offset:36864
    v_mfma_f32_16x16x32_bf16 v[72:75], v[136:139], v[48:51], v[72:75]
    v_mfma_f32_16x16x32_bf16 v[72:75], v[148:151], v[52:55], v[72:75]
    ds_read_b128 v[40:43], v6 offset:8192
    v_mfma_f32_16x16x32_bf16 v[76:79], v[140:143], v[48:51], v[76:79]
    ds_read_b128 v[44:47], v7 offset:9216
    v_mfma_f32_16x16x32_bf16 v[76:79], v[152:155], v[52:55], v[76:79]
    v_mfma_f32_16x16x32_bf16 v[80:83], v[144:147], v[48:51], v[80:83]
    v_mfma_f32_16x16x32_bf16 v[80:83], v[156:159], v[52:55], v[80:83]
    s_waitcnt lgkmcnt(4)
    s_waitcnt lgkmcnt(2)
    s_barrier
    v_mfma_f32_16x16x32_bf16 v[72:75], v[160:163], v[32:35], v[72:75]
    ds_read_b128 v[104:107], v23 offset:24576
    v_mfma_f32_16x16x32_bf16 v[72:75], v[172:175], v[36:39], v[72:75]
    ds_read_b128 v[48:51], v6 offset:10240
    v_mfma_f32_16x16x32_bf16 v[76:79], v[164:167], v[32:35], v[76:79]
    ds_read_b128 v[52:55], v7 offset:11264
    v_mfma_f32_16x16x32_bf16 v[76:79], v[176:179], v[36:39], v[76:79]
    ds_read_b64 v[108:109], v24 offset:24576
    v_mfma_f32_16x16x32_bf16 v[80:83], v[168:171], v[32:35], v[80:83]
    ds_read_b128 v[112:115], v23 offset:36864
    v_mfma_f32_16x16x32_bf16 v[80:83], v[180:183], v[36:39], v[80:83]
    s_waitcnt lgkmcnt(5)
    ds_read_b64 v[116:117], v24 offset:36864
    v_mfma_f32_16x16x32_bf16 v[72:75], v[184:187], v[40:43], v[72:75]
    v_mfma_f32_16x16x32_bf16 v[72:75], v[196:199], v[44:47], v[72:75]
    ds_read_b128 v[32:35], v6 offset:12288
    v_mfma_f32_16x16x32_bf16 v[76:79], v[188:191], v[40:43], v[76:79]
    ds_read_b128 v[36:39], v7 offset:13312
    v_mfma_f32_16x16x32_bf16 v[76:79], v[200:203], v[44:47], v[76:79]
    v_mfma_f32_16x16x32_bf16 v[80:83], v[192:195], v[40:43], v[80:83]
    v_mfma_f32_16x16x32_bf16 v[80:83], v[204:207], v[44:47], v[80:83]
    s_waitcnt lgkmcnt(5)
    v_mfma_f32_16x16x32_bf16 v[72:75], v[208:211], v[48:51], v[72:75]
    v_mfma_f32_16x16x32_bf16 v[72:75], v[220:223], v[52:55], v[72:75]
    ds_read_b128 v[40:43], v6 offset:14336
    v_mfma_f32_16x16x32_bf16 v[76:79], v[212:215], v[48:51], v[76:79]
    ds_read_b128 v[44:47], v7 offset:15360
    v_mfma_f32_16x16x32_bf16 v[76:79], v[224:227], v[52:55], v[76:79]
    buffer_store_dwordx4 v[104:107], v0, s[24:27], s52 offen offset:512 nt sc1
    v_mfma_f32_16x16x32_bf16 v[80:83], v[216:219], v[48:51], v[80:83]
    v_mfma_f32_16x16x32_bf16 v[80:83], v[228:231], v[52:55], v[80:83]
    s_waitcnt lgkmcnt(2)
    v_mfma_f32_16x16x32_bf16 v[72:75], v[232:235], v[32:35], v[72:75]
    v_mfma_f32_16x16x32_bf16 v[72:75], v[244:247], v[36:39], v[72:75]
    ds_read_b128 v[48:51], v6 offset:16384
    v_mfma_f32_16x16x32_bf16 v[76:79], v[236:239], v[32:35], v[76:79]
    ds_read_b128 v[52:55], v7 offset:17408
    v_mfma_f32_16x16x32_bf16 v[76:79], v[248:251], v[36:39], v[76:79]
    v_mfma_f32_16x16x32_bf16 v[80:83], v[240:243], v[32:35], v[80:83]
    v_mfma_f32_16x16x32_bf16 v[80:83], v[252:255], v[36:39], v[80:83]
    s_waitcnt lgkmcnt(2)
    v_mfma_f32_16x16x32_bf16 v[88:91], a[224:227], v[40:43], 0
    buffer_store_dwordx2 v[108:109], v1, s[24:27], s52 offen nt sc1
    v_mfma_f32_16x16x32_bf16 v[88:91], a[236:239], v[44:47], v[88:91]
    ds_read_b128 v[32:35], v6 offset:18432
    v_mfma_f32_16x16x32_bf16 v[92:95], a[228:231], v[40:43], 0
    ds_read_b128 v[36:39], v7 offset:19456
    v_mfma_f32_16x16x32_bf16 v[92:95], a[240:243], v[44:47], v[92:95]
    v_mfma_f32_16x16x32_bf16 v[96:99], a[232:235], v[40:43], 0
    v_cvt_pk_bf16_f32 v72, v72, v73
    v_cvt_pk_bf16_f32 v73, v74, v75
    v_mfma_f32_16x16x32_bf16 v[96:99], a[244:247], v[44:47], v[96:99]
    s_waitcnt lgkmcnt(2)
    ds_write_b64 v21, v[72:73] offset:0
    v_mfma_f32_16x16x32_bf16 v[88:91], a[248:251], v[48:51], v[88:91]
    v_cvt_pk_bf16_f32 v76, v76, v77
    v_cvt_pk_bf16_f32 v77, v78, v79
    v_mfma_f32_16x16x32_bf16 v[88:91], v[124:127], v[52:55], v[88:91]
    ds_read_b128 v[40:43], v6 offset:20480
    v_mfma_f32_16x16x32_bf16 v[92:95], a[252:255], v[48:51], v[92:95]
    ds_read_b128 v[44:47], v7 offset:21504
    v_mfma_f32_16x16x32_bf16 v[92:95], v[128:131], v[52:55], v[92:95]
    buffer_store_dwordx4 v[112:115], v0, s[24:27], s53 offen offset:512 nt sc1
    v_mfma_f32_16x16x32_bf16 v[96:99], v[120:123], v[48:51], v[96:99]
    ds_write_b64 v21, v[76:77] offset:32
    v_mfma_f32_16x16x32_bf16 v[96:99], v[132:135], v[52:55], v[96:99]
    s_waitcnt lgkmcnt(4)
    v_cvt_pk_bf16_f32 v80, v80, v81
    v_cvt_pk_bf16_f32 v81, v82, v83
    v_mfma_f32_16x16x32_bf16 v[88:91], v[136:139], v[32:35], v[88:91]
    ds_write_b64 v22, v[80:81] offset:0
    v_mfma_f32_16x16x32_bf16 v[88:91], v[148:151], v[36:39], v[88:91]
    ds_read_b128 v[48:51], v6 offset:22528
    v_mfma_f32_16x16x32_bf16 v[92:95], v[140:143], v[32:35], v[92:95]
    ds_read_b128 v[52:55], v7 offset:23552
    v_mfma_f32_16x16x32_bf16 v[92:95], v[152:155], v[36:39], v[92:95]
    v_mfma_f32_16x16x32_bf16 v[96:99], v[144:147], v[32:35], v[96:99]
    v_mfma_f32_16x16x32_bf16 v[96:99], v[156:159], v[36:39], v[96:99]
    s_waitcnt lgkmcnt(4)
    v_mfma_f32_16x16x32_bf16 v[88:91], v[160:163], v[40:43], v[88:91]
    buffer_store_dwordx2 v[116:117], v1, s[24:27], s53 offen nt sc1
    v_mfma_f32_16x16x32_bf16 v[88:91], v[172:175], v[44:47], v[88:91]
    ds_read_b128 v[32:35], v6 offset:24576
    v_mfma_f32_16x16x32_bf16 v[92:95], v[164:167], v[40:43], v[92:95]
    ds_read_b128 v[36:39], v7 offset:25600
    v_mfma_f32_16x16x32_bf16 v[92:95], v[176:179], v[44:47], v[92:95]
    v_mfma_f32_16x16x32_bf16 v[96:99], v[168:171], v[40:43], v[96:99]
    v_mfma_f32_16x16x32_bf16 v[96:99], v[180:183], v[44:47], v[96:99]
    s_waitcnt lgkmcnt(2)
    v_mfma_f32_16x16x32_bf16 v[88:91], v[184:187], v[48:51], v[88:91]
    v_mfma_f32_16x16x32_bf16 v[88:91], v[196:199], v[52:55], v[88:91]
    ds_read_b128 v[40:43], v6 offset:26624
    v_mfma_f32_16x16x32_bf16 v[92:95], v[188:191], v[48:51], v[92:95]
    ds_read_b128 v[44:47], v7 offset:27648
    v_mfma_f32_16x16x32_bf16 v[92:95], v[200:203], v[52:55], v[92:95]
    v_mfma_f32_16x16x32_bf16 v[96:99], v[192:195], v[48:51], v[96:99]
    v_mfma_f32_16x16x32_bf16 v[96:99], v[204:207], v[52:55], v[96:99]
    s_waitcnt lgkmcnt(2)
    v_mfma_f32_16x16x32_bf16 v[88:91], v[208:211], v[32:35], v[88:91]
    v_mfma_f32_16x16x32_bf16 v[88:91], v[220:223], v[36:39], v[88:91]
    ds_read_b128 v[48:51], v6 offset:28672
    v_mfma_f32_16x16x32_bf16 v[92:95], v[212:215], v[32:35], v[92:95]
    ds_read_b128 v[52:55], v7 offset:29696
    v_mfma_f32_16x16x32_bf16 v[92:95], v[224:227], v[36:39], v[92:95]
    v_mfma_f32_16x16x32_bf16 v[96:99], v[216:219], v[32:35], v[96:99]
    v_mfma_f32_16x16x32_bf16 v[96:99], v[228:231], v[36:39], v[96:99]
    s_waitcnt lgkmcnt(2)
    v_mfma_f32_16x16x32_bf16 v[88:91], v[232:235], v[40:43], v[88:91]
    v_mfma_f32_16x16x32_bf16 v[88:91], v[244:247], v[44:47], v[88:91]
    ds_read_b128 v[32:35], v6 offset:30720
    v_mfma_f32_16x16x32_bf16 v[92:95], v[236:239], v[40:43], v[92:95]
    ds_read_b128 v[36:39], v7 offset:31744
    v_mfma_f32_16x16x32_bf16 v[92:95], v[248:251], v[44:47], v[92:95]
    v_mfma_f32_16x16x32_bf16 v[96:99], v[240:243], v[40:43], v[96:99]
    v_mfma_f32_16x16x32_bf16 v[96:99], v[252:255], v[44:47], v[96:99]
    s_waitcnt lgkmcnt(2)
    v_mfma_f32_16x16x32_bf16 v[56:59], a[224:227], v[48:51], 0
    v_mfma_f32_16x16x32_bf16 v[56:59], a[236:239], v[52:55], v[56:59]
    ds_read_b128 v[40:43], v6 offset:32768
    v_mfma_f32_16x16x32_bf16 v[60:63], a[228:231], v[48:51], 0
    ds_read_b128 v[44:47], v7 offset:33792
    v_mfma_f32_16x16x32_bf16 v[60:63], a[240:243], v[52:55], v[60:63]
    v_mfma_f32_16x16x32_bf16 v[64:67], a[232:235], v[48:51], 0
    v_cvt_pk_bf16_f32 v88, v88, v89
    v_cvt_pk_bf16_f32 v89, v90, v91
    v_mfma_f32_16x16x32_bf16 v[64:67], a[244:247], v[52:55], v[64:67]
    s_waitcnt lgkmcnt(2)
    ds_write_b64 v21, v[88:89] offset:12288
    v_mfma_f32_16x16x32_bf16 v[56:59], a[248:251], v[32:35], v[56:59]
    v_cvt_pk_bf16_f32 v92, v92, v93
    v_cvt_pk_bf16_f32 v93, v94, v95
    v_mfma_f32_16x16x32_bf16 v[56:59], v[124:127], v[36:39], v[56:59]
    ds_read_b128 v[48:51], v6 offset:34816
    v_mfma_f32_16x16x32_bf16 v[60:63], a[252:255], v[32:35], v[60:63]
    ds_read_b128 v[52:55], v7 offset:35840
    v_mfma_f32_16x16x32_bf16 v[60:63], v[128:131], v[36:39], v[60:63]
    ds_write_b64 v21, v[92:93] offset:12320
    v_mfma_f32_16x16x32_bf16 v[64:67], v[120:123], v[32:35], v[64:67]
    v_cvt_pk_bf16_f32 v96, v96, v97
    v_cvt_pk_bf16_f32 v97, v98, v99
    v_mfma_f32_16x16x32_bf16 v[64:67], v[132:135], v[36:39], v[64:67]
    s_waitcnt lgkmcnt(4)
    ds_write_b64 v22, v[96:97] offset:12288
    v_mfma_f32_16x16x32_bf16 v[56:59], v[136:139], v[40:43], v[56:59]
    v_mfma_f32_16x16x32_bf16 v[56:59], v[148:151], v[44:47], v[56:59]
    ds_read_b128 v[32:35], v6 offset:36864
    v_mfma_f32_16x16x32_bf16 v[60:63], v[140:143], v[40:43], v[60:63]
    ds_read_b128 v[36:39], v7 offset:37888
    v_mfma_f32_16x16x32_bf16 v[60:63], v[152:155], v[44:47], v[60:63]
    v_mfma_f32_16x16x32_bf16 v[64:67], v[144:147], v[40:43], v[64:67]
    v_mfma_f32_16x16x32_bf16 v[64:67], v[156:159], v[44:47], v[64:67]
    s_waitcnt lgkmcnt(4)
    s_waitcnt lgkmcnt(2)
    s_barrier
    v_mfma_f32_16x16x32_bf16 v[56:59], v[160:163], v[48:51], v[56:59]
    ds_read_b128 v[104:107], v23 offset:0
    v_mfma_f32_16x16x32_bf16 v[56:59], v[172:175], v[52:55], v[56:59]
    ds_read_b128 v[40:43], v6 offset:38912
    v_mfma_f32_16x16x32_bf16 v[60:63], v[164:167], v[48:51], v[60:63]
    ds_read_b128 v[44:47], v7 offset:39936
    v_mfma_f32_16x16x32_bf16 v[60:63], v[176:179], v[52:55], v[60:63]
    ds_read_b64 v[108:109], v24 offset:0
    v_mfma_f32_16x16x32_bf16 v[64:67], v[168:171], v[48:51], v[64:67]
    ds_read_b128 v[112:115], v23 offset:12288
    v_mfma_f32_16x16x32_bf16 v[64:67], v[180:183], v[52:55], v[64:67]
    s_waitcnt lgkmcnt(5)
    ds_read_b64 v[116:117], v24 offset:12288
    v_mfma_f32_16x16x32_bf16 v[56:59], v[184:187], v[32:35], v[56:59]
    v_mfma_f32_16x16x32_bf16 v[56:59], v[196:199], v[36:39], v[56:59]
    ds_read_b128 v[48:51], v6 offset:40960
    v_mfma_f32_16x16x32_bf16 v[60:63], v[188:191], v[32:35], v[60:63]
    ds_read_b128 v[52:55], v7 offset:41984
    v_mfma_f32_16x16x32_bf16 v[60:63], v[200:203], v[36:39], v[60:63]
    v_mfma_f32_16x16x32_bf16 v[64:67], v[192:195], v[32:35], v[64:67]
    v_mfma_f32_16x16x32_bf16 v[64:67], v[204:207], v[36:39], v[64:67]
    s_waitcnt lgkmcnt(5)
    v_mfma_f32_16x16x32_bf16 v[56:59], v[208:211], v[40:43], v[56:59]
    v_mfma_f32_16x16x32_bf16 v[56:59], v[220:223], v[44:47], v[56:59]
    ds_read_b128 v[32:35], v6 offset:43008
    v_mfma_f32_16x16x32_bf16 v[60:63], v[212:215], v[40:43], v[60:63]
    ds_read_b128 v[36:39], v7 offset:44032
    v_mfma_f32_16x16x32_bf16 v[60:63], v[224:227], v[44:47], v[60:63]
    buffer_store_dwordx4 v[104:107], v0, s[24:27], s54 offen offset:512 nt sc1
    v_mfma_f32_16x16x32_bf16 v[64:67], v[216:219], v[40:43], v[64:67]
    v_mfma_f32_16x16x32_bf16 v[64:67], v[228:231], v[44:47], v[64:67]
    s_waitcnt lgkmcnt(2)
    v_mfma_f32_16x16x32_bf16 v[56:59], v[232:235], v[48:51], v[56:59]
    v_mfma_f32_16x16x32_bf16 v[56:59], v[244:247], v[52:55], v[56:59]
    ds_read_b128 v[40:43], v6 offset:45056
    v_mfma_f32_16x16x32_bf16 v[60:63], v[236:239], v[48:51], v[60:63]
    ds_read_b128 v[44:47], v7 offset:46080
    v_mfma_f32_16x16x32_bf16 v[60:63], v[248:251], v[52:55], v[60:63]
    v_mfma_f32_16x16x32_bf16 v[64:67], v[240:243], v[48:51], v[64:67]
    buffer_store_dwordx2 v[108:109], v1, s[24:27], s54 offen nt sc1
    v_mfma_f32_16x16x32_bf16 v[64:67], v[252:255], v[52:55], v[64:67]
    s_waitcnt lgkmcnt(2)
    v_mfma_f32_16x16x32_bf16 v[72:75], a[224:227], v[32:35], 0
    v_mfma_f32_16x16x32_bf16 v[72:75], a[236:239], v[36:39], v[72:75]
    ds_read_b128 v[48:51], v6 offset:47104
    v_mfma_f32_16x16x32_bf16 v[76:79], a[228:231], v[32:35], 0
    ds_read_b128 v[52:55], v7 offset:48128
    v_mfma_f32_16x16x32_bf16 v[76:79], a[240:243], v[36:39], v[76:79]
    v_mfma_f32_16x16x32_bf16 v[80:83], a[232:235], v[32:35], 0
    v_cvt_pk_bf16_f32 v56, v56, v57
    v_cvt_pk_bf16_f32 v57, v58, v59
    v_mfma_f32_16x16x32_bf16 v[80:83], a[244:247], v[36:39], v[80:83]
    s_waitcnt lgkmcnt(2)
    ds_write_b64 v21, v[56:57] offset:24576
    v_mfma_f32_16x16x32_bf16 v[72:75], a[248:251], v[40:43], v[72:75]
    buffer_store_dwordx4 v[112:115], v0, s[24:27], s55 offen offset:512 nt sc1
    v_mfma_f32_16x16x32_bf16 v[72:75], v[124:127], v[44:47], v[72:75]
    ds_read_b128 v[32:35], v6 offset:49152
    v_cvt_pk_bf16_f32 v60, v60, v61
    v_mfma_f32_16x16x32_bf16 v[76:79], a[252:255], v[40:43], v[76:79]
    ds_read_b128 v[36:39], v7 offset:50176
    v_cvt_pk_bf16_f32 v61, v62, v63
    v_mfma_f32_16x16x32_bf16 v[76:79], v[128:131], v[44:47], v[76:79]
    ds_write_b64 v21, v[60:61] offset:24608
    v_mfma_f32_16x16x32_bf16 v[80:83], v[120:123], v[40:43], v[80:83]
    v_cvt_pk_bf16_f32 v64, v64, v65
    v_cvt_pk_bf16_f32 v65, v66, v67
    v_mfma_f32_16x16x32_bf16 v[80:83], v[132:135], v[44:47], v[80:83]
    s_waitcnt lgkmcnt(4)
    ds_write_b64 v22, v[64:65] offset:24576
    v_mfma_f32_16x16x32_bf16 v[72:75], v[136:139], v[48:51], v[72:75]
    v_mfma_f32_16x16x32_bf16 v[72:75], v[148:151], v[52:55], v[72:75]
    ds_read_b128 v[40:43], v6 offset:51200
    v_mfma_f32_16x16x32_bf16 v[76:79], v[140:143], v[48:51], v[76:79]
    ds_read_b128 v[44:47], v7 offset:52224
    v_mfma_f32_16x16x32_bf16 v[76:79], v[152:155], v[52:55], v[76:79]
    buffer_store_dwordx2 v[116:117], v1, s[24:27], s55 offen nt sc1
    v_mfma_f32_16x16x32_bf16 v[80:83], v[144:147], v[48:51], v[80:83]
    v_mfma_f32_16x16x32_bf16 v[80:83], v[156:159], v[52:55], v[80:83]
    s_waitcnt lgkmcnt(4)
    s_waitcnt lgkmcnt(2)
    s_barrier
    v_mfma_f32_16x16x32_bf16 v[72:75], v[160:163], v[32:35], v[72:75]
    ds_read_b128 v[104:107], v23 offset:24576
    v_mfma_f32_16x16x32_bf16 v[72:75], v[172:175], v[36:39], v[72:75]
    ds_read_b128 v[48:51], v6 offset:53248
    v_mfma_f32_16x16x32_bf16 v[76:79], v[164:167], v[32:35], v[76:79]
    ds_read_b128 v[52:55], v7 offset:54272
    v_mfma_f32_16x16x32_bf16 v[76:79], v[176:179], v[36:39], v[76:79]
    ds_read_b64 v[108:109], v24 offset:24576
    v_mfma_f32_16x16x32_bf16 v[80:83], v[168:171], v[32:35], v[80:83]
    v_mfma_f32_16x16x32_bf16 v[80:83], v[180:183], v[36:39], v[80:83]
    s_waitcnt lgkmcnt(4)
    v_mfma_f32_16x16x32_bf16 v[72:75], v[184:187], v[40:43], v[72:75]
    v_mfma_f32_16x16x32_bf16 v[72:75], v[196:199], v[44:47], v[72:75]
    ds_read_b128 v[32:35], v6 offset:55296
    v_mfma_f32_16x16x32_bf16 v[76:79], v[188:191], v[40:43], v[76:79]
    ds_read_b128 v[36:39], v7 offset:56320
    v_mfma_f32_16x16x32_bf16 v[76:79], v[200:203], v[44:47], v[76:79]
    v_mfma_f32_16x16x32_bf16 v[80:83], v[192:195], v[40:43], v[80:83]
    v_mfma_f32_16x16x32_bf16 v[80:83], v[204:207], v[44:47], v[80:83]
    s_waitcnt lgkmcnt(3)
    v_mfma_f32_16x16x32_bf16 v[72:75], v[208:211], v[48:51], v[72:75]
    buffer_store_dwordx4 v[104:107], v0, s[24:27], s56 offen offset:512 nt sc1
    v_mfma_f32_16x16x32_bf16 v[72:75], v[220:223], v[52:55], v[72:75]
    v_mfma_f32_16x16x32_bf16 v[76:79], v[212:215], v[48:51], v[76:79]
    v_mfma_f32_16x16x32_bf16 v[76:79], v[224:227], v[52:55], v[76:79]
    v_mfma_f32_16x16x32_bf16 v[80:83], v[216:219], v[48:51], v[80:83]
    s_waitcnt lgkmcnt(2)
    buffer_store_dwordx2 v[108:109], v1, s[24:27], s56 offen nt sc1
    v_mfma_f32_16x16x32_bf16 v[80:83], v[228:231], v[52:55], v[80:83]
    s_waitcnt lgkmcnt(0)
    v_mfma_f32_16x16x32_bf16 v[72:75], v[232:235], v[32:35], v[72:75]
    v_mfma_f32_16x16x32_bf16 v[72:75], v[244:247], v[36:39], v[72:75]
    v_mfma_f32_16x16x32_bf16 v[76:79], v[236:239], v[32:35], v[76:79]
    v_mfma_f32_16x16x32_bf16 v[76:79], v[248:251], v[36:39], v[76:79]
    v_mfma_f32_16x16x32_bf16 v[80:83], v[240:243], v[32:35], v[80:83]
    v_mfma_f32_16x16x32_bf16 v[80:83], v[252:255], v[36:39], v[80:83]
    s_nop 3
    v_cvt_pk_bf16_f32 v72, v72, v73
    v_cvt_pk_bf16_f32 v73, v74, v75
    ds_write_b64 v21, v[72:73] offset:36864
    v_cvt_pk_bf16_f32 v76, v76, v77
    v_cvt_pk_bf16_f32 v77, v78, v79
    ds_write_b64 v21, v[76:77] offset:36896
    v_cvt_pk_bf16_f32 v80, v80, v81
    v_cvt_pk_bf16_f32 v81, v82, v83
    ds_write_b64 v22, v[80:81] offset:36864
    s_waitcnt lgkmcnt(0)
    s_barrier
    ds_read_b128 v[112:115], v23 offset:36864
    ds_read_b64 v[116:117], v24 offset:36864
    s_waitcnt lgkmcnt(1)
    buffer_store_dwordx4 v[112:115], v0, s[24:27], s57 offen offset:512 nt sc1
    s_waitcnt lgkmcnt(0)
    buffer_store_dwordx2 v[116:117], v1, s[24:27], s57 offen nt sc1
L_end:
    s_endpgm
L_codeend:
.fill 1280, 4, 0xbf800000
.set CODE_LINES, (L_codeend - standalone__layernorm_linear__sampling_kernel) / 128 + 32
.section .rodata,"a"
.p2align 6
.amdhsa_kernel standalone__layernorm_linear__sampling_kernel
  .amdhsa_next_free_vgpr 512
  .amdhsa_next_free_sgpr 102
  .amdhsa_accum_offset 256
  .amdhsa_group_segment_fixed_size 0
  .amdhsa_kernarg_size 56
  .amdhsa_user_sgpr_count 2
  .amdhsa_user_sgpr_kernarg_segment_ptr 1
  .amdhsa_system_sgpr_workgroup_id_x 1
.end_amdhsa_kernel
```
